```python
import torch

def _softmax(x, axis=-1):
    return torch.softmax(x, dim=axis)
def _gelu(x):
    return torch.nn.functional.gelu(x, approximate="tanh")
def _silu(x):
    return torch.nn.functional.silu(x)
def _sigmoid(x):
    return torch.sigmoid(x)
def _layernorm(x, axis=-1, eps=1e-5):
    m = x.mean(dim=axis, keepdim=True)
    v = x.var(dim=axis, keepdim=True, unbiased=False)
    return (x - m) / torch.sqrt(v + eps)
def _scatter_add(tgt, idx, src, axis=0):
    return tgt.clone().index_add_(axis, idx, src)
def _segment_sum(src, seg, n):
    out = torch.zeros((n,) + src.shape[1:], dtype=src.dtype)
    return out.index_add_(0, seg, src)
def _pad(x, pw):
    flat = tuple(v for pair in reversed(pw) for v in pair)
    return torch.nn.functional.pad(x, flat)

kernel_name = 'interleave_layers__sliding_local_dilated__glu_gated_reglu__prompt'

def setup_inputs():

    _w = (lambda a: (lambda t: t.to(torch.bfloat16) if t.is_floating_point() else t)(torch.as_tensor(a)))
    def _A_setup():
        B, S, D = 1, 2048, 576
        return {
            "x": _w((lambda *s: torch.randn(*s, dtype=torch.bfloat16) * 0.05)(B, S, D)),
            "wqkv": _w((lambda *s: torch.randn(*s, dtype=torch.bfloat16) * 0.05)(D, 3 * D)),
            "wo": _w((lambda *s: torch.randn(*s, dtype=torch.bfloat16) * 0.05)(D, D)),
        }
    _A_in = _A_setup()

    def _B_setup():
        B, S, D, F = 1, 2048, 576, 4608
        return {
            "x": _w((lambda *s: torch.randn(*s, dtype=torch.bfloat16) * 0.05)(B, S, D)),
            "W_gate": _w((lambda *s: torch.randn(*s, dtype=torch.bfloat16) * 0.8)(D, F) * (2.0 / D) ** 0.5),
            "W_up": _w((lambda *s: torch.randn(*s, dtype=torch.bfloat16) * 0.8)(D, F) * (2.0 / D) ** 0.5),
            "W_down": _w((lambda *s: torch.randn(*s, dtype=torch.bfloat16) * 0.8)(F, D) * (1.0 / F) ** 0.5),
        }
    _B_in = _B_setup()

    return {
        "A_x": _A_in["x"],
        "A_wqkv": _A_in["wqkv"],
        "A_wo": _A_in["wo"],
        "B_x": _B_in["x"],
        "B_W_gate": _B_in["W_gate"],
        "B_W_up": _B_in["W_up"],
        "B_W_down": _B_in["W_down"],
    }

def reference(A_x, A_wqkv, A_wo, B_x, B_W_gate, B_W_up, B_W_down):
    def _A_ref(x, wqkv, wo):
        B, S, D = x.shape
        H = 32; Dh = D // H
        W, dil = 8, 2
        qkv = (lambda x, *d: x.permute(*d))((x @ wqkv).reshape(B, S, 3, H, Dh), 2, 0, 3, 1, 4)
        q, k, v = qkv[0], qkv[1], qkv[2]
        scale = Dh ** -0.5
        pos = torch.arange(S)
        off = torch.arange(W) * dil
        idx = pos[:, None] - off[None, :]
        mask = idx >= 0
        idx_c = torch.where(mask, idx, 0).reshape(-1)
        kg = k[:, :, idx_c, :].reshape(B, H, S, W, Dh)
        vg = v[:, :, idx_c, :].reshape(B, H, S, W, Dh)
        logits = torch.einsum("bhsd,bhswd->bhsw", q, kg) * scale
        logits = torch.where(mask[None, None, :, :], logits, -1e9)
        attn = _softmax(logits, axis=-1)
        o = torch.einsum("bhsw,bhswd->bhsd", attn, vg)
        return (lambda x, *d: x.permute(*d))(o, 0, 2, 1, 3).reshape(B, S, D) @ wo

    def _B_ref(x, W_gate, W_up, W_down):
        gate = torch.einsum("bsd,df->bsf", x, W_gate)
        up = torch.einsum("bsd,df->bsf", x, W_up)
        gate = gate * (lambda x, dt: x.to(dt))(gate > 0, gate.dtype)
        h = gate * up
        return torch.einsum("bsf,fd->bsd", h, W_down)

    x = A_x
    x = x + _A_ref(_layernorm(x, axis=-1), A_wqkv, A_wo)
    x = x + _B_ref(_layernorm(x, axis=-1), B_W_gate, B_W_up, B_W_down)
    x = x + _A_ref(_layernorm(x, axis=-1), A_wqkv, A_wo)
    x = x + _B_ref(_layernorm(x, axis=-1), B_W_gate, B_W_up, B_W_down)
    return x
```

```asm
; @launch kernel=k0_kernel grid=(256,1,1) block=(576,1,1) lds=1024
; @launch kernel=k3_kernel grid=(256,1,1) block=(256,1,1) lds=163840
; @launch kernel=k3d_kernel grid=(256,1,1) block=(256,1,1) lds=163840
.amdgcn_target "amdgcn-amd-amdhsa--gfx950"
.text
.globl k0_kernel
.p2align 8
.type k0_kernel,@function
k0_kernel:
  s_cmp_ge_u32 s2, 256
  s_cbranch_scc1 end_1
  s_load_dwordx2 s[4:5], s[0:1], 72
  s_load_dwordx2 s[6:7], s[0:1], 0
  s_load_dwordx4 s[44:47], s[0:1], 8
  v_lshrrev_b32 v1, 6, v0
  v_and_b32 v2, 63, v0
  v_readfirstlane_b32 s79, v1
  s_nop 0
  s_cmp_lg_u32 s79, 6
  s_cbranch_scc1 noct_3
  s_getpc_b64 s[76:77]
pc_4:
  s_sub_u32 s76, s76, pc_4-k0_kernel
  s_subb_u32 s77, s77, 0
  s_lshr_b32 s78, s2, 3
  s_mul_i32 s78, s78, 17
  v_min_u32 v66, 16, v2
  v_add_u32 v66, s78, v66
  v_lshlrev_b32 v66, 7, v66
  v_min_u32 v66, code_end-k0_kernel-4, v66
  v_mov_b32 v67, s77
  v_add_co_u32 v66, vcc, s76, v66
  s_nop 1
  v_addc_co_u32 v67, vcc, 0, v67, vcc
  global_load_dword v68, v[66:67], off
noct_3:
  s_waitcnt lgkmcnt(0)
  s_mov_b32 s8, s4
  s_mov_b32 s9, s5
  s_mov_b32 s10, 2359296
  s_mov_b32 s11, 0x20000
  s_add_u32 s12, s4, 2359296
  s_addc_u32 s13, s5, 0
  s_mov_b32 s14, 2359296
  s_mov_b32 s15, 0x20000
  s_add_u32 s16, s4, 12460032
  s_addc_u32 s17, s5, 0
  s_mov_b32 s18, 37748736
  s_mov_b32 s19, 0x20000
  s_mov_b32 s20, s6
  s_mov_b32 s21, s7
  s_mov_b32 s22, 2359296
  s_mov_b32 s23, 0x20000
  v_lshrrev_b32 v3, 5, v0
  v_bfe_u32 v4, v0, 3, 2
  v_and_b32 v5, 7, v0
  s_lshr_b32 s24, s2, 1
  s_and_b32 s25, s2, 1
  v_lshlrev_b32 v6, 10, v3
  v_lshl_add_u32 v6, v4, 8, v6
  v_lshl_add_u32 v6, v5, 4, v6
  s_mul_i32 s26, s24, 18432
  s_lshl_b32 s27, s25, 7
  s_add_u32 s26, s26, s27
  v_add_u32 v6, s26, v6
  s_lshl_b32 s27, s2, 3
  v_add_u32 v7, s27, v5
  v_mul_u32_u24 v7, 1152, v7
  v_lshl_add_u32 v7, v3, 6, v7
  v_lshl_add_u32 v7, v4, 3, v7
  s_mov_b32 s56, s44
  s_mov_b32 s57, s45
  s_mov_b32 s58, 1990656
  s_mov_b32 s59, 0x20000
  s_mov_b32 s60, s46
  s_mov_b32 s61, s47
  s_mov_b32 s62, 663552
  s_mov_b32 s63, 0x20000
  s_mov_b32 s64, s4
  s_mov_b32 s65, s5
  s_mov_b32 s66, 57450496
  s_mov_b32 s67, 0x20000
  v_readfirstlane_b32 s47, v1
  s_lshr_b32 s49, s2, 3
  s_mul_i32 s49, s49, 9
  s_add_u32 s48, s47, s49
  s_and_b32 s49, s2, 7
  v_lshrrev_b32 v46, 4, v2
  v_and_b32 v47, 15, v2
  v_mul_u32_u24 v44, 9216, v46
  v_lshl_add_u32 v44, v47, 1, v44
  v_add_u32 v45, 4608, v44
  s_lshr_b32 s68, s2, 3
  s_lshl_b32 s68, s68, 1
  s_add_u32 s68, s68, s47
  s_sub_u32 s68, s68, 7
  s_cmp_lt_u32 s47, 7
  s_cselect_b32 s68, 360, s68
  s_cmp_ge_u32 s68, 45
  s_cbranch_scc1 xfd_7
  s_mul_i32 s51, s49, 81
  s_add_u32 s51, s51, s68
  s_add_u32 s51, s51, 36
  s_mul_i32 s55, s51, 1821
  s_lshr_b32 s55, s55, 16
  s_mul_i32 s54, s55, 36
  s_sub_u32 s54, s51, s54
  s_lshr_b32 s53, s54, 1
  s_mul_i32 s53, s53, 18
  s_add_u32 s53, s53, s55
  s_lshl_b32 s53, s53, 1
  s_and_b32 s52, s54, 1
  s_add_u32 s53, s53, s52
  s_mul_i32 s55, s55, 36864
  s_lshl_b32 s54, s54, 5
  s_add_u32 s55, s55, s54
  buffer_load_ushort v56, v44, s[60:63], s55 offen offset:0
  buffer_load_ushort v57, v44, s[60:63], s55 offen offset:1152
  buffer_load_ushort v58, v44, s[60:63], s55 offen offset:2304
  buffer_load_ushort v59, v44, s[60:63], s55 offen offset:3456
  buffer_load_ushort v60, v45, s[60:63], s55 offen offset:0
  buffer_load_ushort v61, v45, s[60:63], s55 offen offset:1152
  buffer_load_ushort v62, v45, s[60:63], s55 offen offset:2304
  buffer_load_ushort v63, v45, s[60:63], s55 offen offset:3456
  s_lshl_b32 s51, s53, 10
  s_add_u32 s51, s51, 11796480
xfd_7:
  buffer_load_dwordx2 v[8:9], v7, s[20:23], 0 offen
  buffer_load_dwordx2 v[10:11], v7, s[20:23], 0 offen offset:32
  s_cmp_ge_u32 s48, 252
  s_cbranch_scc1 xfwo_5
  s_mul_i32 s50, s49, 252
  s_add_u32 s48, s48, s50
  s_mul_i32 s52, s48, 9363
  s_lshr_b32 s52, s52, 20
  s_mul_i32 s69, s52, 112
  s_sub_u32 s69, s48, s69
  s_mul_i32 s50, s69, 9363
  s_lshr_b32 s50, s50, 16
  s_mul_i32 s53, s50, 7
  s_sub_u32 s53, s69, s53
  s_mul_i32 s48, s50, 126
  s_mul_i32 s69, s52, 7
  s_add_u32 s48, s48, s69
  s_add_u32 s48, s48, s53
  s_lshr_b32 s54, s53, 1
  s_mul_i32 s54, s54, 576
  s_and_b32 s55, s53, 1
  s_mul_i32 s55, s55, 18
  s_add_u32 s54, s54, s55
  v_add_u32 v43, s54, v47
  v_bfe_u32 v42, v47, 1, 1
  v_lshrrev_b32 v41, 2, v47
  v_mul_u32_u24 v40, 576, v42
  v_mul_u32_u24 v41, 18, v41
  v_add_u32 v40, v40, v41
  v_add_u32 v40, 576, v40
  v_mul_u32_u24 v41, 18, v42
  v_cmp_gt_u32 vcc, 8, v47
  s_nop 1
  v_cndmask_b32 v40, v41, v40, vcc
  v_and_b32 v41, 1, v47
  v_add3_u32 v40, v40, v41, 16
  s_cmp_eq_u32 s53, 6
  s_cselect_b64 vcc, -1, 0
  v_cndmask_b32 v43, v43, v40, vcc
  v_mul_u32_u24 v46, 13824, v46
  v_lshl_add_u32 v46, v43, 1, v46
  s_mul_i32 s52, s52, 110592
  s_mul_i32 s50, s50, 72
  s_add_u32 s52, s52, s50
  buffer_load_ushort v48, v46, s[56:59], s52 offen offset:0
  buffer_load_ushort v49, v46, s[56:59], s52 offen offset:3456
  s_add_u32 s52, s52, 6912
  buffer_load_ushort v50, v46, s[56:59], s52 offen offset:0
  buffer_load_ushort v51, v46, s[56:59], s52 offen offset:3456
  s_add_u32 s52, s52, 48384
  buffer_load_ushort v52, v46, s[56:59], s52 offen offset:0
  buffer_load_ushort v53, v46, s[56:59], s52 offen offset:3456
  s_add_u32 s52, s52, 6912
  buffer_load_ushort v54, v46, s[56:59], s52 offen offset:0
  buffer_load_ushort v55, v46, s[56:59], s52 offen offset:3456
  s_lshl_b32 s50, s48, 10
  s_add_u32 s50, s50, 50208768
  s_branch xfb_6
xfwo_5:
  s_mul_i32 s50, s49, 81
  s_add_u32 s50, s50, s48
  s_sub_u32 s50, s50, 252
  s_mul_i32 s55, s50, 1821
  s_lshr_b32 s55, s55, 16
  s_mul_i32 s54, s55, 36
  s_sub_u32 s54, s50, s54
  s_lshr_b32 s53, s54, 1
  s_mul_i32 s53, s53, 18
  s_add_u32 s53, s53, s55
  s_lshl_b32 s53, s53, 1
  s_and_b32 s52, s54, 1
  s_add_u32 s53, s53, s52
  s_mul_i32 s55, s55, 36864
  s_lshl_b32 s54, s54, 5
  s_add_u32 s55, s55, s54
  buffer_load_ushort v48, v44, s[60:63], s55 offen offset:0
  buffer_load_ushort v49, v44, s[60:63], s55 offen offset:1152
  buffer_load_ushort v50, v44, s[60:63], s55 offen offset:2304
  buffer_load_ushort v51, v44, s[60:63], s55 offen offset:3456
  buffer_load_ushort v52, v45, s[60:63], s55 offen offset:0
  buffer_load_ushort v53, v45, s[60:63], s55 offen offset:1152
  buffer_load_ushort v54, v45, s[60:63], s55 offen offset:2304
  buffer_load_ushort v55, v45, s[60:63], s55 offen offset:3456
  s_lshl_b32 s50, s53, 10
  s_add_u32 s50, s50, 11796480
xfb_6:
  s_mul_i32 s48, s68, 8
  s_waitcnt vmcnt(9)
  v_lshlrev_b32 v16, 16, v8
  v_and_b32 v17, 0xffff0000, v8
  v_lshlrev_b32 v18, 16, v9
  v_and_b32 v19, 0xffff0000, v9
  s_waitcnt vmcnt(8)
  v_lshlrev_b32 v20, 16, v10
  v_and_b32 v21, 0xffff0000, v10
  v_lshlrev_b32 v22, 16, v11
  v_and_b32 v23, 0xffff0000, v11
  v_mul_u32_u24 v26, 48, v5
  v_lshl_add_u32 v27, v1, 2, v26
  v_add_f32 v24, v16, v17
  v_add_f32 v24, v24, v18
  v_add_f32 v24, v24, v19
  v_add_f32 v24, v24, v20
  v_add_f32 v24, v24, v21
  v_add_f32 v24, v24, v22
  v_add_f32 v24, v24, v23
  s_nop 1
  v_add_f32_dpp v24, v24, v24 row_ror:8 row_mask:0xf bank_mask:0xf
  v_mov_b32 v25, v24
  s_nop 1
  v_permlane16_swap_b32 v24, v25
  v_add_f32 v24, v24, v25
  v_mov_b32 v25, v24
  s_nop 1
  v_permlane32_swap_b32 v24, v25
  v_add_f32 v24, v24, v25
  s_mov_b64 exec, 0xff
  ds_write_b32 v27, v24 offset:0
  s_mov_b64 exec, -1
  s_waitcnt lgkmcnt(0)
  s_barrier
  ds_read_b128 v[32:35], v26 offset:0
  ds_read_b128 v[36:39], v26 offset:16
  ds_read_b32 v40, v26 offset:32
  s_waitcnt lgkmcnt(2)
  v_add_f32 v28, v32, v33
  v_add_f32 v28, v28, v34
  v_add_f32 v28, v28, v35
  s_waitcnt lgkmcnt(1)
  v_add_f32 v28, v28, v36
  v_add_f32 v28, v28, v37
  v_add_f32 v28, v28, v38
  v_add_f32 v28, v28, v39
  s_waitcnt lgkmcnt(0)
  v_add_f32 v28, v28, v40
  v_mul_f32 v28, 0x3ae38e39, v28
  v_sub_f32 v25, v16, v28
  v_mul_f32 v24, v25, v25
  v_sub_f32 v25, v17, v28
  v_fmac_f32 v24, v25, v25
  v_sub_f32 v25, v18, v28
  v_fmac_f32 v24, v25, v25
  v_sub_f32 v25, v19, v28
  v_fmac_f32 v24, v25, v25
  v_sub_f32 v25, v20, v28
  v_fmac_f32 v24, v25, v25
  v_sub_f32 v25, v21, v28
  v_fmac_f32 v24, v25, v25
  v_sub_f32 v25, v22, v28
  v_fmac_f32 v24, v25, v25
  v_sub_f32 v25, v23, v28
  v_fmac_f32 v24, v25, v25
  s_nop 1
  v_add_f32_dpp v24, v24, v24 row_ror:8 row_mask:0xf bank_mask:0xf
  v_mov_b32 v25, v24
  s_nop 1
  v_permlane16_swap_b32 v24, v25
  v_add_f32 v24, v24, v25
  v_mov_b32 v25, v24
  s_nop 1
  v_permlane32_swap_b32 v24, v25
  v_add_f32 v24, v24, v25
  s_mov_b64 exec, 0xff
  ds_write_b32 v27, v24 offset:512
  s_mov_b64 exec, -1
  s_waitcnt lgkmcnt(0)
  s_barrier
  ds_read_b128 v[32:35], v26 offset:512
  ds_read_b128 v[36:39], v26 offset:528
  ds_read_b32 v40, v26 offset:544
  s_waitcnt lgkmcnt(2)
  v_add_f32 v29, v32, v33
  v_add_f32 v29, v29, v34
  v_add_f32 v29, v29, v35
  s_waitcnt lgkmcnt(1)
  v_add_f32 v29, v29, v36
  v_add_f32 v29, v29, v37
  v_add_f32 v29, v29, v38
  v_add_f32 v29, v29, v39
  s_waitcnt lgkmcnt(0)
  v_add_f32 v29, v29, v40
  v_mul_f32 v29, 0x3ae38e39, v29
  v_cvt_pk_bf16_f32 v28, 0, v28
  v_cvt_pk_bf16_f32 v29, 0, v29
  v_add_f32 v29, 0x3727c5ac, v29
  v_cvt_pk_bf16_f32 v29, 0, v29
  v_sqrt_f32 v29, v29
  s_nop 0
  v_cvt_pk_bf16_f32 v29, 0, v29
  v_rcp_f32 v29, v29
  v_sub_f32 v16, v16, v28
  v_sub_f32 v17, v17, v28
  v_cvt_pk_bf16_f32 v24, v16, v17
  v_lshlrev_b32 v16, 16, v24
  v_and_b32 v17, 0xffff0000, v24
  v_mul_f32 v16, v16, v29
  v_mul_f32 v17, v17, v29
  v_cvt_pk_bf16_f32 v12, v16, v17
  v_sub_f32 v18, v18, v28
  v_sub_f32 v19, v19, v28
  v_cvt_pk_bf16_f32 v24, v18, v19
  v_lshlrev_b32 v18, 16, v24
  v_and_b32 v19, 0xffff0000, v24
  v_mul_f32 v18, v18, v29
  v_mul_f32 v19, v19, v29
  v_cvt_pk_bf16_f32 v13, v18, v19
  v_sub_f32 v20, v20, v28
  v_sub_f32 v21, v21, v28
  v_cvt_pk_bf16_f32 v24, v20, v21
  v_lshlrev_b32 v20, 16, v24
  v_and_b32 v21, 0xffff0000, v24
  v_mul_f32 v20, v20, v29
  v_mul_f32 v21, v21, v29
  v_cvt_pk_bf16_f32 v14, v20, v21
  v_sub_f32 v22, v22, v28
  v_sub_f32 v23, v23, v28
  v_cvt_pk_bf16_f32 v24, v22, v23
  v_lshlrev_b32 v22, 16, v24
  v_and_b32 v23, 0xffff0000, v24
  v_mul_f32 v22, v22, v29
  v_mul_f32 v23, v23, v29
  v_cvt_pk_bf16_f32 v15, v22, v23
  buffer_store_dwordx4 v[12:15], v6, s[12:15], 0 offen sc1
  s_waitcnt vmcnt(1)
  v_lshlrev_b32 v44, 4, v2
  v_lshl_or_b32 v48, v49, 16, v48
  v_lshl_or_b32 v49, v51, 16, v50
  v_lshl_or_b32 v50, v53, 16, v52
  v_lshl_or_b32 v51, v55, 16, v54
  buffer_store_dwordx4 v[48:51], v44, s[64:67], s50 offen sc1
  s_cmp_ge_u32 s48, 360
  s_cbranch_scc1 xfd_8
  v_lshl_or_b32 v56, v57, 16, v56
  v_lshl_or_b32 v57, v59, 16, v58
  v_lshl_or_b32 v58, v61, 16, v60
  v_lshl_or_b32 v59, v63, 16, v62
  buffer_store_dwordx4 v[56:59], v44, s[64:67], s51 offen sc1
xfd_8:
  s_add_u32 s80, s4, 52273152
  s_addc_u32 s81, s5, 0
  s_mov_b32 s82, 5177344
  s_mov_b32 s83, 0x20000
  v_mov_b32 v72, -1
  v_mov_b32 v73, -1
  v_mov_b32 v74, -1
  v_mov_b32 v75, -1
  v_lshlrev_b32 v76, 4, v0
  s_mul_i32 s84, s2, 9216
  buffer_store_dwordx4 v[72:75], v76, s[80:83], s84 offen sc1
  s_mul_i32 s84, s2, 384
  s_add_u32 s84, s84, 2359296
  s_lshl_b32 s85, s2, 8
  s_sub_u32 s85, 98304, s85
  v_mov_b32 v77, s85
  v_cmp_gt_u32 vcc, 24, v0
  s_nop 1
  v_cndmask_b32 v78, v77, v76, vcc
  v_lshlrev_b32 v77, 7, v0
  v_add_u32 v77, 127872, v77
  v_cmp_gt_u32 vcc, 25, v0
  s_nop 1
  v_cndmask_b32 v78, v77, v78, vcc
  v_bfrev_b32 v77, 1
  v_cmp_gt_u32 vcc, 28, v0
  s_nop 1
  v_cndmask_b32 v78, v77, v78, vcc
  buffer_store_dwordx4 v[72:75], v78, s[80:83], s84 offen sc1
  s_add_u32 s84, s84, 2588672
  buffer_store_dwordx4 v[72:75], v78, s[80:83], s84 offen sc1
fin_2:
end_1:
  s_endpgm
.globl k3d_kernel
.p2align 8
.type k3d_kernel,@function
k3d_kernel:
  s_mov_b32 s86, 0
  s_mov_b32 s3, 2588672
  s_branch body_9
.globl k3_kernel
.p2align 8
.type k3_kernel,@function
k3_kernel:
  s_mov_b32 s86, 1
  s_mov_b32 s3, 0
body_9:
  s_cmp_ge_u32 s2, 256
  s_cbranch_scc1 end_10
  s_load_dwordx2 s[4:5], s[0:1], 72
  s_load_dwordx4 s[40:43], s[0:1], 32
  s_load_dwordx2 s[44:45], s[0:1], 48
  s_load_dwordx2 s[56:57], s[0:1], 0
  s_load_dwordx2 s[58:59], s[0:1], 56
  v_lshrrev_b32 v1, 6, v0
  v_and_b32 v2, 63, v0
  v_readfirstlane_b32 s24, v1
  s_and_b32 s25, s2, 7
  s_lshr_b32 s26, s2, 3
  s_lshr_b32 s27, s25, 1
  s_lshl_b32 s27, s27, 2
  s_and_b32 s28, s26, 3
  s_add_u32 s27, s27, s28
  s_and_b32 s28, s25, 1
  s_lshl_b32 s28, s28, 3
  s_lshr_b32 s29, s26, 2
  s_add_u32 s28, s28, s29
  v_lshlrev_b32 v3, 4, v2
  s_lshl_b32 s30, s24, 10
  s_lshl_b32 s31, s27, 3
  s_lshl_b32 s32, s24, 1
  s_add_u32 s32, s32, s31
  s_mov_b32 s46, s32
  s_mul_i32 s32, s32, 18432
  s_add_u32 s32, s32, 2359296
  s_add_u32 s32, s32, s3
  s_add_u32 s33, s32, 18432
  s_max_u32 s31, s31, 1
  s_sub_u32 s31, s31, 1
  s_mul_i32 s31, s31, 18432
  s_add_u32 s31, s31, 2359296
  s_add_u32 s31, s31, s3
  s_mul_i32 s35, s28, 129024
  s_add_u32 s35, s35, s30
  s_add_u32 s35, s35, 50208768
  s_add_u32 s34, s35, 4096
  s_cmp_eq_u32 s24, 3
  s_cselect_b32 s34, s31, s34
  s_cselect_b32 s29, 1, 7
  s_lshl_b32 s29, s29, 10
  s_waitcnt lgkmcnt(0)
  s_mov_b32 s8, s4
  s_mov_b32 s9, s5
  s_mov_b32 s10, 57450496
  s_mov_b32 s11, 0x20000
  s_add_u32 s16, s4, 52273152
  s_addc_u32 s17, s5, 0
  s_mov_b32 s18, 2588672
  s_mov_b32 s19, 0x20000
  s_add_u32 s16, s16, s3
  s_addc_u32 s17, s17, 0
  s_add_u32 m0, s30, 0
  s_nop 0
  buffer_load_dwordx4 v3, s[8:11], s35 offen lds
  s_add_u32 m0, s30, 4096
  s_nop 0
  buffer_load_dwordx4 v3, s[8:11], s34 offen lds
  buffer_load_dwordx4 v[152:155], v3, s[8:11], s32 offen offset:0
  buffer_load_dwordx4 v[156:159], v3, s[8:11], s33 offen offset:0
  s_add_u32 m0, s30, 8192
  s_add_u32 s35, s35, 7168
  buffer_load_dwordx4 v3, s[8:11], s35 offen lds
  s_add_u32 m0, s30, 12288
  s_add_u32 s34, s34, s29
  buffer_load_dwordx4 v3, s[8:11], s34 offen lds
  buffer_load_dwordx4 v[160:163], v3, s[8:11], s32 offen offset:1024
  buffer_load_dwordx4 v[164:167], v3, s[8:11], s33 offen offset:1024
  s_add_u32 m0, s30, 16384
  s_add_u32 s35, s35, 7168
  buffer_load_dwordx4 v3, s[8:11], s35 offen lds
  s_add_u32 m0, s30, 20480
  s_add_u32 s34, s34, s29
  buffer_load_dwordx4 v3, s[8:11], s34 offen lds
  buffer_load_dwordx4 v[168:171], v3, s[8:11], s32 offen offset:2048
  buffer_load_dwordx4 v[172:175], v3, s[8:11], s33 offen offset:2048
  s_add_u32 m0, s30, 24576
  s_add_u32 s35, s35, 7168
  buffer_load_dwordx4 v3, s[8:11], s35 offen lds
  s_add_u32 m0, s30, 28672
  s_add_u32 s34, s34, s29
  buffer_load_dwordx4 v3, s[8:11], s34 offen lds
  buffer_load_dwordx4 v[176:179], v3, s[8:11], s32 offen offset:3072
  s_add_u32 s32, s32, 4096
  buffer_load_dwordx4 v[180:183], v3, s[8:11], s33 offen offset:3072
  s_add_u32 s33, s33, 4096
  s_add_u32 m0, s30, 32768
  s_add_u32 s35, s35, 7168
  buffer_load_dwordx4 v3, s[8:11], s35 offen lds
  s_add_u32 m0, s30, 36864
  s_add_u32 s34, s34, s29
  buffer_load_dwordx4 v3, s[8:11], s34 offen lds
  buffer_load_dwordx4 v[184:187], v3, s[8:11], s32 offen offset:0
  buffer_load_dwordx4 v[188:191], v3, s[8:11], s33 offen offset:0
  v_add_u32 v4, 0x10000, v3
  v_add_u32 v5, 0x20000, v3
  s_add_u32 s31, s30, 2048
  v_add_u32 v6, s31, v3
  v_add_u32 v7, s31, v4
  v_add_u32 v8, s31, v5
  s_waitcnt vmcnt(18)
  s_barrier
  ds_read_b128 v[80:83], v3 offset:0
  ds_read_b128 v[84:87], v3 offset:1024
  ds_read_b128 v[88:91], v3 offset:2048
  ds_read_b128 v[92:95], v3 offset:3072
  ds_read_b128 v[96:99], v3 offset:4096
  ds_read_b128 v[100:103], v3 offset:5120
  ds_read_b128 v[104:107], v3 offset:6144
  ds_read_b128 v[108:111], v3 offset:7168
  ds_read_b128 v[112:115], v6 offset:0
  s_waitcnt vmcnt(17) lgkmcnt(8)
  v_mfma_f32_16x16x32_bf16 v[16:19], v[80:83], v[152:155], 0
  s_waitcnt vmcnt(10)
  s_barrier
  ds_read_b128 v[116:119], v3 offset:8192
  v_mfma_f32_16x16x32_bf16 v[20:23], v[80:83], v[156:159], 0
  s_add_u32 m0, s30, 40960
  s_add_u32 s35, s35, 7168
  buffer_load_dwordx4 v3, s[8:11], s35 offen lds
  s_waitcnt lgkmcnt(8)
  v_mfma_f32_16x16x32_bf16 v[24:27], v[84:87], v[152:155], 0
  ds_read_b128 v[120:123], v3 offset:9216
  v_mfma_f32_16x16x32_bf16 v[28:31], v[84:87], v[156:159], 0
  s_mov_b32 s47, 40960
  v_and_b32 v250, 15, v2
  s_waitcnt lgkmcnt(8)
  v_mfma_f32_16x16x32_bf16 v[32:35], v[88:91], v[152:155], 0
  ds_read_b128 v[124:127], v3 offset:10240
  v_mfma_f32_16x16x32_bf16 v[36:39], v[88:91], v[156:159], 0
  s_add_u32 m0, s30, 45056
  s_add_u32 s34, s34, s29
  buffer_load_dwordx4 v3, s[8:11], s34 offen lds
  s_waitcnt lgkmcnt(8)
  v_mfma_f32_16x16x32_bf16 v[40:43], v[92:95], v[152:155], 0
  ds_read_b128 v[128:131], v3 offset:11264
  v_mfma_f32_16x16x32_bf16 v[44:47], v[92:95], v[156:159], 0
  v_lshrrev_b32 v251, 4, v2
  v_mul_u32_u24 v9, 240, v250
  s_waitcnt lgkmcnt(8)
  v_mfma_f32_16x16x32_bf16 v[48:51], v[96:99], v[152:155], 0
  ds_read_b128 v[132:135], v3 offset:12288
  v_mfma_f32_16x16x32_bf16 v[52:55], v[96:99], v[156:159], 0
  buffer_load_dwordx4 v[192:195], v3, s[8:11], s32 offen offset:1024
  s_waitcnt lgkmcnt(8)
  v_mfma_f32_16x16x32_bf16 v[56:59], v[100:103], v[152:155], 0
  ds_read_b128 v[136:139], v3 offset:13312
  v_mfma_f32_16x16x32_bf16 v[60:63], v[100:103], v[156:159], 0
  v_lshl_add_u32 v9, v251, 3, v9
  s_mul_i32 s31, s24, 7680
  s_waitcnt lgkmcnt(8)
  v_mfma_f32_16x16x32_bf16 v[64:67], v[104:107], v[152:155], 0
  ds_read_b128 v[140:143], v3 offset:14336
  v_mfma_f32_16x16x32_bf16 v[68:71], v[104:107], v[156:159], 0
  buffer_load_dwordx4 v[196:199], v3, s[8:11], s33 offen offset:1024
  s_waitcnt lgkmcnt(8)
  v_mfma_f32_16x16x32_bf16 v[76:79], v[104:107], v[108:111], 0
  ds_read_b128 v[144:147], v3 offset:15360
  s_waitcnt lgkmcnt(8)
  v_mfma_f32_16x16x32_bf16 v[72:75], v[112:115], v[108:111], 0
  ds_read_b128 v[148:151], v6 offset:8192
  s_waitcnt lgkmcnt(8)
  v_mfma_f32_16x16x32_bf16 v[16:19], v[116:119], v[160:163], v[16:19]
  ds_read_b128 v[80:83], v3 offset:16384
  v_mfma_f32_16x16x32_bf16 v[20:23], v[116:119], v[164:167], v[20:23]
  s_add_u32 m0, s30, 49152
  s_add_u32 s35, s35, 7168
  buffer_load_dwordx4 v3, s[8:11], s35 offen lds
  s_waitcnt lgkmcnt(8)
  v_mfma_f32_16x16x32_bf16 v[24:27], v[120:123], v[160:163], v[24:27]
  ds_read_b128 v[84:87], v3 offset:17408
  v_mfma_f32_16x16x32_bf16 v[28:31], v[120:123], v[164:167], v[28:31]
  s_add_u32 s31, s31, 3840
  v_add_u32 v10, s31, v9
  s_waitcnt lgkmcnt(8)
  v_mfma_f32_16x16x32_bf16 v[32:35], v[124:127], v[160:163], v[32:35]
  ds_read_b128 v[88:91], v3 offset:18432
  v_mfma_f32_16x16x32_bf16 v[36:39], v[124:127], v[164:167], v[36:39]
  s_add_u32 m0, s30, 53248
  s_add_u32 s34, s34, s29
  buffer_load_dwordx4 v3, s[8:11], s34 offen lds
  s_waitcnt lgkmcnt(8)
  v_mfma_f32_16x16x32_bf16 v[40:43], v[128:131], v[160:163], v[40:43]
  ds_read_b128 v[92:95], v3 offset:19456
  v_mfma_f32_16x16x32_bf16 v[44:47], v[128:131], v[164:167], v[44:47]
  s_lshl_b32 s31, s24, 5
  v_add_u32 v11, s31, v9
  s_waitcnt lgkmcnt(8)
  v_mfma_f32_16x16x32_bf16 v[48:51], v[132:135], v[160:163], v[48:51]
  ds_read_b128 v[96:99], v3 offset:20480
  v_mfma_f32_16x16x32_bf16 v[52:55], v[132:135], v[164:167], v[52:55]
  buffer_load_dwordx4 v[152:155], v3, s[8:11], s32 offen offset:2048
  s_waitcnt lgkmcnt(8)
  v_mfma_f32_16x16x32_bf16 v[56:59], v[136:139], v[160:163], v[56:59]
  ds_read_b128 v[100:103], v3 offset:21504
  v_mfma_f32_16x16x32_bf16 v[60:63], v[136:139], v[164:167], v[60:63]
  v_and_b32 v249, 31, v2
  v_add_u32 v249, s31, v249
  s_waitcnt lgkmcnt(8)
  v_mfma_f32_16x16x32_bf16 v[64:67], v[140:143], v[160:163], v[64:67]
  ds_read_b128 v[104:107], v3 offset:22528
  v_mfma_f32_16x16x32_bf16 v[68:71], v[140:143], v[164:167], v[68:71]
  buffer_load_dwordx4 v[156:159], v3, s[8:11], s33 offen offset:2048
  s_waitcnt lgkmcnt(8)
  v_mfma_f32_16x16x32_bf16 v[76:79], v[140:143], v[144:147], v[76:79]
  ds_read_b128 v[108:111], v3 offset:23552
  s_waitcnt lgkmcnt(8)
  v_mfma_f32_16x16x32_bf16 v[72:75], v[148:151], v[144:147], v[72:75]
  ds_read_b128 v[112:115], v6 offset:16384
  s_waitcnt vmcnt(17) lgkmcnt(8)
  v_mfma_f32_16x16x32_bf16 v[16:19], v[80:83], v[168:171], v[16:19]
  s_waitcnt vmcnt(10)
  s_barrier
  ds_read_b128 v[116:119], v3 offset:24576
  v_mfma_f32_16x16x32_bf16 v[20:23], v[80:83], v[172:175], v[20:23]
  s_add_u32 m0, s30, 57344
  s_add_u32 s35, s35, 7168
  buffer_load_dwordx4 v3, s[8:11], s35 offen lds
  s_waitcnt lgkmcnt(8)
  v_mfma_f32_16x16x32_bf16 v[24:27], v[84:87], v[168:171], v[24:27]
  ds_read_b128 v[120:123], v3 offset:25600
  v_mfma_f32_16x16x32_bf16 v[28:31], v[84:87], v[172:175], v[28:31]
  v_lshrrev_b32 v15, 5, v2
  v_mul_u32_u24 v14, 240, v249
  s_waitcnt lgkmcnt(8)
  v_mfma_f32_16x16x32_bf16 v[32:35], v[88:91], v[168:171], v[32:35]
  ds_read_b128 v[124:127], v3 offset:26624
  v_mfma_f32_16x16x32_bf16 v[36:39], v[88:91], v[172:175], v[36:39]
  s_add_u32 m0, s30, 61440
  s_add_u32 s34, s34, s29
  buffer_load_dwordx4 v3, s[8:11], s34 offen lds
  s_waitcnt lgkmcnt(8)
  v_mfma_f32_16x16x32_bf16 v[40:43], v[92:95], v[168:171], v[40:43]
  ds_read_b128 v[128:131], v3 offset:27648
  v_mfma_f32_16x16x32_bf16 v[44:47], v[92:95], v[172:175], v[44:47]
  v_lshl_add_u32 v12, v15, 5, v14
  v_add_u32 v12, 480, v12
  s_waitcnt lgkmcnt(8)
  v_mfma_f32_16x16x32_bf16 v[48:51], v[96:99], v[168:171], v[48:51]
  ds_read_b128 v[132:135], v3 offset:28672
  v_mfma_f32_16x16x32_bf16 v[52:55], v[96:99], v[172:175], v[52:55]
  buffer_load_dwordx4 v[160:163], v3, s[8:11], s32 offen offset:3072
  s_add_u32 s32, s32, 4096
  s_waitcnt lgkmcnt(8)
  v_mfma_f32_16x16x32_bf16 v[56:59], v[100:103], v[168:171], v[56:59]
  ds_read_b128 v[136:139], v3 offset:29696
  v_mfma_f32_16x16x32_bf16 v[60:63], v[100:103], v[172:175], v[60:63]
  v_lshl_add_u32 v13, v15, 3, v14
  v_add_u32 v13, 672, v13
  s_waitcnt lgkmcnt(8)
  v_mfma_f32_16x16x32_bf16 v[64:67], v[104:107], v[168:171], v[64:67]
  ds_read_b128 v[140:143], v3 offset:30720
  v_mfma_f32_16x16x32_bf16 v[68:71], v[104:107], v[172:175], v[68:71]
  buffer_load_dwordx4 v[164:167], v3, s[8:11], s33 offen offset:3072
  s_add_u32 s33, s33, 4096
  s_waitcnt lgkmcnt(8)
  v_mfma_f32_16x16x32_bf16 v[76:79], v[104:107], v[108:111], v[76:79]
  ds_read_b128 v[144:147], v3 offset:31744
  s_waitcnt lgkmcnt(8)
  v_mfma_f32_16x16x32_bf16 v[72:75], v[112:115], v[108:111], v[72:75]
  ds_read_b128 v[148:151], v6 offset:24576
  s_waitcnt lgkmcnt(8)
  v_mfma_f32_16x16x32_bf16 v[16:19], v[116:119], v[176:179], v[16:19]
  ds_read_b128 v[80:83], v3 offset:32768
  v_mfma_f32_16x16x32_bf16 v[20:23], v[116:119], v[180:183], v[20:23]
  s_add_u32 m0, s30, 65536
  s_add_u32 s35, s35, 7168
  buffer_load_dwordx4 v3, s[8:11], s35 offen lds
  s_waitcnt lgkmcnt(8)
  v_mfma_f32_16x16x32_bf16 v[24:27], v[120:123], v[176:179], v[24:27]
  ds_read_b128 v[84:87], v3 offset:33792
  v_mfma_f32_16x16x32_bf16 v[28:31], v[120:123], v[180:183], v[28:31]
  v_lshl_add_u32 v14, v15, 2, v14
  v_add_u32 v14, 4048, v14
  s_waitcnt lgkmcnt(8)
  v_mfma_f32_16x16x32_bf16 v[32:35], v[124:127], v[176:179], v[32:35]
  ds_read_b128 v[88:91], v3 offset:34816
  v_mfma_f32_16x16x32_bf16 v[36:39], v[124:127], v[180:183], v[36:39]
  s_add_u32 m0, s30, 69632
  s_add_u32 s34, s34, s29
  buffer_load_dwordx4 v3, s[8:11], s34 offen lds
  s_waitcnt lgkmcnt(8)
  v_mfma_f32_16x16x32_bf16 v[40:43], v[128:131], v[176:179], v[40:43]
  ds_read_b128 v[92:95], v3 offset:35840
  v_mfma_f32_16x16x32_bf16 v[44:47], v[128:131], v[180:183], v[44:47]
  v_mul_u32_u24 v15, 36, v15
  v_mul_u32_u24 v252, 72, v249
  s_waitcnt lgkmcnt(8)
  v_mfma_f32_16x16x32_bf16 v[48:51], v[132:135], v[176:179], v[48:51]
  ds_read_b128 v[96:99], v3 offset:36864
  v_mfma_f32_16x16x32_bf16 v[52:55], v[132:135], v[180:183], v[52:55]
  buffer_load_dwordx4 v[168:171], v3, s[8:11], s32 offen offset:0
  s_waitcnt lgkmcnt(8)
  v_mfma_f32_16x16x32_bf16 v[56:59], v[136:139], v[176:179], v[56:59]
  ds_read_b128 v[100:103], v3 offset:37888
  v_mfma_f32_16x16x32_bf16 v[60:63], v[136:139], v[180:183], v[60:63]
  v_add3_u32 v15, v15, v252, s47
  s_lshl_b32 s31, s27, 7
  s_waitcnt lgkmcnt(8)
  v_mfma_f32_16x16x32_bf16 v[64:67], v[140:143], v[176:179], v[64:67]
  ds_read_b128 v[104:107], v3 offset:38912
  v_mfma_f32_16x16x32_bf16 v[68:71], v[140:143], v[180:183], v[68:71]
  buffer_load_dwordx4 v[172:175], v3, s[8:11], s33 offen offset:0
  s_waitcnt lgkmcnt(8)
  v_mfma_f32_16x16x32_bf16 v[76:79], v[140:143], v[144:147], v[76:79]
  ds_read_b128 v[108:111], v3 offset:39936
  s_waitcnt lgkmcnt(8)
  v_mfma_f32_16x16x32_bf16 v[72:75], v[148:151], v[144:147], v[72:75]
  ds_read_b128 v[112:115], v6 offset:32768
  s_waitcnt vmcnt(17) lgkmcnt(8)
  v_mfma_f32_16x16x32_bf16 v[16:19], v[80:83], v[184:187], v[16:19]
  s_waitcnt vmcnt(10)
  s_barrier
  ds_read_b128 v[116:119], v3 offset:40960
  v_mfma_f32_16x16x32_bf16 v[20:23], v[80:83], v[188:191], v[20:23]
  s_add_u32 m0, s30, 73728
  s_add_u32 s35, s35, 7168
  buffer_load_dwordx4 v3, s[8:11], s35 offen lds
  s_waitcnt lgkmcnt(8)
  v_mfma_f32_16x16x32_bf16 v[24:27], v[84:87], v[184:187], v[24:27]
  ds_read_b128 v[120:123], v3 offset:41984
  v_mfma_f32_16x16x32_bf16 v[28:31], v[84:87], v[188:191], v[28:31]
  v_add_u32 v249, s31, v249
  s_cmp_eq_u32 s27, 0
  s_cselect_b32 s36, 1, 0
  s_waitcnt lgkmcnt(8)
  v_mfma_f32_16x16x32_bf16 v[32:35], v[88:91], v[184:187], v[32:35]
  ds_read_b128 v[124:127], v3 offset:43008
  v_mfma_f32_16x16x32_bf16 v[36:39], v[88:91], v[188:191], v[36:39]
  s_add_u32 m0, s30, 77824
  s_add_u32 s34, s34, s29
  buffer_load_dwordx4 v3, s[8:11], s34 offen lds
  s_waitcnt lgkmcnt(8)
  v_mfma_f32_16x16x32_bf16 v[40:43], v[92:95], v[184:187], v[40:43]
  ds_read_b128 v[128:131], v3 offset:44032
  v_mfma_f32_16x16x32_bf16 v[44:47], v[92:95], v[188:191], v[44:47]
  s_waitcnt lgkmcnt(8)
  v_mfma_f32_16x16x32_bf16 v[48:51], v[96:99], v[184:187], v[48:51]
  ds_read_b128 v[132:135], v3 offset:45056
  v_mfma_f32_16x16x32_bf16 v[52:55], v[96:99], v[188:191], v[52:55]
  buffer_load_dwordx4 v[176:179], v3, s[8:11], s32 offen offset:1024
  s_waitcnt lgkmcnt(8)
  v_mfma_f32_16x16x32_bf16 v[56:59], v[100:103], v[184:187], v[56:59]
  ds_read_b128 v[136:139], v3 offset:46080
  v_mfma_f32_16x16x32_bf16 v[60:63], v[100:103], v[188:191], v[60:63]
  s_waitcnt lgkmcnt(8)
  v_mfma_f32_16x16x32_bf16 v[64:67], v[104:107], v[184:187], v[64:67]
  ds_read_b128 v[140:143], v3 offset:47104
  v_mfma_f32_16x16x32_bf16 v[68:71], v[104:107], v[188:191], v[68:71]
  buffer_load_dwordx4 v[180:183], v3, s[8:11], s33 offen offset:1024
  s_waitcnt lgkmcnt(8)
  v_mfma_f32_16x16x32_bf16 v[76:79], v[104:107], v[108:111], v[76:79]
  ds_read_b128 v[144:147], v3 offset:48128
  s_waitcnt lgkmcnt(8)
  v_mfma_f32_16x16x32_bf16 v[72:75], v[112:115], v[108:111], v[72:75]
  ds_read_b128 v[148:151], v6 offset:40960
  s_waitcnt lgkmcnt(8)
  v_mfma_f32_16x16x32_bf16 v[16:19], v[116:119], v[192:195], v[16:19]
  ds_read_b128 v[80:83], v3 offset:49152
  v_mfma_f32_16x16x32_bf16 v[20:23], v[116:119], v[196:199], v[20:23]
  s_add_u32 m0, s30, 81920
  s_add_u32 s35, s35, 7168
  buffer_load_dwordx4 v3, s[8:11], s35 offen lds
  s_waitcnt lgkmcnt(8)
  v_mfma_f32_16x16x32_bf16 v[24:27], v[120:123], v[192:195], v[24:27]
  ds_read_b128 v[84:87], v3 offset:50176
  v_mfma_f32_16x16x32_bf16 v[28:31], v[120:123], v[196:199], v[28:31]
  s_waitcnt lgkmcnt(8)
  v_mfma_f32_16x16x32_bf16 v[32:35], v[124:127], v[192:195], v[32:35]
  ds_read_b128 v[88:91], v3 offset:51200
  v_mfma_f32_16x16x32_bf16 v[36:39], v[124:127], v[196:199], v[36:39]
  s_add_u32 m0, s30, 86016
  s_add_u32 s34, s34, s29
  buffer_load_dwordx4 v3, s[8:11], s34 offen lds
  s_waitcnt lgkmcnt(8)
  v_mfma_f32_16x16x32_bf16 v[40:43], v[128:131], v[192:195], v[40:43]
  ds_read_b128 v[92:95], v3 offset:52224
  v_mfma_f32_16x16x32_bf16 v[44:47], v[128:131], v[196:199], v[44:47]
  s_waitcnt lgkmcnt(8)
  v_mfma_f32_16x16x32_bf16 v[48:51], v[132:135], v[192:195], v[48:51]
  ds_read_b128 v[96:99], v3 offset:53248
  v_mfma_f32_16x16x32_bf16 v[52:55], v[132:135], v[196:199], v[52:55]
  buffer_load_dwordx4 v[184:187], v3, s[8:11], s32 offen offset:2048
  s_waitcnt lgkmcnt(8)
  v_mfma_f32_16x16x32_bf16 v[56:59], v[136:139], v[192:195], v[56:59]
  ds_read_b128 v[100:103], v3 offset:54272
  v_mfma_f32_16x16x32_bf16 v[60:63], v[136:139], v[196:199], v[60:63]
  s_waitcnt lgkmcnt(8)
  v_mfma_f32_16x16x32_bf16 v[64:67], v[140:143], v[192:195], v[64:67]
  ds_read_b128 v[104:107], v3 offset:55296
  v_mfma_f32_16x16x32_bf16 v[68:71], v[140:143], v[196:199], v[68:71]
  buffer_load_dwordx4 v[188:191], v3, s[8:11], s33 offen offset:2048
  s_waitcnt lgkmcnt(8)
  v_mfma_f32_16x16x32_bf16 v[76:79], v[140:143], v[144:147], v[76:79]
  ds_read_b128 v[108:111], v3 offset:56320
  s_waitcnt lgkmcnt(8)
  v_mfma_f32_16x16x32_bf16 v[72:75], v[148:151], v[144:147], v[72:75]
  ds_read_b128 v[112:115], v6 offset:49152
  s_waitcnt vmcnt(17) lgkmcnt(8)
  v_mfma_f32_16x16x32_bf16 v[16:19], v[80:83], v[152:155], v[16:19]
  s_waitcnt vmcnt(10)
  s_barrier
  ds_read_b128 v[116:119], v3 offset:57344
  v_mfma_f32_16x16x32_bf16 v[20:23], v[80:83], v[156:159], v[20:23]
  s_add_u32 m0, s30, 90112
  s_add_u32 s35, s35, 7168
  buffer_load_dwordx4 v3, s[8:11], s35 offen lds
  s_waitcnt lgkmcnt(8)
  v_mfma_f32_16x16x32_bf16 v[24:27], v[84:87], v[152:155], v[24:27]
  ds_read_b128 v[120:123], v3 offset:58368
  v_mfma_f32_16x16x32_bf16 v[28:31], v[84:87], v[156:159], v[28:31]
  s_waitcnt lgkmcnt(8)
  v_mfma_f32_16x16x32_bf16 v[32:35], v[88:91], v[152:155], v[32:35]
  ds_read_b128 v[124:127], v3 offset:59392
  v_mfma_f32_16x16x32_bf16 v[36:39], v[88:91], v[156:159], v[36:39]
  s_add_u32 m0, s30, 94208
  s_add_u32 s34, s34, s29
  buffer_load_dwordx4 v3, s[8:11], s34 offen lds
  s_waitcnt lgkmcnt(8)
  v_mfma_f32_16x16x32_bf16 v[40:43], v[92:95], v[152:155], v[40:43]
  ds_read_b128 v[128:131], v3 offset:60416
  v_mfma_f32_16x16x32_bf16 v[44:47], v[92:95], v[156:159], v[44:47]
  s_waitcnt lgkmcnt(8)
  v_mfma_f32_16x16x32_bf16 v[48:51], v[96:99], v[152:155], v[48:51]
  ds_read_b128 v[132:135], v3 offset:61440
  v_mfma_f32_16x16x32_bf16 v[52:55], v[96:99], v[156:159], v[52:55]
  buffer_load_dwordx4 v[192:195], v3, s[8:11], s32 offen offset:3072
  s_add_u32 s32, s32, 4096
  s_waitcnt lgkmcnt(8)
  v_mfma_f32_16x16x32_bf16 v[56:59], v[100:103], v[152:155], v[56:59]
  ds_read_b128 v[136:139], v3 offset:62464
  v_mfma_f32_16x16x32_bf16 v[60:63], v[100:103], v[156:159], v[60:63]
  s_waitcnt lgkmcnt(8)
  v_mfma_f32_16x16x32_bf16 v[64:67], v[104:107], v[152:155], v[64:67]
  ds_read_b128 v[140:143], v3 offset:63488
  v_mfma_f32_16x16x32_bf16 v[68:71], v[104:107], v[156:159], v[68:71]
  buffer_load_dwordx4 v[196:199], v3, s[8:11], s33 offen offset:3072
  s_add_u32 s33, s33, 4096
  s_waitcnt lgkmcnt(8)
  v_mfma_f32_16x16x32_bf16 v[76:79], v[104:107], v[108:111], v[76:79]
  ds_read_b128 v[144:147], v3 offset:64512
  s_waitcnt lgkmcnt(8)
  v_mfma_f32_16x16x32_bf16 v[72:75], v[112:115], v[108:111], v[72:75]
  ds_read_b128 v[148:151], v6 offset:57344
  s_waitcnt lgkmcnt(8)
  v_mfma_f32_16x16x32_bf16 v[16:19], v[116:119], v[160:163], v[16:19]
  ds_read_b128 v[80:83], v4 offset:0
  v_mfma_f32_16x16x32_bf16 v[20:23], v[116:119], v[164:167], v[20:23]
  s_add_u32 m0, s30, 98304
  s_add_u32 s35, s35, 7168
  buffer_load_dwordx4 v3, s[8:11], s35 offen lds
  s_waitcnt lgkmcnt(8)
  v_mfma_f32_16x16x32_bf16 v[24:27], v[120:123], v[160:163], v[24:27]
  ds_read_b128 v[84:87], v4 offset:1024
  v_mfma_f32_16x16x32_bf16 v[28:31], v[120:123], v[164:167], v[28:31]
  s_waitcnt lgkmcnt(8)
  v_mfma_f32_16x16x32_bf16 v[32:35], v[124:127], v[160:163], v[32:35]
  ds_read_b128 v[88:91], v4 offset:2048
  v_mfma_f32_16x16x32_bf16 v[36:39], v[124:127], v[164:167], v[36:39]
  s_add_u32 m0, s30, 102400
  s_add_u32 s34, s34, s29
  buffer_load_dwordx4 v3, s[8:11], s34 offen lds
  s_waitcnt lgkmcnt(8)
  v_mfma_f32_16x16x32_bf16 v[40:43], v[128:131], v[160:163], v[40:43]
  ds_read_b128 v[92:95], v4 offset:3072
  v_mfma_f32_16x16x32_bf16 v[44:47], v[128:131], v[164:167], v[44:47]
  s_waitcnt lgkmcnt(8)
  v_mfma_f32_16x16x32_bf16 v[48:51], v[132:135], v[160:163], v[48:51]
  ds_read_b128 v[96:99], v4 offset:4096
  v_mfma_f32_16x16x32_bf16 v[52:55], v[132:135], v[164:167], v[52:55]
  buffer_load_dwordx4 v[152:155], v3, s[8:11], s32 offen offset:0
  s_waitcnt lgkmcnt(8)
  v_mfma_f32_16x16x32_bf16 v[56:59], v[136:139], v[160:163], v[56:59]
  ds_read_b128 v[100:103], v4 offset:5120
  v_mfma_f32_16x16x32_bf16 v[60:63], v[136:139], v[164:167], v[60:63]
  s_waitcnt lgkmcnt(8)
  v_mfma_f32_16x16x32_bf16 v[64:67], v[140:143], v[160:163], v[64:67]
  ds_read_b128 v[104:107], v4 offset:6144
  v_mfma_f32_16x16x32_bf16 v[68:71], v[140:143], v[164:167], v[68:71]
  buffer_load_dwordx4 v[156:159], v3, s[8:11], s33 offen offset:0
  s_waitcnt lgkmcnt(8)
  v_mfma_f32_16x16x32_bf16 v[76:79], v[140:143], v[144:147], v[76:79]
  ds_read_b128 v[108:111], v4 offset:7168
  s_waitcnt lgkmcnt(8)
  v_mfma_f32_16x16x32_bf16 v[72:75], v[148:151], v[144:147], v[72:75]
  ds_read_b128 v[112:115], v7 offset:0
  s_waitcnt vmcnt(17) lgkmcnt(8)
  v_mfma_f32_16x16x32_bf16 v[16:19], v[80:83], v[168:171], v[16:19]
  s_waitcnt vmcnt(10)
  s_barrier
  ds_read_b128 v[116:119], v4 offset:8192
  v_mfma_f32_16x16x32_bf16 v[20:23], v[80:83], v[172:175], v[20:23]
  s_add_u32 m0, s30, 106496
  s_add_u32 s35, s35, 7168
  buffer_load_dwordx4 v3, s[8:11], s35 offen lds
  s_waitcnt lgkmcnt(8)
  v_mfma_f32_16x16x32_bf16 v[24:27], v[84:87], v[168:171], v[24:27]
  ds_read_b128 v[120:123], v4 offset:9216
  v_mfma_f32_16x16x32_bf16 v[28:31], v[84:87], v[172:175], v[28:31]
  s_waitcnt lgkmcnt(8)
  v_mfma_f32_16x16x32_bf16 v[32:35], v[88:91], v[168:171], v[32:35]
  ds_read_b128 v[124:127], v4 offset:10240
  v_mfma_f32_16x16x32_bf16 v[36:39], v[88:91], v[172:175], v[36:39]
  s_add_u32 m0, s30, 110592
  s_add_u32 s34, s34, s29
  buffer_load_dwordx4 v3, s[8:11], s34 offen lds
  s_waitcnt lgkmcnt(8)
  v_mfma_f32_16x16x32_bf16 v[40:43], v[92:95], v[168:171], v[40:43]
  ds_read_b128 v[128:131], v4 offset:11264
  v_mfma_f32_16x16x32_bf16 v[44:47], v[92:95], v[172:175], v[44:47]
  s_waitcnt lgkmcnt(8)
  v_mfma_f32_16x16x32_bf16 v[48:51], v[96:99], v[168:171], v[48:51]
  ds_read_b128 v[132:135], v4 offset:12288
  v_mfma_f32_16x16x32_bf16 v[52:55], v[96:99], v[172:175], v[52:55]
  buffer_load_dwordx4 v[160:163], v3, s[8:11], s32 offen offset:1024
  s_waitcnt lgkmcnt(8)
  v_mfma_f32_16x16x32_bf16 v[56:59], v[100:103], v[168:171], v[56:59]
  ds_read_b128 v[136:139], v4 offset:13312
  v_mfma_f32_16x16x32_bf16 v[60:63], v[100:103], v[172:175], v[60:63]
  s_waitcnt lgkmcnt(8)
  v_mfma_f32_16x16x32_bf16 v[64:67], v[104:107], v[168:171], v[64:67]
  ds_read_b128 v[140:143], v4 offset:14336
  v_mfma_f32_16x16x32_bf16 v[68:71], v[104:107], v[172:175], v[68:71]
  buffer_load_dwordx4 v[164:167], v3, s[8:11], s33 offen offset:1024
  s_waitcnt lgkmcnt(8)
  v_mfma_f32_16x16x32_bf16 v[76:79], v[104:107], v[108:111], v[76:79]
  ds_read_b128 v[144:147], v4 offset:15360
  s_waitcnt lgkmcnt(8)
  v_mfma_f32_16x16x32_bf16 v[72:75], v[112:115], v[108:111], v[72:75]
  ds_read_b128 v[148:151], v7 offset:8192
  s_waitcnt lgkmcnt(8)
  v_mfma_f32_16x16x32_bf16 v[16:19], v[116:119], v[176:179], v[16:19]
  ds_read_b128 v[80:83], v4 offset:16384
  v_mfma_f32_16x16x32_bf16 v[20:23], v[116:119], v[180:183], v[20:23]
  s_add_u32 m0, s30, 114688
  s_add_u32 s35, s35, 7168
  buffer_load_dwordx4 v3, s[8:11], s35 offen lds
  s_waitcnt lgkmcnt(8)
  v_mfma_f32_16x16x32_bf16 v[24:27], v[120:123], v[176:179], v[24:27]
  ds_read_b128 v[84:87], v4 offset:17408
  v_mfma_f32_16x16x32_bf16 v[28:31], v[120:123], v[180:183], v[28:31]
  s_waitcnt lgkmcnt(8)
  v_mfma_f32_16x16x32_bf16 v[32:35], v[124:127], v[176:179], v[32:35]
  ds_read_b128 v[88:91], v4 offset:18432
  v_mfma_f32_16x16x32_bf16 v[36:39], v[124:127], v[180:183], v[36:39]
  s_add_u32 m0, s30, 118784
  s_add_u32 s34, s34, s29
  buffer_load_dwordx4 v3, s[8:11], s34 offen lds
  s_waitcnt lgkmcnt(8)
  v_mfma_f32_16x16x32_bf16 v[40:43], v[128:131], v[176:179], v[40:43]
  ds_read_b128 v[92:95], v4 offset:19456
  v_mfma_f32_16x16x32_bf16 v[44:47], v[128:131], v[180:183], v[44:47]
  s_waitcnt lgkmcnt(8)
  v_mfma_f32_16x16x32_bf16 v[48:51], v[132:135], v[176:179], v[48:51]
  ds_read_b128 v[96:99], v4 offset:20480
  v_mfma_f32_16x16x32_bf16 v[52:55], v[132:135], v[180:183], v[52:55]
  buffer_load_dwordx4 v[168:171], v3, s[8:11], s32 offen offset:2048
  s_waitcnt lgkmcnt(8)
  v_mfma_f32_16x16x32_bf16 v[56:59], v[136:139], v[176:179], v[56:59]
  ds_read_b128 v[100:103], v4 offset:21504
  v_mfma_f32_16x16x32_bf16 v[60:63], v[136:139], v[180:183], v[60:63]
  s_waitcnt lgkmcnt(8)
  v_mfma_f32_16x16x32_bf16 v[64:67], v[140:143], v[176:179], v[64:67]
  ds_read_b128 v[104:107], v4 offset:22528
  v_mfma_f32_16x16x32_bf16 v[68:71], v[140:143], v[180:183], v[68:71]
  buffer_load_dwordx4 v[172:175], v3, s[8:11], s33 offen offset:2048
  s_waitcnt lgkmcnt(8)
  v_mfma_f32_16x16x32_bf16 v[76:79], v[140:143], v[144:147], v[76:79]
  ds_read_b128 v[108:111], v4 offset:23552
  s_waitcnt lgkmcnt(8)
  v_mfma_f32_16x16x32_bf16 v[72:75], v[148:151], v[144:147], v[72:75]
  ds_read_b128 v[112:115], v7 offset:16384
  s_waitcnt vmcnt(17) lgkmcnt(8)
  v_mfma_f32_16x16x32_bf16 v[16:19], v[80:83], v[184:187], v[16:19]
  s_waitcnt vmcnt(10)
  s_barrier
  ds_read_b128 v[116:119], v4 offset:24576
  v_mfma_f32_16x16x32_bf16 v[20:23], v[80:83], v[188:191], v[20:23]
  s_add_u32 m0, s30, 122880
  s_add_u32 s35, s35, 7168
  buffer_load_dwordx4 v3, s[8:11], s35 offen lds
  s_waitcnt lgkmcnt(8)
  v_mfma_f32_16x16x32_bf16 v[24:27], v[84:87], v[184:187], v[24:27]
  ds_read_b128 v[120:123], v4 offset:25600
  v_mfma_f32_16x16x32_bf16 v[28:31], v[84:87], v[188:191], v[28:31]
  s_waitcnt lgkmcnt(8)
  v_mfma_f32_16x16x32_bf16 v[32:35], v[88:91], v[184:187], v[32:35]
  ds_read_b128 v[124:127], v4 offset:26624
  v_mfma_f32_16x16x32_bf16 v[36:39], v[88:91], v[188:191], v[36:39]
  s_add_u32 m0, s30, 126976
  s_add_u32 s34, s34, s29
  buffer_load_dwordx4 v3, s[8:11], s34 offen lds
  s_waitcnt lgkmcnt(8)
  v_mfma_f32_16x16x32_bf16 v[40:43], v[92:95], v[184:187], v[40:43]
  ds_read_b128 v[128:131], v4 offset:27648
  v_mfma_f32_16x16x32_bf16 v[44:47], v[92:95], v[188:191], v[44:47]
  s_waitcnt lgkmcnt(8)
  v_mfma_f32_16x16x32_bf16 v[48:51], v[96:99], v[184:187], v[48:51]
  ds_read_b128 v[132:135], v4 offset:28672
  v_mfma_f32_16x16x32_bf16 v[52:55], v[96:99], v[188:191], v[52:55]
  buffer_load_dwordx4 v[176:179], v3, s[8:11], s32 offen offset:3072
  s_add_u32 s32, s32, 4096
  s_waitcnt lgkmcnt(8)
  v_mfma_f32_16x16x32_bf16 v[56:59], v[100:103], v[184:187], v[56:59]
  ds_read_b128 v[136:139], v4 offset:29696
  v_mfma_f32_16x16x32_bf16 v[60:63], v[100:103], v[188:191], v[60:63]
  s_waitcnt lgkmcnt(8)
  v_mfma_f32_16x16x32_bf16 v[64:67], v[104:107], v[184:187], v[64:67]
  ds_read_b128 v[140:143], v4 offset:30720
  v_mfma_f32_16x16x32_bf16 v[68:71], v[104:107], v[188:191], v[68:71]
  buffer_load_dwordx4 v[180:183], v3, s[8:11], s33 offen offset:3072
  s_add_u32 s33, s33, 4096
  s_waitcnt lgkmcnt(8)
  v_mfma_f32_16x16x32_bf16 v[76:79], v[104:107], v[108:111], v[76:79]
  ds_read_b128 v[144:147], v4 offset:31744
  s_waitcnt lgkmcnt(8)
  v_mfma_f32_16x16x32_bf16 v[72:75], v[112:115], v[108:111], v[72:75]
  ds_read_b128 v[148:151], v7 offset:24576
  s_waitcnt lgkmcnt(8)
  v_mfma_f32_16x16x32_bf16 v[16:19], v[116:119], v[192:195], v[16:19]
  ds_read_b128 v[80:83], v4 offset:32768
  v_mfma_f32_16x16x32_bf16 v[20:23], v[116:119], v[196:199], v[20:23]
  s_add_u32 m0, s30, 131072
  s_add_u32 s35, s35, 7168
  buffer_load_dwordx4 v3, s[8:11], s35 offen lds
  s_waitcnt lgkmcnt(8)
  v_mfma_f32_16x16x32_bf16 v[24:27], v[120:123], v[192:195], v[24:27]
  ds_read_b128 v[84:87], v4 offset:33792
  v_mfma_f32_16x16x32_bf16 v[28:31], v[120:123], v[196:199], v[28:31]
  s_waitcnt lgkmcnt(8)
  v_mfma_f32_16x16x32_bf16 v[32:35], v[124:127], v[192:195], v[32:35]
  ds_read_b128 v[88:91], v4 offset:34816
  v_mfma_f32_16x16x32_bf16 v[36:39], v[124:127], v[196:199], v[36:39]
  s_add_u32 m0, s30, 135168
  s_add_u32 s34, s34, s29
  buffer_load_dwordx4 v3, s[8:11], s34 offen lds
  s_waitcnt lgkmcnt(8)
  v_mfma_f32_16x16x32_bf16 v[40:43], v[128:131], v[192:195], v[40:43]
  ds_read_b128 v[92:95], v4 offset:35840
  v_mfma_f32_16x16x32_bf16 v[44:47], v[128:131], v[196:199], v[44:47]
  s_waitcnt lgkmcnt(8)
  v_mfma_f32_16x16x32_bf16 v[48:51], v[132:135], v[192:195], v[48:51]
  ds_read_b128 v[96:99], v4 offset:36864
  v_mfma_f32_16x16x32_bf16 v[52:55], v[132:135], v[196:199], v[52:55]
  buffer_load_dwordx4 v[184:187], v3, s[8:11], s32 offen offset:0
  s_waitcnt lgkmcnt(8)
  v_mfma_f32_16x16x32_bf16 v[56:59], v[136:139], v[192:195], v[56:59]
  ds_read_b128 v[100:103], v4 offset:37888
  v_mfma_f32_16x16x32_bf16 v[60:63], v[136:139], v[196:199], v[60:63]
  s_waitcnt lgkmcnt(8)
  v_mfma_f32_16x16x32_bf16 v[64:67], v[140:143], v[192:195], v[64:67]
  ds_read_b128 v[104:107], v4 offset:38912
  v_mfma_f32_16x16x32_bf16 v[68:71], v[140:143], v[196:199], v[68:71]
  buffer_load_dwordx4 v[188:191], v3, s[8:11], s33 offen offset:0
  s_waitcnt lgkmcnt(8)
  v_mfma_f32_16x16x32_bf16 v[76:79], v[140:143], v[144:147], v[76:79]
  ds_read_b128 v[108:111], v4 offset:39936
  s_waitcnt lgkmcnt(8)
  v_mfma_f32_16x16x32_bf16 v[72:75], v[148:151], v[144:147], v[72:75]
  ds_read_b128 v[112:115], v7 offset:32768
  s_waitcnt vmcnt(17) lgkmcnt(8)
  v_mfma_f32_16x16x32_bf16 v[16:19], v[80:83], v[152:155], v[16:19]
  s_waitcnt vmcnt(10)
  s_barrier
  ds_read_b128 v[116:119], v4 offset:40960
  v_mfma_f32_16x16x32_bf16 v[20:23], v[80:83], v[156:159], v[20:23]
  s_add_u32 m0, s30, 139264
  s_add_u32 s35, s35, 7168
  buffer_load_dwordx4 v3, s[8:11], s35 offen lds
  s_waitcnt lgkmcnt(8)
  v_mfma_f32_16x16x32_bf16 v[24:27], v[84:87], v[152:155], v[24:27]
  ds_read_b128 v[120:123], v4 offset:41984
  v_mfma_f32_16x16x32_bf16 v[28:31], v[84:87], v[156:159], v[28:31]
  s_waitcnt lgkmcnt(8)
  v_mfma_f32_16x16x32_bf16 v[32:35], v[88:91], v[152:155], v[32:35]
  ds_read_b128 v[124:127], v4 offset:43008
  v_mfma_f32_16x16x32_bf16 v[36:39], v[88:91], v[156:159], v[36:39]
  s_add_u32 m0, s30, 143360
  s_add_u32 s34, s34, s29
  buffer_load_dwordx4 v3, s[8:11], s34 offen lds
  s_waitcnt lgkmcnt(8)
  v_mfma_f32_16x16x32_bf16 v[40:43], v[92:95], v[152:155], v[40:43]
  ds_read_b128 v[128:131], v4 offset:44032
  v_mfma_f32_16x16x32_bf16 v[44:47], v[92:95], v[156:159], v[44:47]
  s_waitcnt lgkmcnt(8)
  v_mfma_f32_16x16x32_bf16 v[48:51], v[96:99], v[152:155], v[48:51]
  ds_read_b128 v[132:135], v4 offset:45056
  v_mfma_f32_16x16x32_bf16 v[52:55], v[96:99], v[156:159], v[52:55]
  buffer_load_dwordx4 v[192:195], v3, s[8:11], s32 offen offset:1024
  s_waitcnt lgkmcnt(8)
  v_mfma_f32_16x16x32_bf16 v[56:59], v[100:103], v[152:155], v[56:59]
  ds_read_b128 v[136:139], v4 offset:46080
  v_mfma_f32_16x16x32_bf16 v[60:63], v[100:103], v[156:159], v[60:63]
  s_waitcnt lgkmcnt(8)
  v_mfma_f32_16x16x32_bf16 v[64:67], v[104:107], v[152:155], v[64:67]
  ds_read_b128 v[140:143], v4 offset:47104
  v_mfma_f32_16x16x32_bf16 v[68:71], v[104:107], v[156:159], v[68:71]
  buffer_load_dwordx4 v[196:199], v3, s[8:11], s33 offen offset:1024
  s_waitcnt lgkmcnt(8)
  v_mfma_f32_16x16x32_bf16 v[76:79], v[104:107], v[108:111], v[76:79]
  ds_read_b128 v[144:147], v4 offset:48128
  s_waitcnt lgkmcnt(8)
  v_mfma_f32_16x16x32_bf16 v[72:75], v[112:115], v[108:111], v[72:75]
  ds_read_b128 v[148:151], v7 offset:40960
  s_waitcnt lgkmcnt(8)
  v_mfma_f32_16x16x32_bf16 v[16:19], v[116:119], v[160:163], v[16:19]
  ds_read_b128 v[80:83], v4 offset:49152
  v_mfma_f32_16x16x32_bf16 v[20:23], v[116:119], v[164:167], v[20:23]
  s_and_b32 s79, s2, 7
  s_waitcnt lgkmcnt(8)
  v_mfma_f32_16x16x32_bf16 v[24:27], v[120:123], v[160:163], v[24:27]
  ds_read_b128 v[84:87], v4 offset:50176
  v_mfma_f32_16x16x32_bf16 v[28:31], v[120:123], v[164:167], v[28:31]
  s_lshr_b32 s83, s2, 3
  s_waitcnt lgkmcnt(8)
  v_mfma_f32_16x16x32_bf16 v[32:35], v[124:127], v[160:163], v[32:35]
  ds_read_b128 v[88:91], v4 offset:51200
  v_mfma_f32_16x16x32_bf16 v[36:39], v[124:127], v[164:167], v[36:39]
  s_mul_i32 s84, s83, 43
  s_waitcnt lgkmcnt(8)
  v_mfma_f32_16x16x32_bf16 v[40:43], v[128:131], v[160:163], v[40:43]
  ds_read_b128 v[92:95], v4 offset:52224
  v_mfma_f32_16x16x32_bf16 v[44:47], v[128:131], v[164:167], v[44:47]
  s_lshr_b32 s84, s84, 8
  s_waitcnt lgkmcnt(8)
  v_mfma_f32_16x16x32_bf16 v[48:51], v[132:135], v[160:163], v[48:51]
  ds_read_b128 v[96:99], v4 offset:53248
  v_mfma_f32_16x16x32_bf16 v[52:55], v[132:135], v[164:167], v[52:55]
  s_mul_i32 s78, s84, 6
  s_waitcnt lgkmcnt(8)
  v_mfma_f32_16x16x32_bf16 v[56:59], v[136:139], v[160:163], v[56:59]
  ds_read_b128 v[100:103], v4 offset:54272
  v_mfma_f32_16x16x32_bf16 v[60:63], v[136:139], v[164:167], v[60:63]
  s_sub_u32 s78, s83, s78
  s_waitcnt lgkmcnt(8)
  v_mfma_f32_16x16x32_bf16 v[64:67], v[140:143], v[160:163], v[64:67]
  ds_read_b128 v[104:107], v4 offset:55296
  v_mfma_f32_16x16x32_bf16 v[68:71], v[140:143], v[164:167], v[68:71]
  s_lshl_b32 s79, s79, 2
  s_waitcnt lgkmcnt(8)
  v_mfma_f32_16x16x32_bf16 v[76:79], v[140:143], v[144:147], v[76:79]
  ds_read_b128 v[108:111], v4 offset:56320
  s_waitcnt lgkmcnt(8)
  v_mfma_f32_16x16x32_bf16 v[72:75], v[148:151], v[144:147], v[72:75]
  ds_read_b128 v[112:115], v7 offset:49152
  s_waitcnt vmcnt(13) lgkmcnt(8)
  v_mfma_f32_16x16x32_bf16 v[16:19], v[80:83], v[168:171], v[16:19]
  s_waitcnt vmcnt(6)
  s_barrier
  ds_read_b128 v[116:119], v4 offset:57344
  v_mfma_f32_16x16x32_bf16 v[20:23], v[80:83], v[172:175], v[20:23]
  s_add_u32 s79, s79, s84
  s_waitcnt lgkmcnt(8)
  v_mfma_f32_16x16x32_bf16 v[24:27], v[84:87], v[168:171], v[24:27]
  ds_read_b128 v[120:123], v4 offset:58368
  v_mfma_f32_16x16x32_bf16 v[28:31], v[84:87], v[172:175], v[28:31]
  s_lshl_b32 s79, s79, 2
  s_waitcnt lgkmcnt(8)
  v_mfma_f32_16x16x32_bf16 v[32:35], v[88:91], v[168:171], v[32:35]
  ds_read_b128 v[124:127], v4 offset:59392
  v_mfma_f32_16x16x32_bf16 v[36:39], v[88:91], v[172:175], v[36:39]
  s_add_u32 s79, s79, s24
  s_waitcnt lgkmcnt(8)
  v_mfma_f32_16x16x32_bf16 v[40:43], v[92:95], v[168:171], v[40:43]
  ds_read_b128 v[128:131], v4 offset:60416
  v_mfma_f32_16x16x32_bf16 v[44:47], v[92:95], v[172:175], v[44:47]
  s_mul_i32 s80, s78, 110592
  s_waitcnt lgkmcnt(8)
  v_mfma_f32_16x16x32_bf16 v[48:51], v[96:99], v[168:171], v[48:51]
  ds_read_b128 v[132:135], v4 offset:61440
  v_mfma_f32_16x16x32_bf16 v[52:55], v[96:99], v[172:175], v[52:55]
  s_add_u32 s80, s80, s30
  s_waitcnt lgkmcnt(8)
  v_mfma_f32_16x16x32_bf16 v[56:59], v[100:103], v[168:171], v[56:59]
  ds_read_b128 v[136:139], v4 offset:62464
  v_mfma_f32_16x16x32_bf16 v[60:63], v[100:103], v[172:175], v[60:63]
  s_add_u32 s80, s80, 11796480
  s_waitcnt lgkmcnt(8)
  v_mfma_f32_16x16x32_bf16 v[64:67], v[104:107], v[168:171], v[64:67]
  ds_read_b128 v[140:143], v4 offset:63488
  v_mfma_f32_16x16x32_bf16 v[68:71], v[104:107], v[172:175], v[68:71]
  s_cmp_lt_u32 s2, 192
  s_cselect_b32 s80, s80, 0x7f000000
  s_waitcnt lgkmcnt(8)
  v_mfma_f32_16x16x32_bf16 v[76:79], v[104:107], v[108:111], v[76:79]
  ds_read_b128 v[144:147], v4 offset:64512
  s_waitcnt lgkmcnt(8)
  v_mfma_f32_16x16x32_bf16 v[72:75], v[112:115], v[108:111], v[72:75]
  ds_read_b128 v[148:151], v7 offset:57344
  s_waitcnt lgkmcnt(8)
  v_mfma_f32_16x16x32_bf16 v[16:19], v[116:119], v[176:179], v[16:19]
  ds_read_b128 v[80:83], v5 offset:0
  v_mfma_f32_16x16x32_bf16 v[20:23], v[116:119], v[180:183], v[20:23]
  s_cmp_eq_u32 s3, 0
  s_cselect_b32 s52, s56, s58
  s_cselect_b32 s53, s57, s59
  s_waitcnt lgkmcnt(8)
  v_mfma_f32_16x16x32_bf16 v[24:27], v[120:123], v[176:179], v[24:27]
  ds_read_b128 v[84:87], v5 offset:1024
  v_mfma_f32_16x16x32_bf16 v[28:31], v[120:123], v[180:183], v[28:31]
  s_mov_b32 s54, 2359296
  s_waitcnt lgkmcnt(8)
  v_mfma_f32_16x16x32_bf16 v[32:35], v[124:127], v[176:179], v[32:35]
  ds_read_b128 v[88:91], v5 offset:2048
  v_mfma_f32_16x16x32_bf16 v[36:39], v[124:127], v[180:183], v[36:39]
  s_mov_b32 s55, 0x20000
  s_waitcnt lgkmcnt(8)
  v_mfma_f32_16x16x32_bf16 v[40:43], v[128:131], v[176:179], v[40:43]
  ds_read_b128 v[92:95], v5 offset:3072
  v_mfma_f32_16x16x32_bf16 v[44:47], v[128:131], v[180:183], v[44:47]
  s_waitcnt lgkmcnt(8)
  v_mfma_f32_16x16x32_bf16 v[48:51], v[132:135], v[176:179], v[48:51]
  ds_read_b128 v[96:99], v5 offset:4096
  v_mfma_f32_16x16x32_bf16 v[52:55], v[132:135], v[180:183], v[52:55]
  s_waitcnt lgkmcnt(8)
  v_mfma_f32_16x16x32_bf16 v[56:59], v[136:139], v[176:179], v[56:59]
  ds_read_b128 v[100:103], v5 offset:5120
  v_mfma_f32_16x16x32_bf16 v[60:63], v[136:139], v[180:183], v[60:63]
  s_waitcnt lgkmcnt(8)
  v_mfma_f32_16x16x32_bf16 v[64:67], v[140:143], v[176:179], v[64:67]
  ds_read_b128 v[104:107], v5 offset:6144
  v_mfma_f32_16x16x32_bf16 v[68:71], v[140:143], v[180:183], v[68:71]
  s_waitcnt lgkmcnt(8)
  v_mfma_f32_16x16x32_bf16 v[76:79], v[140:143], v[144:147], v[76:79]
  ds_read_b128 v[108:111], v5 offset:7168
  s_waitcnt lgkmcnt(8)
  v_mfma_f32_16x16x32_bf16 v[72:75], v[148:151], v[144:147], v[72:75]
  ds_read_b128 v[112:115], v8 offset:0
  s_waitcnt vmcnt(5) lgkmcnt(8)
  v_mfma_f32_16x16x32_bf16 v[16:19], v[80:83], v[184:187], v[16:19]
  s_waitcnt vmcnt(2)
  s_barrier
  ds_read_b128 v[116:119], v5 offset:8192
  v_mfma_f32_16x16x32_bf16 v[20:23], v[80:83], v[188:191], v[20:23]
  s_waitcnt lgkmcnt(8)
  v_mfma_f32_16x16x32_bf16 v[24:27], v[84:87], v[184:187], v[24:27]
  ds_read_b128 v[120:123], v5 offset:9216
  v_mfma_f32_16x16x32_bf16 v[28:31], v[84:87], v[188:191], v[28:31]
  s_waitcnt lgkmcnt(8)
  v_mfma_f32_16x16x32_bf16 v[32:35], v[88:91], v[184:187], v[32:35]
  ds_read_b128 v[124:127], v5 offset:10240
  v_mfma_f32_16x16x32_bf16 v[36:39], v[88:91], v[188:191], v[36:39]
  s_waitcnt lgkmcnt(8)
  v_mfma_f32_16x16x32_bf16 v[40:43], v[92:95], v[184:187], v[40:43]
  ds_read_b128 v[128:131], v5 offset:11264
  v_mfma_f32_16x16x32_bf16 v[44:47], v[92:95], v[188:191], v[44:47]
  s_waitcnt lgkmcnt(8)
  v_mfma_f32_16x16x32_bf16 v[48:51], v[96:99], v[184:187], v[48:51]
  ds_read_b128 v[132:135], v5 offset:12288
  v_mfma_f32_16x16x32_bf16 v[52:55], v[96:99], v[188:191], v[52:55]
  s_waitcnt lgkmcnt(8)
  v_mfma_f32_16x16x32_bf16 v[56:59], v[100:103], v[184:187], v[56:59]
  ds_read_b128 v[136:139], v5 offset:13312
  v_mfma_f32_16x16x32_bf16 v[60:63], v[100:103], v[188:191], v[60:63]
  s_waitcnt lgkmcnt(8)
  v_mfma_f32_16x16x32_bf16 v[64:67], v[104:107], v[184:187], v[64:67]
  ds_read_b128 v[140:143], v5 offset:14336
  v_mfma_f32_16x16x32_bf16 v[68:71], v[104:107], v[188:191], v[68:71]
  s_waitcnt lgkmcnt(8)
  v_mfma_f32_16x16x32_bf16 v[76:79], v[104:107], v[108:111], v[76:79]
  ds_read_b128 v[144:147], v5 offset:15360
  s_waitcnt lgkmcnt(8)
  v_mfma_f32_16x16x32_bf16 v[72:75], v[112:115], v[108:111], v[72:75]
  ds_read_b128 v[148:151], v8 offset:8192
  s_waitcnt vmcnt(1) lgkmcnt(8)
  v_mfma_f32_16x16x32_bf16 v[16:19], v[116:119], v[192:195], v[16:19]
  s_waitcnt vmcnt(0)
  v_mfma_f32_16x16x32_bf16 v[20:23], v[116:119], v[196:199], v[20:23]
  s_waitcnt lgkmcnt(7)
  v_mfma_f32_16x16x32_bf16 v[24:27], v[120:123], v[192:195], v[24:27]
  v_mfma_f32_16x16x32_bf16 v[28:31], v[120:123], v[196:199], v[28:31]
  s_waitcnt lgkmcnt(6)
  v_mfma_f32_16x16x32_bf16 v[32:35], v[124:127], v[192:195], v[32:35]
  v_mfma_f32_16x16x32_bf16 v[36:39], v[124:127], v[196:199], v[36:39]
  s_waitcnt lgkmcnt(5)
  v_mfma_f32_16x16x32_bf16 v[40:43], v[128:131], v[192:195], v[40:43]
  v_mfma_f32_16x16x32_bf16 v[44:47], v[128:131], v[196:199], v[44:47]
  s_waitcnt lgkmcnt(4)
  v_mfma_f32_16x16x32_bf16 v[48:51], v[132:135], v[192:195], v[48:51]
  v_mfma_f32_16x16x32_bf16 v[52:55], v[132:135], v[196:199], v[52:55]
  s_waitcnt lgkmcnt(3)
  v_mfma_f32_16x16x32_bf16 v[56:59], v[136:139], v[192:195], v[56:59]
  v_mfma_f32_16x16x32_bf16 v[60:63], v[136:139], v[196:199], v[60:63]
  s_waitcnt lgkmcnt(2)
  v_mfma_f32_16x16x32_bf16 v[64:67], v[140:143], v[192:195], v[64:67]
  v_mfma_f32_16x16x32_bf16 v[68:71], v[140:143], v[196:199], v[68:71]
  s_waitcnt lgkmcnt(1)
  v_mfma_f32_16x16x32_bf16 v[76:79], v[140:143], v[144:147], v[76:79]
  s_waitcnt lgkmcnt(0)
  v_mfma_f32_16x16x32_bf16 v[72:75], v[148:151], v[144:147], v[72:75]
  s_barrier
  v_cvt_pk_bf16_f32 v16, v16, v17
  v_cvt_pk_bf16_f32 v17, v18, v19
  ds_write_b64 v10, v[16:17] offset:0
  v_cvt_pk_bf16_f32 v20, v20, v21
  v_cvt_pk_bf16_f32 v21, v22, v23
  ds_write_b64 v10, v[20:21] offset:3840
  v_cvt_pk_bf16_f32 v24, v24, v25
  v_cvt_pk_bf16_f32 v25, v26, v27
  ds_write_b64 v10, v[24:25] offset:32
  v_cvt_pk_bf16_f32 v28, v28, v29
  v_cvt_pk_bf16_f32 v29, v30, v31
  ds_write_b64 v10, v[28:29] offset:3872
  v_cvt_pk_bf16_f32 v32, v32, v33
  v_cvt_pk_bf16_f32 v33, v34, v35
  ds_write_b64 v10, v[32:33] offset:64
  v_cvt_pk_bf16_f32 v36, v36, v37
  v_cvt_pk_bf16_f32 v37, v38, v39
  ds_write_b64 v10, v[36:37] offset:3904
  v_cvt_pk_bf16_f32 v40, v40, v41
  v_cvt_pk_bf16_f32 v41, v42, v43
  s_add_u32 m0, s30, 53248
  s_nop 0
  buffer_load_dwordx4 v3, s[8:11], s80 offen lds
  ds_write_b64 v10, v[40:41] offset:96
  v_cvt_pk_bf16_f32 v44, v44, v45
  v_cvt_pk_bf16_f32 v45, v46, v47
  ds_write_b64 v10, v[44:45] offset:3936
  v_cvt_pk_bf16_f32 v48, v48, v49
  v_cvt_pk_bf16_f32 v49, v50, v51
  ds_write_b64 v10, v[48:49] offset:128
  v_cvt_pk_bf16_f32 v52, v52, v53
  v_cvt_pk_bf16_f32 v53, v54, v55
  ds_write_b64 v10, v[52:53] offset:3968
  v_cvt_pk_bf16_f32 v56, v56, v57
  v_cvt_pk_bf16_f32 v57, v58, v59
  ds_write_b64 v10, v[56:57] offset:160
  v_cvt_pk_bf16_f32 v60, v60, v61
  v_cvt_pk_bf16_f32 v61, v62, v63
  ds_write_b64 v10, v[60:61] offset:4000
  v_cvt_pk_bf16_f32 v64, v64, v65
  v_cvt_pk_bf16_f32 v65, v66, v67
  ds_write_b64 v10, v[64:65] offset:192
  v_cvt_pk_bf16_f32 v68, v68, v69
  v_cvt_pk_bf16_f32 v69, v70, v71
  s_add_u32 m0, s30, 57344
  s_add_u32 s80, s80, 4096
  buffer_load_dwordx4 v3, s[8:11], s80 offen lds
  ds_write_b64 v10, v[68:69] offset:4032
  v_cvt_pk_bf16_f32 v72, v72, v73
  v_cvt_pk_bf16_f32 v73, v74, v75
  ds_write_b64 v11, v[72:73] offset:64
  v_cvt_pk_bf16_f32 v76, v76, v77
  v_cvt_pk_bf16_f32 v77, v78, v79
  ds_write_b64 v9, v[76:77] offset:192
  s_waitcnt lgkmcnt(0)
  s_barrier
  s_mov_b32 s60, 0x05040100
  s_mov_b32 s61, 0x07060302
  s_mov_b32 s62, 0x3fb8aa3b
  ds_read_b128 v[16:19], v12 offset:3360
  ds_read_b128 v[20:23], v12 offset:3376
  ds_read_b32 v24, v14
  ds_read_b128 v[26:29], v12 offset:3424
  ds_read_b128 v[30:33], v12 offset:3440
  ds_read_b64 v[42:43], v13 offset:3360
  ds_read_b128 v[44:47], v12 offset:2944
  ds_read_b128 v[48:51], v12 offset:2960
  ds_read_b64 v[60:61], v13 offset:2880
  s_add_u32 m0, s30, 61440
  s_add_u32 s80, s80, 4096
  buffer_load_dwordx4 v3, s[8:11], s80 offen lds
  ds_read_b128 v[62:65], v12 offset:2464
  ds_read_b128 v[66:69], v12 offset:2480
  ds_read_b64 v[78:79], v13 offset:2400
  ds_read_b128 v[80:83], v12 offset:1984
  ds_read_b128 v[84:87], v12 offset:2000
  ds_read_b64 v[96:97], v13 offset:1920
  s_waitcnt lgkmcnt(11)
  v_dot2_f32_bf16 v170, v16, v26, 0
  s_waitcnt lgkmcnt(8)
  v_dot2_f32_bf16 v171, v16, v44, 0
  s_waitcnt lgkmcnt(5)
  v_dot2_f32_bf16 v172, v16, v62, 0
  s_waitcnt lgkmcnt(2)
  v_dot2_f32_bf16 v173, v16, v80, 0
  v_dot2_f32_bf16 v170, v17, v27, v170
  v_dot2_f32_bf16 v171, v17, v45, v171
  v_dot2_f32_bf16 v172, v17, v63, v172
  v_dot2_f32_bf16 v173, v17, v81, v173
  ds_read_b128 v[98:101], v12 offset:1504
  ds_read_b128 v[102:105], v12 offset:1520
  ds_read_b64 v[114:115], v13 offset:1440
  s_add_u32 m0, s30, 65536
  s_add_u32 s80, s80, 4096
  buffer_load_dwordx4 v3, s[8:11], s80 offen lds
  v_dot2_f32_bf16 v170, v18, v28, v170
  v_dot2_f32_bf16 v171, v18, v46, v171
  v_dot2_f32_bf16 v172, v18, v64, v172
  v_dot2_f32_bf16 v173, v18, v82, v173
  v_dot2_f32_bf16 v170, v19, v29, v170
  v_dot2_f32_bf16 v171, v19, v47, v171
  v_dot2_f32_bf16 v172, v19, v65, v172
  v_dot2_f32_bf16 v173, v19, v83, v173
  ds_read_b128 v[116:119], v12 offset:1024
  ds_read_b128 v[120:123], v12 offset:1040
  ds_read_b64 v[132:133], v13 offset:960
  v_dot2_f32_bf16 v170, v20, v30, v170
  v_dot2_f32_bf16 v171, v20, v48, v171
  v_dot2_f32_bf16 v172, v20, v66, v172
  s_waitcnt lgkmcnt(7)
  v_dot2_f32_bf16 v173, v20, v84, v173
  v_dot2_f32_bf16 v170, v21, v31, v170
  v_dot2_f32_bf16 v171, v21, v49, v171
  v_dot2_f32_bf16 v172, v21, v67, v172
  v_dot2_f32_bf16 v173, v21, v85, v173
  s_add_u32 m0, s30, 69632
  s_add_u32 s80, s80, 4096
  buffer_load_dwordx4 v3, s[8:11], s80 offen lds
  ds_read_b128 v[134:137], v12 offset:544
  ds_read_b128 v[138:141], v12 offset:560
  ds_read_b64 v[150:151], v13 offset:480
  v_dot2_f32_bf16 v170, v22, v32, v170
  v_dot2_f32_bf16 v171, v22, v50, v171
  v_dot2_f32_bf16 v172, v22, v68, v172
  v_dot2_f32_bf16 v173, v22, v86, v173
  v_dot2_f32_bf16 v170, v23, v33, v170
  v_dot2_f32_bf16 v171, v23, v51, v171
  v_dot2_f32_bf16 v172, v23, v69, v172
  v_dot2_f32_bf16 v173, v23, v87, v173
  ds_read_b128 v[152:155], v12 offset:64
  ds_read_b128 v[156:159], v12 offset:80
  ds_read_b64 v[168:169], v13 offset:0
  v_dot2_f32_bf16 v170, v24, v42, v170
  v_dot2_f32_bf16 v171, v24, v60, v171
  v_dot2_f32_bf16 v172, v24, v78, v172
  s_waitcnt lgkmcnt(12)
  v_dot2_f32_bf16 v173, v24, v96, v173
  s_waitcnt lgkmcnt(11)
  v_dot2_f32_bf16 v174, v16, v98, 0
  s_add_u32 m0, s30, 73728
  s_add_u32 s80, s80, 4096
  buffer_load_dwordx4 v3, s[8:11], s80 offen lds
  s_waitcnt lgkmcnt(8)
  v_dot2_f32_bf16 v175, v16, v116, 0
  s_waitcnt lgkmcnt(5)
  v_dot2_f32_bf16 v176, v16, v134, 0
  s_waitcnt lgkmcnt(2)
  v_dot2_f32_bf16 v177, v16, v152, 0
  ds_read_b128 v[34:37], v12 offset:3488
  ds_read_b128 v[38:41], v12 offset:3504
  v_dot2_f32_bf16 v174, v17, v99, v174
  v_dot2_f32_bf16 v175, v17, v117, v175
  v_dot2_f32_bf16 v176, v17, v135, v176
  v_dot2_f32_bf16 v177, v17, v153, v177
  ds_read_b128 v[52:55], v12 offset:3008
  ds_read_b128 v[56:59], v12 offset:3024
  v_dot2_f32_bf16 v174, v18, v100, v174
  v_dot2_f32_bf16 v175, v18, v118, v175
  v_dot2_f32_bf16 v176, v18, v136, v176
  v_dot2_f32_bf16 v177, v18, v154, v177
  ds_read_b128 v[70:73], v12 offset:2528
  ds_read_b128 v[74:77], v12 offset:2544
  s_add_u32 m0, s30, 77824
  s_add_u32 s80, s80, 4096
  buffer_load_dwordx4 v3, s[8:11], s80 offen lds
  v_dot2_f32_bf16 v174, v19, v101, v174
  v_dot2_f32_bf16 v175, v19, v119, v175
  v_dot2_f32_bf16 v176, v19, v137, v176
  v_dot2_f32_bf16 v177, v19, v155, v177
  ds_read_b128 v[88:91], v12 offset:2048
  ds_read_b128 v[92:95], v12 offset:2064
  v_dot2_f32_bf16 v174, v20, v102, v174
  v_dot2_f32_bf16 v175, v20, v120, v175
  v_dot2_f32_bf16 v176, v20, v138, v176
  s_waitcnt lgkmcnt(9)
  v_dot2_f32_bf16 v177, v20, v156, v177
  ds_read_b128 v[106:109], v12 offset:1568
  ds_read_b128 v[110:113], v12 offset:1584
  v_dot2_f32_bf16 v174, v21, v103, v174
  v_dot2_f32_bf16 v175, v21, v121, v175
  v_dot2_f32_bf16 v176, v21, v139, v176
  v_dot2_f32_bf16 v177, v21, v157, v177
  ds_read_b128 v[124:127], v12 offset:1088
  ds_read_b128 v[128:131], v12 offset:1104
  v_dot2_f32_bf16 v174, v22, v104, v174
  s_add_u32 m0, s30, 81920
  s_add_u32 s80, s80, 4096
  buffer_load_dwordx4 v3, s[8:11], s80 offen lds
  v_dot2_f32_bf16 v175, v22, v122, v175
  v_dot2_f32_bf16 v176, v22, v140, v176
  v_dot2_f32_bf16 v177, v22, v158, v177
  ds_read_b128 v[142:145], v12 offset:608
  ds_read_b128 v[146:149], v12 offset:624
  v_dot2_f32_bf16 v174, v23, v105, v174
  v_dot2_f32_bf16 v175, v23, v123, v175
  v_dot2_f32_bf16 v176, v23, v141, v176
  v_dot2_f32_bf16 v177, v23, v159, v177
  ds_read_b128 v[160:163], v12 offset:128
  ds_read_b128 v[164:167], v12 offset:144
  v_dot2_f32_bf16 v174, v24, v114, v174
  v_dot2_f32_bf16 v175, v24, v132, v175
  v_dot2_f32_bf16 v176, v24, v150, v176
  s_waitcnt lgkmcnt(15)
  v_dot2_f32_bf16 v177, v24, v168, v177
  v_cvt_pk_bf16_f32 v170, 0, v170
  v_cvt_pk_bf16_f32 v171, 0, v171
  v_cvt_pk_bf16_f32 v172, 0, v172
  v_cvt_pk_bf16_f32 v173, 0, v173
  s_add_u32 m0, s30, 86016
  s_add_u32 s80, s80, 4096
  buffer_load_dwordx4 v3, s[8:11], s80 offen lds
  v_cvt_pk_bf16_f32 v174, 0, v174
  v_cvt_pk_bf16_f32 v175, 0, v175
  v_cvt_pk_bf16_f32 v176, 0, v176
  v_cvt_pk_bf16_f32 v177, 0, v177
  v_mul_f32 v170, 0x3e715bef, v170
  v_mul_f32 v171, 0x3e715bef, v171
  v_mul_f32 v172, 0x3e715bef, v172
  v_mul_f32 v173, 0x3e715bef, v173
  v_mul_f32 v174, 0x3e715bef, v174
  v_mul_f32 v175, 0x3e715bef, v175
  v_mul_f32 v176, 0x3e715bef, v176
  v_mul_f32 v177, 0x3e715bef, v177
  v_cvt_pk_bf16_f32 v170, 0, v170
  v_cvt_pk_bf16_f32 v171, 0, v171
  v_cvt_pk_bf16_f32 v172, 0, v172
  v_cvt_pk_bf16_f32 v173, 0, v173
  v_cvt_pk_bf16_f32 v174, 0, v174
  v_cvt_pk_bf16_f32 v175, 0, v175
  v_cvt_pk_bf16_f32 v176, 0, v176
  v_cvt_pk_bf16_f32 v177, 0, v177
  s_add_u32 m0, s30, 90112
  s_add_u32 s80, s80, 4096
  buffer_load_dwordx4 v3, s[8:11], s80 offen lds
  s_cmp_eq_u32 s36, 0
  s_cbranch_scc1 nomask_12
  v_mov_b32 v196, 0xce6e0000
  v_cmp_gt_u32 vcc, 2, v249
  s_nop 1
  v_cndmask_b32 v171, v171, v196, vcc
  v_cmp_gt_u32 vcc, 4, v249
  s_nop 1
  v_cndmask_b32 v172, v172, v196, vcc
  v_cmp_gt_u32 vcc, 6, v249
  s_nop 1
  v_cndmask_b32 v173, v173, v196, vcc
  v_cmp_gt_u32 vcc, 8, v249
  s_nop 1
  v_cndmask_b32 v174, v174, v196, vcc
  v_cmp_gt_u32 vcc, 10, v249
  s_nop 1
  v_cndmask_b32 v175, v175, v196, vcc
  v_cmp_gt_u32 vcc, 12, v249
  s_nop 1
  v_cndmask_b32 v176, v176, v196, vcc
  v_cmp_gt_u32 vcc, 14, v249
  s_nop 1
  v_cndmask_b32 v177, v177, v196, vcc
nomask_12:
  v_max3_f32 v196, v170, v171, v172
  s_add_u32 m0, s30, 94208
  s_add_u32 s80, s80, 4096
  buffer_load_dwordx4 v3, s[8:11], s80 offen lds
  v_max3_f32 v197, v173, v174, v175
  v_max3_f32 v196, v196, v176, v177
  v_max_f32 v196, v196, v197
  v_sub_f32 v170, v170, v196
  v_sub_f32 v171, v171, v196
  v_sub_f32 v172, v172, v196
  v_sub_f32 v173, v173, v196
  v_sub_f32 v174, v174, v196
  v_sub_f32 v175, v175, v196
  v_sub_f32 v176, v176, v196
  v_sub_f32 v177, v177, v196
  v_mul_f32 v170, s62, v170
  v_mul_f32 v171, s62, v171
  v_mul_f32 v172, s62, v172
  v_mul_f32 v173, s62, v173
  v_mul_f32 v174, s62, v174
  v_mul_f32 v175, s62, v175
  v_mul_f32 v176, s62, v176
  v_mul_f32 v177, s62, v177
  v_exp_f32 v170, v170
  s_add_u32 m0, s30, 98304
  s_add_u32 s80, s80, 4096
  buffer_load_dwordx4 v3, s[8:11], s80 offen lds
  v_exp_f32 v171, v171
  v_exp_f32 v172, v172
  v_exp_f32 v173, v173
  v_exp_f32 v174, v174
  v_exp_f32 v175, v175
  v_exp_f32 v176, v176
  v_exp_f32 v177, v177
  v_add_f32 v196, v170, v171
  v_add_f32 v197, v172, v173
  v_add_f32 v198, v174, v175
  v_add_f32 v199, v176, v177
  v_add_f32 v196, v196, v197
  v_add_f32 v198, v198, v199
  v_add_f32 v196, v196, v198
  v_rcp_f32 v196, v196
  s_waitcnt lgkmcnt(13)
  v_perm_b32 v26, v52, v34, s60
  v_perm_b32 v44, v52, v34, s61
  v_perm_b32 v27, v53, v35, s60
  v_perm_b32 v45, v53, v35, s61
  s_add_u32 m0, s30, 102400
  s_add_u32 s80, s80, 4096
  buffer_load_dwordx4 v3, s[8:11], s80 offen lds
  v_perm_b32 v28, v54, v36, s60
  v_perm_b32 v46, v54, v36, s61
  v_perm_b32 v29, v55, v37, s60
  v_perm_b32 v47, v55, v37, s61
  s_waitcnt lgkmcnt(12)
  v_perm_b32 v30, v56, v38, s60
  v_perm_b32 v48, v56, v38, s61
  v_perm_b32 v31, v57, v39, s60
  v_perm_b32 v49, v57, v39, s61
  v_perm_b32 v32, v58, v40, s60
  v_perm_b32 v50, v58, v40, s61
  v_perm_b32 v33, v59, v41, s60
  v_perm_b32 v51, v59, v41, s61
  v_perm_b32 v42, v61, v43, s60
  v_perm_b32 v60, v61, v43, s61
  v_mul_f32 v170, v170, v196
  v_mul_f32 v171, v171, v196
  v_mul_f32 v172, v172, v196
  v_mul_f32 v173, v173, v196
  v_mul_f32 v174, v174, v196
  s_add_u32 m0, s30, 106496
  s_add_u32 s80, s80, 4096
  buffer_load_dwordx4 v3, s[8:11], s80 offen lds
  v_mul_f32 v175, v175, v196
  v_mul_f32 v176, v176, v196
  v_mul_f32 v177, v177, v196
  v_cvt_pk_bf16_f32 v170, v170, v171
  v_cvt_pk_bf16_f32 v171, v172, v173
  v_cvt_pk_bf16_f32 v172, v174, v175
  v_cvt_pk_bf16_f32 v173, v176, v177
  v_dot2_f32_bf16 v178, v26, v170, 0
  v_dot2_f32_bf16 v179, v44, v170, 0
  v_dot2_f32_bf16 v180, v27, v170, 0
  v_dot2_f32_bf16 v181, v45, v170, 0
  v_dot2_f32_bf16 v182, v28, v170, 0
  v_dot2_f32_bf16 v183, v46, v170, 0
  v_dot2_f32_bf16 v184, v29, v170, 0
  v_dot2_f32_bf16 v185, v47, v170, 0
  v_dot2_f32_bf16 v186, v30, v170, 0
  v_dot2_f32_bf16 v187, v48, v170, 0
  v_dot2_f32_bf16 v188, v31, v170, 0
  v_dot2_f32_bf16 v189, v49, v170, 0
  v_dot2_f32_bf16 v190, v32, v170, 0
  s_add_u32 m0, s30, 110592
  s_add_u32 s80, s80, 4096
  buffer_load_dwordx4 v3, s[8:11], s80 offen lds
  v_dot2_f32_bf16 v191, v50, v170, 0
  v_dot2_f32_bf16 v192, v33, v170, 0
  v_dot2_f32_bf16 v193, v51, v170, 0
  v_dot2_f32_bf16 v194, v42, v170, 0
  v_dot2_f32_bf16 v195, v60, v170, 0
  s_waitcnt lgkmcnt(9)
  v_perm_b32 v62, v88, v70, s60
  v_perm_b32 v80, v88, v70, s61
  v_perm_b32 v63, v89, v71, s60
  v_perm_b32 v81, v89, v71, s61
  v_perm_b32 v64, v90, v72, s60
  v_perm_b32 v82, v90, v72, s61
  v_perm_b32 v65, v91, v73, s60
  v_perm_b32 v83, v91, v73, s61
  s_waitcnt lgkmcnt(8)
  v_perm_b32 v66, v92, v74, s60
  v_perm_b32 v84, v92, v74, s61
  v_perm_b32 v67, v93, v75, s60
  v_perm_b32 v85, v93, v75, s61
  v_perm_b32 v68, v94, v76, s60
  s_add_u32 m0, s30, 114688
  s_add_u32 s80, s80, 4096
  buffer_load_dwordx4 v3, s[8:11], s80 offen lds
  v_perm_b32 v86, v94, v76, s61
  v_perm_b32 v69, v95, v77, s60
  v_perm_b32 v87, v95, v77, s61
  v_perm_b32 v78, v97, v79, s60
  v_perm_b32 v96, v97, v79, s61
  v_dot2_f32_bf16 v178, v62, v171, v178
  v_dot2_f32_bf16 v179, v80, v171, v179
  v_dot2_f32_bf16 v180, v63, v171, v180
  v_dot2_f32_bf16 v181, v81, v171, v181
  v_dot2_f32_bf16 v182, v64, v171, v182
  v_dot2_f32_bf16 v183, v82, v171, v183
  v_dot2_f32_bf16 v184, v65, v171, v184
  v_dot2_f32_bf16 v185, v83, v171, v185
  v_dot2_f32_bf16 v186, v66, v171, v186
  v_dot2_f32_bf16 v187, v84, v171, v187
  v_dot2_f32_bf16 v188, v67, v171, v188
  v_dot2_f32_bf16 v189, v85, v171, v189
  v_dot2_f32_bf16 v190, v68, v171, v190
  v_dot2_f32_bf16 v191, v86, v171, v191
  v_dot2_f32_bf16 v192, v69, v171, v192
  s_add_u32 m0, s30, 118784
  s_add_u32 s80, s80, 4096
  buffer_load_dwordx4 v3, s[8:11], s80 offen lds
  v_dot2_f32_bf16 v193, v87, v171, v193
  v_dot2_f32_bf16 v194, v78, v171, v194
  v_dot2_f32_bf16 v195, v96, v171, v195
  s_waitcnt lgkmcnt(5)
  v_perm_b32 v98, v124, v106, s60
  v_perm_b32 v116, v124, v106, s61
  v_perm_b32 v99, v125, v107, s60
  v_perm_b32 v117, v125, v107, s61
  v_perm_b32 v100, v126, v108, s60
  v_perm_b32 v118, v126, v108, s61
  v_perm_b32 v101, v127, v109, s60
  v_perm_b32 v119, v127, v109, s61
  s_waitcnt lgkmcnt(4)
  v_perm_b32 v102, v128, v110, s60
  v_perm_b32 v120, v128, v110, s61
  v_perm_b32 v103, v129, v111, s60
  v_perm_b32 v121, v129, v111, s61
  v_perm_b32 v104, v130, v112, s60
  v_perm_b32 v122, v130, v112, s61
  v_perm_b32 v105, v131, v113, s60
  s_add_u32 m0, s30, 122880
  s_add_u32 s80, s80, 4096
  buffer_load_dwordx4 v3, s[8:11], s80 offen lds
  v_perm_b32 v123, v131, v113, s61
  v_perm_b32 v114, v133, v115, s60
  v_perm_b32 v132, v133, v115, s61
  v_dot2_f32_bf16 v178, v98, v172, v178
  v_dot2_f32_bf16 v179, v116, v172, v179
  v_dot2_f32_bf16 v180, v99, v172, v180
  v_dot2_f32_bf16 v181, v117, v172, v181
  v_dot2_f32_bf16 v182, v100, v172, v182
  v_dot2_f32_bf16 v183, v118, v172, v183
  v_dot2_f32_bf16 v184, v101, v172, v184
  v_dot2_f32_bf16 v185, v119, v172, v185
  v_dot2_f32_bf16 v186, v102, v172, v186
  v_dot2_f32_bf16 v187, v120, v172, v187
  v_dot2_f32_bf16 v188, v103, v172, v188
  v_dot2_f32_bf16 v189, v121, v172, v189
  v_dot2_f32_bf16 v190, v104, v172, v190
  v_dot2_f32_bf16 v191, v122, v172, v191
  v_dot2_f32_bf16 v192, v105, v172, v192
  v_dot2_f32_bf16 v193, v123, v172, v193
  v_dot2_f32_bf16 v194, v114, v172, v194
  s_add_u32 m0, s30, 126976
  s_add_u32 s80, s80, 4096
  buffer_load_dwordx4 v3, s[8:11], s80 offen lds
  v_dot2_f32_bf16 v195, v132, v172, v195
  s_waitcnt lgkmcnt(1)
  v_perm_b32 v134, v160, v142, s60
  v_perm_b32 v152, v160, v142, s61
  v_perm_b32 v135, v161, v143, s60
  v_perm_b32 v153, v161, v143, s61
  v_perm_b32 v136, v162, v144, s60
  v_perm_b32 v154, v162, v144, s61
  v_perm_b32 v137, v163, v145, s60
  v_perm_b32 v155, v163, v145, s61
  s_waitcnt lgkmcnt(0)
  v_perm_b32 v138, v164, v146, s60
  v_perm_b32 v156, v164, v146, s61
  v_perm_b32 v139, v165, v147, s60
  v_perm_b32 v157, v165, v147, s61
  v_perm_b32 v140, v166, v148, s60
  v_perm_b32 v158, v166, v148, s61
  v_perm_b32 v141, v167, v149, s60
  v_perm_b32 v159, v167, v149, s61
  v_perm_b32 v150, v169, v151, s60
  s_add_u32 m0, s30, 131072
  s_add_u32 s80, s80, 4096
  buffer_load_dwordx4 v3, s[8:11], s80 offen lds
  v_perm_b32 v168, v169, v151, s61
  v_dot2_f32_bf16 v178, v134, v173, v178
  v_dot2_f32_bf16 v179, v152, v173, v179
  v_dot2_f32_bf16 v180, v135, v173, v180
  v_dot2_f32_bf16 v181, v153, v173, v181
  v_dot2_f32_bf16 v182, v136, v173, v182
  v_dot2_f32_bf16 v183, v154, v173, v183
  v_dot2_f32_bf16 v184, v137, v173, v184
  v_dot2_f32_bf16 v185, v155, v173, v185
  v_dot2_f32_bf16 v186, v138, v173, v186
  v_dot2_f32_bf16 v187, v156, v173, v187
  v_dot2_f32_bf16 v188, v139, v173, v188
  v_dot2_f32_bf16 v189, v157, v173, v189
  v_dot2_f32_bf16 v190, v140, v173, v190
  v_dot2_f32_bf16 v191, v158, v173, v191
  v_dot2_f32_bf16 v192, v141, v173, v192
  v_dot2_f32_bf16 v193, v159, v173, v193
  v_dot2_f32_bf16 v194, v150, v173, v194
  v_dot2_f32_bf16 v195, v168, v173, v195
  v_cvt_pk_bf16_f32 v16, v178, v179
  s_add_u32 m0, s30, 135168
  s_add_u32 s80, s80, 4096
  buffer_load_dwordx4 v3, s[8:11], s80 offen lds
  v_cvt_pk_bf16_f32 v17, v180, v181
  v_cvt_pk_bf16_f32 v18, v182, v183
  v_cvt_pk_bf16_f32 v19, v184, v185
  v_cvt_pk_bf16_f32 v20, v186, v187
  v_cvt_pk_bf16_f32 v21, v188, v189
  v_cvt_pk_bf16_f32 v22, v190, v191
  v_cvt_pk_bf16_f32 v23, v192, v193
  v_cvt_pk_bf16_f32 v24, v194, v195
  v_min_u32 v16, -2, v16
  v_min_u32 v17, -2, v17
  v_min_u32 v18, -2, v18
  v_min_u32 v19, -2, v19
  v_min_u32 v20, -2, v20
  v_min_u32 v21, -2, v21
  v_min_u32 v22, -2, v22
  v_min_u32 v23, -2, v23
  v_min_u32 v24, -2, v24
  ds_write2_b32 v15, v16, v17 offset0:0 offset1:1
  ds_write2_b32 v15, v18, v19 offset0:2 offset1:3
  ds_write2_b32 v15, v20, v21 offset0:4 offset1:5
  ds_write2_b32 v15, v22, v23 offset0:6 offset1:7
  ds_write_b32 v15, v24 offset:32
  s_and_b32 s31, s28, 1
  s_lshl_b32 s37, s31, 3
  s_mul_i32 s38, s24, 2304
  s_add_u32 s38, s38, 40960
  s_add_u32 s39, s38, s37
  v_mul_u32_u24 v4, 72, v250
  v_lshl_add_u32 v4, v251, 4, v4
  v_add_u32 v4, s39, v4
  s_xor_b32 s39, s31, 1
  s_lshl_b32 s39, s39, 6
  s_add_u32 s39, s39, s38
  v_mul_u32_u24 v5, 72, v2
  v_add_u32 v5, s39, v5
  s_waitcnt lgkmcnt(0)
  ds_read2_b64 v[32:35], v4 offset0:0 offset1:1
  ds_read2_b64 v[36:39], v4 offset0:144 offset1:145
  ds_read_b64 v[40:41], v5
  s_mul_i32 s38, s28, 72
  s_add_u32 s38, s38, s37
  s_lshl_b32 s38, s38, 4
  s_mul_i32 s39, s46, 18432
  s_add_u32 s38, s38, s39
  s_add_u32 s39, s38, 18432
  s_mul_i32 s37, s31, 1272
  s_add_u32 s47, s38, 1024
  s_sub_u32 s47, s47, s37
  v_mul_u32_u24 v6, 18432, v251
  v_lshl_add_u32 v6, v250, 4, v6
  s_waitcnt lgkmcnt(2)
  buffer_store_dwordx4 v[32:35], v3, s[16:19], s38 offen sc1
  s_waitcnt lgkmcnt(1)
  buffer_store_dwordx4 v[36:39], v3, s[16:19], s39 offen sc1
  s_mov_b32 exec_hi, 0
  s_waitcnt lgkmcnt(0)
  buffer_store_dwordx2 v[40:41], v6, s[16:19], s47 offen sc1
  s_mov_b32 exec_hi, -1
  s_add_u32 m0, s30, 139264
  s_add_u32 s80, s80, 4096
  buffer_load_dwordx4 v3, s[8:11], s80 offen lds
  s_add_u32 m0, s30, 143360
  s_add_u32 s80, s80, 4096
  buffer_load_dwordx4 v3, s[8:11], s80 offen lds
  s_add_u32 m0, s30, 147456
  s_add_u32 s80, s80, 4096
  buffer_load_dwordx4 v3, s[8:11], s80 offen lds
  s_add_u32 m0, s30, 151552
  s_add_u32 s80, s80, 4096
  buffer_load_dwordx4 v3, s[8:11], s80 offen lds
  s_add_u32 m0, s30, 155648
  s_add_u32 s80, s80, 4096
  buffer_load_dwordx4 v3, s[8:11], s80 offen lds
  s_add_u32 m0, s30, 159744
  s_add_u32 s80, s80, 4096
  buffer_load_dwordx4 v3, s[8:11], s80 offen lds
  s_and_b32 s25, s2, 7
  s_lshl_b32 s25, s25, 1
  s_lshr_b32 s26, s2, 3
  s_and_b32 s27, s26, 1
  s_add_u32 s25, s25, s27
  s_lshr_b32 s26, s26, 1
  s_and_b32 s28, s24, 1
  s_lshr_b32 s29, s24, 1
  v_lshlrev_b32 v5, 4, v2
  s_lshl_b32 s32, s24, 10
  s_mul_i32 s81, s79, 18432
  s_mul_i32 s84, s78, 3072
  s_add_u32 s84, s84, s81
  s_add_u32 s81, s81, 52273152
  s_add_u32 s81, s81, s3
  s_cmp_ge_u32 s2, 192
  s_cbranch_scc1 spare_13
  v_and_b32 v215, 15, v2
  v_mul_u32_u24 v215, 1152, v215
  v_lshrrev_b32 v216, 4, v2
  v_lshl_add_u32 v215, v216, 3, v215
  s_mul_i32 s77, s79, 18432
  s_mul_i32 s47, s78, 192
  s_add_u32 s77, s77, s47
  v_add_u32 v215, s77, v215
  v_lshrrev_b32 v216, 1, v2
  v_mul_u32_u24 v216, 2304, v216
  v_and_b32 v217, 1, v2
  v_lshl_add_u32 v216, v217, 3, v216
  v_add_u32 v216, 1024, v216
  v_mov_b32 v221, 0
  s_mov_b32 s47, 0
  s_waitcnt vmcnt(0)
  s_mov_b64 exec, 0xffff
  buffer_load_dword v221, v216, s[8:11], s81 offen offset:240 sc1
  s_branch opd_15
osf_17:
  s_mov_b32 s47, 1
  s_mov_b32 exec_hi, 0
  s_mov_b32 exec_lo, 0xffff
op_14:
  buffer_load_dword v220, v216, s[8:11], s81 offen offset:240 sc1
  s_waitcnt vmcnt(0)
  v_cmp_eq_u32 vcc, -1, v220
  s_add_u32 s47, s47, 1
  s_cbranch_vccz opd_15
  buffer_load_dword v221, v216, s[8:11], s81 offen offset:240 sc1
  s_waitcnt vmcnt(0)
  v_cmp_eq_u32 vcc, -1, v221
  s_add_u32 s47, s47, 1
  s_cbranch_vccz opd_15
  s_cmp_lt_u32 s47, 0x40000
  s_cbranch_scc1 op_14
opd_15:
  s_mov_b64 exec, -1
  s_mov_b32 s82, 0
redo_18:
  s_mov_b32 s83, s81
  buffer_load_dwordx4 v[32:35], v5, s[8:11], s83 offen offset:0 sc1
  buffer_load_dwordx4 v[36:39], v5, s[8:11], s83 offen offset:1024 sc1
  buffer_load_dwordx4 v[40:43], v5, s[8:11], s83 offen offset:2048 sc1
  buffer_load_dwordx4 v[44:47], v5, s[8:11], s83 offen offset:3072 sc1
  s_add_u32 s83, s83, 4096
  buffer_load_dwordx4 v[48:51], v5, s[8:11], s83 offen offset:0 sc1
  buffer_load_dwordx4 v[52:55], v5, s[8:11], s83 offen offset:1024 sc1
  buffer_load_dwordx4 v[56:59], v5, s[8:11], s83 offen offset:2048 sc1
  buffer_load_dwordx4 v[60:63], v5, s[8:11], s83 offen offset:3072 sc1
  s_add_u32 s83, s83, 4096
  buffer_load_dwordx4 v[64:67], v5, s[8:11], s83 offen offset:0 sc1
  buffer_load_dwordx4 v[68:71], v5, s[8:11], s83 offen offset:1024 sc1
  buffer_load_dwordx4 v[72:75], v5, s[8:11], s83 offen offset:2048 sc1
  buffer_load_dwordx4 v[76:79], v5, s[8:11], s83 offen offset:3072 sc1
  s_add_u32 s83, s83, 4096
  buffer_load_dwordx4 v[80:83], v5, s[8:11], s83 offen offset:0 sc1
  buffer_load_dwordx4 v[84:87], v5, s[8:11], s83 offen offset:1024 sc1
  buffer_load_dwordx4 v[88:91], v5, s[8:11], s83 offen offset:2048 sc1
  buffer_load_dwordx4 v[92:95], v5, s[8:11], s83 offen offset:3072 sc1
  s_add_u32 s83, s83, 4096
  buffer_load_dwordx4 v[96:99], v5, s[8:11], s83 offen offset:0 sc1
  buffer_load_dwordx4 v[100:103], v5, s[8:11], s83 offen offset:1024 sc1
  buffer_load_dwordx2 v[104:105], v215, s[52:55], 0 offen offset:0
  buffer_load_dwordx2 v[106:107], v215, s[52:55], 0 offen offset:32
  buffer_load_dwordx2 v[108:109], v215, s[52:55], 0 offen offset:64
  buffer_load_dwordx2 v[110:111], v215, s[52:55], 0 offen offset:96
  buffer_load_dwordx2 v[112:113], v215, s[52:55], 0 offen offset:128
  buffer_load_dwordx2 v[114:115], v215, s[52:55], 0 offen offset:160
  s_cmp_lg_u32 s47, 0
  s_cbranch_scc1 osk_16
  s_waitcnt vmcnt(24)
  v_cmp_eq_u32 vcc, -1, v221
  s_mov_b32 s47, 1
  s_cbranch_vccnz osf_17
osk_16:
  v_add_u32 v223, 53248, v5
  v_add_u32 v216, 36864, v223
  v_add_u32 v217, 36864, v216
  v_mov_b32 v196, 0
  s_cmp_lg_u32 s82, 0
  s_cbranch_scc1 nb_20
  s_barrier
nb_20:
  ds_read_b128 v[140:143], v223 offset:0
  ds_read_b128 v[144:147], v223 offset:1024
  ds_read_b128 v[148:151], v216 offset:0
  ds_read_b128 v[152:155], v216 offset:1024
  ds_read_b128 v[156:159], v217 offset:0
  ds_read_b128 v[160:163], v217 offset:1024
  ds_read_b128 v[164:167], v223 offset:2048
  ds_read_b128 v[168:171], v223 offset:3072
  s_waitcnt vmcnt(23) lgkmcnt(7)
  v_mfma_f32_16x16x32_bf16 v[116:119], v[140:143], v[32:35], 0
  ds_read_b128 v[172:175], v216 offset:2048
  v_max3_u32 v196, v196, v32, v33
  s_waitcnt lgkmcnt(7)
  v_mfma_f32_16x16x32_bf16 v[120:123], v[144:147], v[32:35], 0
  ds_read_b128 v[176:179], v216 offset:3072
  v_max3_u32 v196, v196, v34, v35
  s_waitcnt lgkmcnt(7)
  v_mfma_f32_16x16x32_bf16 v[124:127], v[148:151], v[32:35], 0
  ds_read_b128 v[180:183], v217 offset:2048
  v_lshrrev_b32 v24, 3, v2
  v_and_b32 v25, 6, v24
  s_waitcnt lgkmcnt(7)
  v_mfma_f32_16x16x32_bf16 v[128:131], v[152:155], v[32:35], 0
  ds_read_b128 v[184:187], v217 offset:3072
  v_xor_b32 v25, v25, v2
  v_and_b32 v25, 7, v25
  s_waitcnt lgkmcnt(7)
  v_mfma_f32_16x16x32_bf16 v[132:135], v[156:159], v[32:35], 0
  ds_read_b128 v[140:143], v223 offset:4096
  v_mul_u32_u24 v3, 9216, v24
  v_lshl_add_u32 v3, v25, 4, v3
  s_waitcnt lgkmcnt(7)
  v_mfma_f32_16x16x32_bf16 v[136:139], v[160:163], v[32:35], 0
  ds_read_b128 v[144:147], v223 offset:5120
  s_mov_b32 s12, s40
  s_mov_b32 s13, s41
  s_waitcnt vmcnt(22) lgkmcnt(7)
  v_mfma_f32_16x16x32_bf16 v[116:119], v[164:167], v[36:39], v[116:119]
  ds_read_b128 v[148:151], v216 offset:4096
  v_max3_u32 v196, v196, v36, v37
  s_waitcnt lgkmcnt(7)
  v_mfma_f32_16x16x32_bf16 v[120:123], v[168:171], v[36:39], v[120:123]
  ds_read_b128 v[152:155], v216 offset:5120
  v_max3_u32 v196, v196, v38, v39
  s_waitcnt lgkmcnt(7)
  v_mfma_f32_16x16x32_bf16 v[124:127], v[172:175], v[36:39], v[124:127]
  ds_read_b128 v[156:159], v217 offset:4096
  s_mov_b32 s14, 5308416
  s_mov_b32 s15, 0x20000
  s_waitcnt lgkmcnt(7)
  v_mfma_f32_16x16x32_bf16 v[128:131], v[176:179], v[36:39], v[128:131]
  ds_read_b128 v[160:163], v217 offset:5120
  s_mov_b32 s16, s42
  s_mov_b32 s17, s43
  s_waitcnt lgkmcnt(7)
  v_mfma_f32_16x16x32_bf16 v[132:135], v[180:183], v[36:39], v[132:135]
  ds_read_b128 v[164:167], v223 offset:6144
  s_mov_b32 s18, 5308416
  s_mov_b32 s19, 0x20000
  s_waitcnt lgkmcnt(7)
  v_mfma_f32_16x16x32_bf16 v[136:139], v[184:187], v[36:39], v[136:139]
  ds_read_b128 v[168:171], v223 offset:7168
  s_mul_i32 s35, s25, 576
  s_lshl_b32 s30, s27, 6
  s_waitcnt vmcnt(21) lgkmcnt(7)
  v_mfma_f32_16x16x32_bf16 v[116:119], v[140:143], v[40:43], v[116:119]
  ds_read_b128 v[172:175], v216 offset:6144
  v_max3_u32 v196, v196, v40, v41
  s_waitcnt lgkmcnt(7)
  v_mfma_f32_16x16x32_bf16 v[120:123], v[144:147], v[40:43], v[120:123]
  ds_read_b128 v[176:179], v216 offset:7168
  v_max3_u32 v196, v196, v42, v43
  s_waitcnt lgkmcnt(7)
  v_mfma_f32_16x16x32_bf16 v[124:127], v[148:151], v[40:43], v[124:127]
  ds_read_b128 v[180:183], v217 offset:6144
  s_mul_i32 s31, s24, 73728
  s_add_u32 s30, s30, s31
  s_waitcnt lgkmcnt(7)
  v_mfma_f32_16x16x32_bf16 v[128:131], v[152:155], v[40:43], v[128:131]
  ds_read_b128 v[184:187], v217 offset:7168
  v_add_u32 v3, s30, v3
  s_mov_b32 s60, s35
  s_waitcnt lgkmcnt(7)
  v_mfma_f32_16x16x32_bf16 v[132:135], v[156:159], v[40:43], v[132:135]
  ds_read_b128 v[140:143], v223 offset:8192
  s_add_u32 s61, s60, 294912
  s_add_u32 s62, s61, 294912
  s_waitcnt lgkmcnt(7)
  v_mfma_f32_16x16x32_bf16 v[136:139], v[160:163], v[40:43], v[136:139]
  ds_read_b128 v[144:147], v223 offset:9216
  s_add_u32 s63, s62, 294912
  s_add_u32 s64, s63, 294912
  s_waitcnt vmcnt(20) lgkmcnt(7)
  v_mfma_f32_16x16x32_bf16 v[116:119], v[164:167], v[44:47], v[116:119]
  ds_read_b128 v[148:151], v216 offset:8192
  v_max3_u32 v196, v196, v44, v45
  s_waitcnt lgkmcnt(7)
  v_mfma_f32_16x16x32_bf16 v[120:123], v[168:171], v[44:47], v[120:123]
  ds_read_b128 v[152:155], v216 offset:9216
  v_max3_u32 v196, v196, v46, v47
  s_waitcnt lgkmcnt(7)
  v_mfma_f32_16x16x32_bf16 v[124:127], v[172:175], v[44:47], v[124:127]
  ds_read_b128 v[156:159], v217 offset:8192
  s_add_u32 s65, s64, 294912
  s_add_u32 s66, s65, 294912
  s_waitcnt lgkmcnt(7)
  v_mfma_f32_16x16x32_bf16 v[128:131], v[176:179], v[44:47], v[128:131]
  ds_read_b128 v[160:163], v217 offset:9216
  s_add_u32 s67, s66, 294912
  s_add_u32 s68, s67, 294912
  s_waitcnt lgkmcnt(7)
  v_mfma_f32_16x16x32_bf16 v[132:135], v[180:183], v[44:47], v[132:135]
  ds_read_b128 v[164:167], v223 offset:10240
  s_add_u32 s69, s68, 294912
  s_add_u32 s70, s69, 294912
  s_waitcnt lgkmcnt(7)
  v_mfma_f32_16x16x32_bf16 v[136:139], v[184:187], v[44:47], v[136:139]
  ds_read_b128 v[168:171], v223 offset:11264
  s_add_u32 s71, s70, 294912
  s_add_u32 s72, s71, 294912
  s_waitcnt vmcnt(19) lgkmcnt(7)
  v_mfma_f32_16x16x32_bf16 v[116:119], v[140:143], v[48:51], v[116:119]
  ds_read_b128 v[172:175], v216 offset:10240
  v_max3_u32 v196, v196, v48, v49
  s_waitcnt lgkmcnt(7)
  v_mfma_f32_16x16x32_bf16 v[120:123], v[144:147], v[48:51], v[120:123]
  ds_read_b128 v[176:179], v216 offset:11264
  v_max3_u32 v196, v196, v50, v51
  s_waitcnt lgkmcnt(7)
  v_mfma_f32_16x16x32_bf16 v[124:127], v[148:151], v[48:51], v[124:127]
  ds_read_b128 v[180:183], v217 offset:10240
  s_add_u32 s73, s72, 294912
  s_add_u32 s74, s73, 294912
  s_waitcnt lgkmcnt(7)
  v_mfma_f32_16x16x32_bf16 v[128:131], v[152:155], v[48:51], v[128:131]
  ds_read_b128 v[184:187], v217 offset:11264
  s_add_u32 s75, s74, 294912
  s_add_u32 s76, s75, 294912
  s_waitcnt lgkmcnt(7)
  v_mfma_f32_16x16x32_bf16 v[132:135], v[156:159], v[48:51], v[132:135]
  ds_read_b128 v[140:143], v223 offset:12288
  s_add_u32 s77, s76, 294912
  v_lshlrev_b32 v218, 3, v2
  s_waitcnt lgkmcnt(7)
  v_mfma_f32_16x16x32_bf16 v[136:139], v[160:163], v[48:51], v[136:139]
  ds_read_b128 v[144:147], v223 offset:13312
  v_and_b32 v219, 0xff, v218
  v_add_u32 v219, 512, v219
  s_waitcnt vmcnt(18) lgkmcnt(7)
  v_mfma_f32_16x16x32_bf16 v[116:119], v[164:167], v[52:55], v[116:119]
  ds_read_b128 v[148:151], v216 offset:12288
  v_max3_u32 v196, v196, v52, v53
  s_waitcnt lgkmcnt(7)
  v_mfma_f32_16x16x32_bf16 v[120:123], v[168:171], v[52:55], v[120:123]
  ds_read_b128 v[152:155], v216 offset:13312
  v_max3_u32 v196, v196, v54, v55
  s_waitcnt lgkmcnt(7)
  v_mfma_f32_16x16x32_bf16 v[124:127], v[172:175], v[52:55], v[124:127]
  ds_read_b128 v[156:159], v217 offset:12288
  s_mul_i32 s86, s79, 768
  s_add_u32 s86, s86, 54632448
  s_waitcnt lgkmcnt(7)
  v_mfma_f32_16x16x32_bf16 v[128:131], v[176:179], v[52:55], v[128:131]
  ds_read_b128 v[160:163], v217 offset:13312
  s_add_u32 s86, s86, s3
  s_lshl_b32 s56, s78, 7
  s_waitcnt lgkmcnt(7)
  v_mfma_f32_16x16x32_bf16 v[132:135], v[180:183], v[52:55], v[132:135]
  ds_read_b128 v[164:167], v223 offset:14336
  s_add_u32 s56, s56, s86
  s_add_u32 s85, s84, 9437184
  s_waitcnt lgkmcnt(7)
  v_mfma_f32_16x16x32_bf16 v[136:139], v[184:187], v[52:55], v[136:139]
  ds_read_b128 v[168:171], v223 offset:15360
  s_add_u32 s34, s56, 131072
  s_waitcnt vmcnt(17) lgkmcnt(7)
  v_mfma_f32_16x16x32_bf16 v[116:119], v[140:143], v[56:59], v[116:119]
  ds_read_b128 v[172:175], v216 offset:14336
  v_max3_u32 v196, v196, v56, v57
  s_waitcnt lgkmcnt(7)
  v_mfma_f32_16x16x32_bf16 v[120:123], v[144:147], v[56:59], v[120:123]
  ds_read_b128 v[176:179], v216 offset:15360
  v_max3_u32 v196, v196, v58, v59
  s_waitcnt lgkmcnt(7)
  v_mfma_f32_16x16x32_bf16 v[124:127], v[148:151], v[56:59], v[124:127]
  ds_read_b128 v[180:183], v217 offset:14336
  s_waitcnt lgkmcnt(7)
  v_mfma_f32_16x16x32_bf16 v[128:131], v[152:155], v[56:59], v[128:131]
  ds_read_b128 v[184:187], v217 offset:15360
  s_waitcnt lgkmcnt(7)
  v_mfma_f32_16x16x32_bf16 v[132:135], v[156:159], v[56:59], v[132:135]
  ds_read_b128 v[140:143], v223 offset:16384
  s_waitcnt lgkmcnt(7)
  v_mfma_f32_16x16x32_bf16 v[136:139], v[160:163], v[56:59], v[136:139]
  ds_read_b128 v[144:147], v223 offset:17408
  s_waitcnt vmcnt(16) lgkmcnt(7)
  v_mfma_f32_16x16x32_bf16 v[116:119], v[164:167], v[60:63], v[116:119]
  ds_read_b128 v[148:151], v216 offset:16384
  v_max3_u32 v196, v196, v60, v61
  s_waitcnt lgkmcnt(7)
  v_mfma_f32_16x16x32_bf16 v[120:123], v[168:171], v[60:63], v[120:123]
  ds_read_b128 v[152:155], v216 offset:17408
  v_max3_u32 v196, v196, v62, v63
  s_waitcnt lgkmcnt(7)
  v_mfma_f32_16x16x32_bf16 v[124:127], v[172:175], v[60:63], v[124:127]
  ds_read_b128 v[156:159], v217 offset:16384
  s_waitcnt lgkmcnt(7)
  v_mfma_f32_16x16x32_bf16 v[128:131], v[176:179], v[60:63], v[128:131]
  ds_read_b128 v[160:163], v217 offset:17408
  s_waitcnt lgkmcnt(7)
  v_mfma_f32_16x16x32_bf16 v[132:135], v[180:183], v[60:63], v[132:135]
  ds_read_b128 v[164:167], v223 offset:18432
  s_waitcnt lgkmcnt(7)
  v_mfma_f32_16x16x32_bf16 v[136:139], v[184:187], v[60:63], v[136:139]
  ds_read_b128 v[168:171], v223 offset:19456
  s_waitcnt vmcnt(15) lgkmcnt(7)
  v_mfma_f32_16x16x32_bf16 v[116:119], v[140:143], v[64:67], v[116:119]
  ds_read_b128 v[172:175], v216 offset:18432
  v_max3_u32 v196, v196, v64, v65
  s_waitcnt lgkmcnt(7)
  v_mfma_f32_16x16x32_bf16 v[120:123], v[144:147], v[64:67], v[120:123]
  ds_read_b128 v[176:179], v216 offset:19456
  v_max3_u32 v196, v196, v66, v67
  s_waitcnt lgkmcnt(7)
  v_mfma_f32_16x16x32_bf16 v[124:127], v[148:151], v[64:67], v[124:127]
  ds_read_b128 v[180:183], v217 offset:18432
  s_waitcnt lgkmcnt(7)
  v_mfma_f32_16x16x32_bf16 v[128:131], v[152:155], v[64:67], v[128:131]
  ds_read_b128 v[184:187], v217 offset:19456
  s_waitcnt lgkmcnt(7)
  v_mfma_f32_16x16x32_bf16 v[132:135], v[156:159], v[64:67], v[132:135]
  ds_read_b128 v[140:143], v223 offset:20480
  s_waitcnt lgkmcnt(7)
  v_mfma_f32_16x16x32_bf16 v[136:139], v[160:163], v[64:67], v[136:139]
  ds_read_b128 v[144:147], v223 offset:21504
  s_waitcnt vmcnt(14) lgkmcnt(7)
  v_mfma_f32_16x16x32_bf16 v[116:119], v[164:167], v[68:71], v[116:119]
  ds_read_b128 v[148:151], v216 offset:20480
  v_max3_u32 v196, v196, v68, v69
  s_waitcnt lgkmcnt(7)
  v_mfma_f32_16x16x32_bf16 v[120:123], v[168:171], v[68:71], v[120:123]
  ds_read_b128 v[152:155], v216 offset:21504
  v_max3_u32 v196, v196, v70, v71
  s_waitcnt lgkmcnt(7)
  v_mfma_f32_16x16x32_bf16 v[124:127], v[172:175], v[68:71], v[124:127]
  ds_read_b128 v[156:159], v217 offset:20480
  s_waitcnt lgkmcnt(7)
  v_mfma_f32_16x16x32_bf16 v[128:131], v[176:179], v[68:71], v[128:131]
  ds_read_b128 v[160:163], v217 offset:21504
  s_waitcnt lgkmcnt(7)
  v_mfma_f32_16x16x32_bf16 v[132:135], v[180:183], v[68:71], v[132:135]
  ds_read_b128 v[164:167], v223 offset:22528
  s_waitcnt lgkmcnt(7)
  v_mfma_f32_16x16x32_bf16 v[136:139], v[184:187], v[68:71], v[136:139]
  ds_read_b128 v[168:171], v223 offset:23552
  s_waitcnt vmcnt(13) lgkmcnt(7)
  v_mfma_f32_16x16x32_bf16 v[116:119], v[140:143], v[72:75], v[116:119]
  ds_read_b128 v[172:175], v216 offset:22528
  v_max3_u32 v196, v196, v72, v73
  s_waitcnt lgkmcnt(7)
  v_mfma_f32_16x16x32_bf16 v[120:123], v[144:147], v[72:75], v[120:123]
  ds_read_b128 v[176:179], v216 offset:23552
  v_max3_u32 v196, v196, v74, v75
  s_waitcnt lgkmcnt(7)
  v_mfma_f32_16x16x32_bf16 v[124:127], v[148:151], v[72:75], v[124:127]
  ds_read_b128 v[180:183], v217 offset:22528
  s_waitcnt lgkmcnt(7)
  v_mfma_f32_16x16x32_bf16 v[128:131], v[152:155], v[72:75], v[128:131]
  ds_read_b128 v[184:187], v217 offset:23552
  s_waitcnt lgkmcnt(7)
  v_mfma_f32_16x16x32_bf16 v[132:135], v[156:159], v[72:75], v[132:135]
  ds_read_b128 v[140:143], v223 offset:24576
  s_waitcnt lgkmcnt(7)
  v_mfma_f32_16x16x32_bf16 v[136:139], v[160:163], v[72:75], v[136:139]
  ds_read_b128 v[144:147], v223 offset:25600
  s_waitcnt vmcnt(12) lgkmcnt(7)
  v_mfma_f32_16x16x32_bf16 v[116:119], v[164:167], v[76:79], v[116:119]
  ds_read_b128 v[148:151], v216 offset:24576
  v_max3_u32 v196, v196, v76, v77
  s_waitcnt lgkmcnt(7)
  v_mfma_f32_16x16x32_bf16 v[120:123], v[168:171], v[76:79], v[120:123]
  ds_read_b128 v[152:155], v216 offset:25600
  v_max3_u32 v196, v196, v78, v79
  s_waitcnt lgkmcnt(7)
  v_mfma_f32_16x16x32_bf16 v[124:127], v[172:175], v[76:79], v[124:127]
  ds_read_b128 v[156:159], v217 offset:24576
  s_waitcnt lgkmcnt(7)
  v_mfma_f32_16x16x32_bf16 v[128:131], v[176:179], v[76:79], v[128:131]
  ds_read_b128 v[160:163], v217 offset:25600
  s_waitcnt lgkmcnt(7)
  v_mfma_f32_16x16x32_bf16 v[132:135], v[180:183], v[76:79], v[132:135]
  ds_read_b128 v[164:167], v223 offset:26624
  s_waitcnt lgkmcnt(7)
  v_mfma_f32_16x16x32_bf16 v[136:139], v[184:187], v[76:79], v[136:139]
  ds_read_b128 v[168:171], v223 offset:27648
  s_waitcnt vmcnt(11) lgkmcnt(7)
  v_mfma_f32_16x16x32_bf16 v[116:119], v[140:143], v[80:83], v[116:119]
  ds_read_b128 v[172:175], v216 offset:26624
  v_max3_u32 v196, v196, v80, v81
  s_waitcnt lgkmcnt(7)
  v_mfma_f32_16x16x32_bf16 v[120:123], v[144:147], v[80:83], v[120:123]
  ds_read_b128 v[176:179], v216 offset:27648
  v_max3_u32 v196, v196, v82, v83
  s_waitcnt lgkmcnt(7)
  v_mfma_f32_16x16x32_bf16 v[124:127], v[148:151], v[80:83], v[124:127]
  ds_read_b128 v[180:183], v217 offset:26624
  s_waitcnt lgkmcnt(7)
  v_mfma_f32_16x16x32_bf16 v[128:131], v[152:155], v[80:83], v[128:131]
  ds_read_b128 v[184:187], v217 offset:27648
  s_add_u32 m0, s32, 0
  s_nop 0
  buffer_load_dwordx4 v3, s[12:15], s60 offen offset:0 lds
  s_waitcnt lgkmcnt(7)
  v_mfma_f32_16x16x32_bf16 v[132:135], v[156:159], v[80:83], v[132:135]
  ds_read_b128 v[140:143], v223 offset:28672
  s_waitcnt lgkmcnt(7)
  v_mfma_f32_16x16x32_bf16 v[136:139], v[160:163], v[80:83], v[136:139]
  ds_read_b128 v[144:147], v223 offset:29696
  s_add_u32 m0, s32, 4096
  s_nop 0
  buffer_load_dwordx4 v3, s[16:19], s60 offen offset:0 lds
  s_waitcnt vmcnt(12) lgkmcnt(7)
  v_mfma_f32_16x16x32_bf16 v[116:119], v[164:167], v[84:87], v[116:119]
  ds_read_b128 v[148:151], v216 offset:28672
  v_max3_u32 v196, v196, v84, v85
  s_waitcnt lgkmcnt(7)
  v_mfma_f32_16x16x32_bf16 v[120:123], v[168:171], v[84:87], v[120:123]
  ds_read_b128 v[152:155], v216 offset:29696
  v_max3_u32 v196, v196, v86, v87
  s_waitcnt lgkmcnt(7)
  v_mfma_f32_16x16x32_bf16 v[124:127], v[172:175], v[84:87], v[124:127]
  ds_read_b128 v[156:159], v217 offset:28672
  s_waitcnt lgkmcnt(7)
  v_mfma_f32_16x16x32_bf16 v[128:131], v[176:179], v[84:87], v[128:131]
  ds_read_b128 v[160:163], v217 offset:29696
  s_add_u32 m0, s32, 8192
  s_nop 0
  buffer_load_dwordx4 v3, s[12:15], s61 offen offset:0 lds
  s_waitcnt lgkmcnt(7)
  v_mfma_f32_16x16x32_bf16 v[132:135], v[180:183], v[84:87], v[132:135]
  ds_read_b128 v[164:167], v223 offset:30720
  s_waitcnt lgkmcnt(7)
  v_mfma_f32_16x16x32_bf16 v[136:139], v[184:187], v[84:87], v[136:139]
  ds_read_b128 v[168:171], v223 offset:31744
  s_add_u32 m0, s32, 12288
  s_nop 0
  buffer_load_dwordx4 v3, s[16:19], s61 offen offset:0 lds
  s_waitcnt vmcnt(13) lgkmcnt(7)
  v_mfma_f32_16x16x32_bf16 v[116:119], v[140:143], v[88:91], v[116:119]
  ds_read_b128 v[172:175], v216 offset:30720
  v_max3_u32 v196, v196, v88, v89
  s_waitcnt lgkmcnt(7)
  v_mfma_f32_16x16x32_bf16 v[120:123], v[144:147], v[88:91], v[120:123]
  ds_read_b128 v[176:179], v216 offset:31744
  v_max3_u32 v196, v196, v90, v91
  s_waitcnt lgkmcnt(7)
  v_mfma_f32_16x16x32_bf16 v[124:127], v[148:151], v[88:91], v[124:127]
  ds_read_b128 v[180:183], v217 offset:30720
  s_waitcnt lgkmcnt(7)
  v_mfma_f32_16x16x32_bf16 v[128:131], v[152:155], v[88:91], v[128:131]
  ds_read_b128 v[184:187], v217 offset:31744
  s_add_u32 m0, s32, 16384
  s_nop 0
  buffer_load_dwordx4 v3, s[12:15], s62 offen offset:0 lds
  s_waitcnt lgkmcnt(7)
  v_mfma_f32_16x16x32_bf16 v[132:135], v[156:159], v[88:91], v[132:135]
  ds_read_b128 v[140:143], v223 offset:32768
  s_waitcnt lgkmcnt(7)
  v_mfma_f32_16x16x32_bf16 v[136:139], v[160:163], v[88:91], v[136:139]
  ds_read_b128 v[144:147], v223 offset:33792
  s_add_u32 m0, s32, 20480
  s_nop 0
  buffer_load_dwordx4 v3, s[16:19], s62 offen offset:0 lds
  s_waitcnt vmcnt(14) lgkmcnt(7)
  v_mfma_f32_16x16x32_bf16 v[116:119], v[164:167], v[92:95], v[116:119]
  ds_read_b128 v[148:151], v216 offset:32768
  v_max3_u32 v196, v196, v92, v93
  s_waitcnt lgkmcnt(7)
  v_mfma_f32_16x16x32_bf16 v[120:123], v[168:171], v[92:95], v[120:123]
  ds_read_b128 v[152:155], v216 offset:33792
  v_max3_u32 v196, v196, v94, v95
  s_waitcnt lgkmcnt(7)
  v_mfma_f32_16x16x32_bf16 v[124:127], v[172:175], v[92:95], v[124:127]
  ds_read_b128 v[156:159], v217 offset:32768
  s_waitcnt lgkmcnt(7)
  v_mfma_f32_16x16x32_bf16 v[128:131], v[176:179], v[92:95], v[128:131]
  ds_read_b128 v[160:163], v217 offset:33792
  s_add_u32 m0, s32, 24576
  s_nop 0
  buffer_load_dwordx4 v3, s[12:15], s63 offen offset:0 lds
  s_waitcnt lgkmcnt(7)
  v_mfma_f32_16x16x32_bf16 v[132:135], v[180:183], v[92:95], v[132:135]
  ds_read_b128 v[164:167], v223 offset:34816
  s_waitcnt lgkmcnt(7)
  v_mfma_f32_16x16x32_bf16 v[136:139], v[184:187], v[92:95], v[136:139]
  ds_read_b128 v[168:171], v223 offset:35840
  s_add_u32 m0, s32, 28672
  s_nop 0
  buffer_load_dwordx4 v3, s[16:19], s63 offen offset:0 lds
  s_waitcnt vmcnt(15) lgkmcnt(7)
  v_mfma_f32_16x16x32_bf16 v[116:119], v[140:143], v[96:99], v[116:119]
  ds_read_b128 v[172:175], v216 offset:34816
  v_max3_u32 v196, v196, v96, v97
  s_waitcnt lgkmcnt(7)
  v_mfma_f32_16x16x32_bf16 v[120:123], v[144:147], v[96:99], v[120:123]
  ds_read_b128 v[176:179], v216 offset:35840
  v_max3_u32 v196, v196, v98, v99
  s_waitcnt lgkmcnt(7)
  v_mfma_f32_16x16x32_bf16 v[124:127], v[148:151], v[96:99], v[124:127]
  ds_read_b128 v[180:183], v217 offset:34816
  s_waitcnt lgkmcnt(7)
  v_mfma_f32_16x16x32_bf16 v[128:131], v[152:155], v[96:99], v[128:131]
  ds_read_b128 v[184:187], v217 offset:35840
  s_add_u32 m0, s32, 32768
  s_nop 0
  buffer_load_dwordx4 v3, s[12:15], s64 offen offset:0 lds
  s_waitcnt lgkmcnt(7)
  v_mfma_f32_16x16x32_bf16 v[132:135], v[156:159], v[96:99], v[132:135]
  s_waitcnt lgkmcnt(6)
  v_mfma_f32_16x16x32_bf16 v[136:139], v[160:163], v[96:99], v[136:139]
  s_waitcnt vmcnt(15) lgkmcnt(5)
  v_mfma_f32_16x16x32_bf16 v[116:119], v[164:167], v[100:103], v[116:119]
  v_max3_u32 v196, v196, v100, v101
  s_waitcnt lgkmcnt(4)
  v_mfma_f32_16x16x32_bf16 v[120:123], v[168:171], v[100:103], v[120:123]
  v_max3_u32 v196, v196, v102, v103
  s_waitcnt lgkmcnt(3)
  v_mfma_f32_16x16x32_bf16 v[124:127], v[172:175], v[100:103], v[124:127]
  s_waitcnt lgkmcnt(2)
  v_mfma_f32_16x16x32_bf16 v[128:131], v[176:179], v[100:103], v[128:131]
  s_waitcnt lgkmcnt(1)
  v_mfma_f32_16x16x32_bf16 v[132:135], v[180:183], v[100:103], v[132:135]
  s_waitcnt lgkmcnt(0)
  v_mfma_f32_16x16x32_bf16 v[136:139], v[184:187], v[100:103], v[136:139]
  v_cmp_eq_u32 vcc, -1, v196
  s_add_u32 s82, s82, 1
  s_cbranch_vccz ook_21
  s_cmp_lt_u32 s82, 0x10000
  s_cbranch_scc1 redo_18
ook_21:
  s_barrier
  v_cvt_pk_bf16_f32 v116, 0, v116
  v_cvt_pk_bf16_f32 v117, 0, v117
  s_waitcnt vmcnt(14)
  v_lshlrev_b32 v188, 16, v104
  v_and_b32 v189, 0xffff0000, v104
  v_add_f32 v116, v116, v188
  v_add_f32 v117, v117, v189
  v_cvt_pk_bf16_f32 v104, v116, v117
  v_lshlrev_b32 v116, 16, v104
  v_and_b32 v117, 0xffff0000, v104
  v_cvt_pk_bf16_f32 v118, 0, v118
  v_cvt_pk_bf16_f32 v119, 0, v119
  v_lshlrev_b32 v188, 16, v105
  v_and_b32 v189, 0xffff0000, v105
  v_add_f32 v118, v118, v188
  v_add_f32 v119, v119, v189
  v_cvt_pk_bf16_f32 v105, v118, v119
  v_lshlrev_b32 v118, 16, v105
  v_and_b32 v119, 0xffff0000, v105
  v_cvt_pk_bf16_f32 v120, 0, v120
  v_cvt_pk_bf16_f32 v121, 0, v121
  s_waitcnt vmcnt(13)
  v_lshlrev_b32 v188, 16, v106
  v_and_b32 v189, 0xffff0000, v106
  v_add_f32 v120, v120, v188
  v_add_f32 v121, v121, v189
  v_cvt_pk_bf16_f32 v106, v120, v121
  v_lshlrev_b32 v120, 16, v106
  v_and_b32 v121, 0xffff0000, v106
  v_cvt_pk_bf16_f32 v122, 0, v122
  v_cvt_pk_bf16_f32 v123, 0, v123
  v_lshlrev_b32 v188, 16, v107
  v_and_b32 v189, 0xffff0000, v107
  v_add_f32 v122, v122, v188
  v_add_f32 v123, v123, v189
  v_cvt_pk_bf16_f32 v107, v122, v123
  v_lshlrev_b32 v122, 16, v107
  v_and_b32 v123, 0xffff0000, v107
  v_cvt_pk_bf16_f32 v124, 0, v124
  v_cvt_pk_bf16_f32 v125, 0, v125
  s_waitcnt vmcnt(12)
  v_lshlrev_b32 v188, 16, v108
  v_and_b32 v189, 0xffff0000, v108
  v_add_f32 v124, v124, v188
  v_add_f32 v125, v125, v189
  v_cvt_pk_bf16_f32 v108, v124, v125
  v_lshlrev_b32 v124, 16, v108
  v_and_b32 v125, 0xffff0000, v108
  v_cvt_pk_bf16_f32 v126, 0, v126
  v_cvt_pk_bf16_f32 v127, 0, v127
  v_lshlrev_b32 v188, 16, v109
  v_and_b32 v189, 0xffff0000, v109
  v_add_f32 v126, v126, v188
  v_add_f32 v127, v127, v189
  v_cvt_pk_bf16_f32 v109, v126, v127
  v_lshlrev_b32 v126, 16, v109
  v_and_b32 v127, 0xffff0000, v109
  v_cvt_pk_bf16_f32 v128, 0, v128
  v_cvt_pk_bf16_f32 v129, 0, v129
  s_waitcnt vmcnt(11)
  v_lshlrev_b32 v188, 16, v110
  v_and_b32 v189, 0xffff0000, v110
  v_add_f32 v128, v128, v188
  v_add_f32 v129, v129, v189
  v_cvt_pk_bf16_f32 v110, v128, v129
  v_lshlrev_b32 v128, 16, v110
  v_and_b32 v129, 0xffff0000, v110
  v_cvt_pk_bf16_f32 v130, 0, v130
  v_cvt_pk_bf16_f32 v131, 0, v131
  v_lshlrev_b32 v188, 16, v111
  v_and_b32 v189, 0xffff0000, v111
  v_add_f32 v130, v130, v188
  v_add_f32 v131, v131, v189
  v_cvt_pk_bf16_f32 v111, v130, v131
  v_lshlrev_b32 v130, 16, v111
  v_and_b32 v131, 0xffff0000, v111
  v_cvt_pk_bf16_f32 v132, 0, v132
  v_cvt_pk_bf16_f32 v133, 0, v133
  s_waitcnt vmcnt(10)
  v_lshlrev_b32 v188, 16, v112
  v_and_b32 v189, 0xffff0000, v112
  v_add_f32 v132, v132, v188
  v_add_f32 v133, v133, v189
  v_cvt_pk_bf16_f32 v112, v132, v133
  v_lshlrev_b32 v132, 16, v112
  v_and_b32 v133, 0xffff0000, v112
  v_cvt_pk_bf16_f32 v134, 0, v134
  v_cvt_pk_bf16_f32 v135, 0, v135
  v_lshlrev_b32 v188, 16, v113
  v_and_b32 v189, 0xffff0000, v113
  v_add_f32 v134, v134, v188
  v_add_f32 v135, v135, v189
  v_cvt_pk_bf16_f32 v113, v134, v135
  v_lshlrev_b32 v134, 16, v113
  v_and_b32 v135, 0xffff0000, v113
  v_cvt_pk_bf16_f32 v136, 0, v136
  v_cvt_pk_bf16_f32 v137, 0, v137
  s_waitcnt vmcnt(9)
  v_lshlrev_b32 v188, 16, v114
  v_and_b32 v189, 0xffff0000, v114
  v_add_f32 v136, v136, v188
  v_add_f32 v137, v137, v189
  v_cvt_pk_bf16_f32 v114, v136, v137
  v_lshlrev_b32 v136, 16, v114
  v_and_b32 v137, 0xffff0000, v114
  v_cvt_pk_bf16_f32 v138, 0, v138
  v_cvt_pk_bf16_f32 v139, 0, v139
  v_lshlrev_b32 v188, 16, v115
  v_and_b32 v189, 0xffff0000, v115
  v_add_f32 v138, v138, v188
  v_add_f32 v139, v139, v189
  v_cvt_pk_bf16_f32 v115, v138, v139
  v_lshlrev_b32 v138, 16, v115
  v_and_b32 v139, 0xffff0000, v115
  v_add_f32 v188, v116, v117
  v_add_f32 v189, v118, v119
  v_add_f32 v188, v188, v120
  v_add_f32 v189, v189, v121
  v_add_f32 v188, v188, v122
  v_add_f32 v189, v189, v123
  v_add_f32 v188, v188, v124
  v_add_f32 v189, v189, v125
  v_add_f32 v188, v188, v126
  v_add_f32 v189, v189, v127
  v_add_f32 v188, v188, v128
  v_add_f32 v189, v189, v129
  v_add_f32 v188, v188, v130
  v_add_f32 v189, v189, v131
  v_add_f32 v188, v188, v132
  v_add_f32 v189, v189, v133
  v_add_f32 v188, v188, v134
  v_add_f32 v189, v189, v135
  v_add_f32 v188, v188, v136
  v_add_f32 v189, v189, v137
  v_add_f32 v188, v188, v138
  v_add_f32 v189, v189, v139
  v_add_f32 v188, v188, v189
  v_mov_b32 v190, v188
  s_nop 1
  v_permlane16_swap_b32 v188, v190
  v_add_f32 v188, v188, v190
  v_mov_b32 v190, v188
  s_nop 1
  v_permlane32_swap_b32 v188, v190
  v_add_f32 v188, v188, v190
  v_mul_f32 v190, 0x3c2aaaab, v188
  v_sub_f32 v191, v116, v190
  v_sub_f32 v192, v117, v190
  v_mul_f32 v189, v191, v191
  v_mul_f32 v193, v192, v192
  v_sub_f32 v191, v118, v190
  v_sub_f32 v192, v119, v190
  v_fmac_f32 v189, v191, v191
  v_fmac_f32 v193, v192, v192
  v_sub_f32 v191, v120, v190
  v_sub_f32 v192, v121, v190
  v_fmac_f32 v189, v191, v191
  v_fmac_f32 v193, v192, v192
  v_sub_f32 v191, v122, v190
  v_sub_f32 v192, v123, v190
  v_fmac_f32 v189, v191, v191
  v_fmac_f32 v193, v192, v192
  v_sub_f32 v191, v124, v190
  v_sub_f32 v192, v125, v190
  v_fmac_f32 v189, v191, v191
  v_fmac_f32 v193, v192, v192
  v_sub_f32 v191, v126, v190
  v_sub_f32 v192, v127, v190
  v_fmac_f32 v189, v191, v191
  v_fmac_f32 v193, v192, v192
  v_sub_f32 v191, v128, v190
  v_sub_f32 v192, v129, v190
  v_fmac_f32 v189, v191, v191
  v_fmac_f32 v193, v192, v192
  v_sub_f32 v191, v130, v190
  v_sub_f32 v192, v131, v190
  v_fmac_f32 v189, v191, v191
  v_fmac_f32 v193, v192, v192
  v_sub_f32 v191, v132, v190
  v_sub_f32 v192, v133, v190
  v_fmac_f32 v189, v191, v191
  v_fmac_f32 v193, v192, v192
  v_sub_f32 v191, v134, v190
  v_sub_f32 v192, v135, v190
  v_fmac_f32 v189, v191, v191
  v_fmac_f32 v193, v192, v192
  v_sub_f32 v191, v136, v190
  v_sub_f32 v192, v137, v190
  v_fmac_f32 v189, v191, v191
  v_fmac_f32 v193, v192, v192
  v_sub_f32 v191, v138, v190
  v_sub_f32 v192, v139, v190
  v_fmac_f32 v189, v191, v191
  v_fmac_f32 v193, v192, v192
  v_add_f32 v189, v189, v193
  v_mov_b32 v190, v189
  s_nop 1
  v_permlane16_swap_b32 v189, v190
  v_add_f32 v189, v189, v190
  v_mov_b32 v190, v189
  s_nop 1
  v_permlane32_swap_b32 v189, v190
  v_add_f32 v189, v189, v190
  s_mov_b64 exec, 0xffff
  buffer_store_dwordx2 v[188:189], v218, s[8:11], s56 offen sc1
  s_mov_b64 exec, -1
  s_add_u32 m0, s32, 36864
  s_nop 0
  buffer_load_dwordx4 v3, s[16:19], s64 offen offset:0 lds
  s_add_u32 m0, s32, 40960
  s_nop 0
  buffer_load_dwordx4 v3, s[12:15], s65 offen offset:0 lds
  s_add_u32 m0, s32, 45056
  s_nop 0
  buffer_load_dwordx4 v3, s[16:19], s65 offen offset:0 lds
  s_add_u32 m0, s32, 49152
  s_nop 0
  buffer_load_dwordx4 v3, s[12:15], s66 offen offset:0 lds
  s_add_u32 m0, s32, 53248
  s_nop 0
  buffer_load_dwordx4 v3, s[16:19], s66 offen offset:0 lds
  s_add_u32 m0, s32, 57344
  s_nop 0
  buffer_load_dwordx4 v3, s[12:15], s67 offen offset:0 lds
  s_add_u32 m0, s32, 61440
  s_nop 0
  buffer_load_dwordx4 v3, s[16:19], s67 offen offset:0 lds
  v_lshrrev_b32 v24, 3, v2
  v_and_b32 v25, 6, v24
  v_xor_b32 v25, v25, v2
  v_and_b32 v25, 7, v25
  v_mul_u32_u24 v4, 1152, v24
  v_lshl_add_u32 v4, v25, 4, v4
  v_lshlrev_b32 v5, 4, v2
  v_lshrrev_b32 v24, 2, v2
  v_lshrrev_b32 v25, 3, v2
  v_and_b32 v25, 2, v25
  v_xor_b32 v25, v25, v2
  v_and_b32 v25, 3, v25
  v_mul_u32_u24 v6, 9216, v24
  v_lshl_add_u32 v6, v25, 4, v6
  v_mul_u32_u24 v22, 1152, v24
  v_lshl_add_u32 v22, v25, 4, v22
  s_lshl_b32 s30, s29, 6
  s_add_u32 s31, s30, 32
  v_lshrrev_b32 v24, 2, v2
  v_and_b32 v25, 6, v24
  v_lshlrev_b32 v25, 4, v25
  v_lshlrev_b32 v24, 7, v24
  v_and_b32 v26, 3, v2
  v_lshl_add_u32 v24, v26, 3, v24
  v_xor_b32 v8, s30, v25
  v_add_u32 v8, v8, v24
  v_xor_b32 v9, s31, v25
  v_add_u32 v9, v9, v24
  v_lshrrev_b32 v24, 2, v2
  v_lshlrev_b32 v24, 6, v24
  v_bfe_u32 v25, v2, 4, 1
  v_xor_b32 v25, s29, v25
  v_lshl_add_u32 v24, v25, 5, v24
  v_and_b32 v25, 3, v2
  v_lshl_add_u32 v14, v25, 3, v24
  s_lshl_b32 s30, s28, 12
  v_add_u32 v17, s30, v5
  v_add_u32 v10, 65536, v8
  v_add_u32 v11, 65536, v9
  v_add_u32 v15, 65536, v14
  v_add_u32 v18, 65536, v17
  v_add_u32 v12, 131072, v8
  v_add_u32 v13, 131072, v9
  v_add_u32 v16, 131072, v14
  v_add_u32 v19, 131072, v17
  s_lshl_b32 s30, s24, 12
  s_add_u32 s30, s30, 65536
  v_add_u32 v20, s30, v5
  s_lshl_b32 s30, s29, 3
  v_add_u32 v21, s30, v18
  s_mov_b32 s33, 0xffff0000
  s_lshl_b32 s32, s24, 10
  s_mov_b32 s20, s44
  s_mov_b32 s21, s45
  s_mov_b32 s22, 5308416
  s_mov_b32 s23, 0x20000
  s_cmp_eq_u32 s29, 0
  s_cselect_b32 s52, s40, s42
  s_cselect_b32 s53, s41, s43
  s_mov_b32 s54, 5308416
  s_mov_b32 s55, 0x20000
  s_xor_b32 s30, s27, 1
  s_lshl_b32 s30, s30, 9
  s_mul_i32 s31, s28, 147456
  s_add_u32 s30, s30, s31
  v_add_u32 v6, s30, v6
  s_lshl_b32 s30, s26, 3
  s_add_u32 s31, s30, s24
  s_mul_i32 s39, s31, 18432
  s_add_u32 s39, s39, 9437184
  v_and_b32 v222, 7, v2
  v_min_u32 v222, 5, v222
  v_lshlrev_b32 v222, 7, v222
  v_bfe_u32 v31, v2, 3, 1
  v_mul_u32_u24 v31, 3072, v31
  v_add_u32 v222, v31, v222
  s_lshl_b32 s56, s26, 3
  s_add_u32 s56, s56, s24
  s_mul_i32 s56, s56, 768
  s_add_u32 s56, s56, 54763520
  s_add_u32 s56, s56, s3
  s_mov_b32 s48, -1
  s_mov_b32 s49, 0
  s_mov_b32 s57, 0
  buffer_load_dwordx2 v[208:209], v218, s[8:11], s86 offen sc1
  buffer_load_dwordx2 v[210:211], v219, s[8:11], s86 offen sc1
poll_22:
  buffer_load_dwordx2 v[212:213], v218, s[8:11], s86 offen sc1
  buffer_load_dwordx2 v[214:215], v219, s[8:11], s86 offen sc1
  s_waitcnt vmcnt(2)
  v_max_u32 v190, v209, v211
  v_cmp_eq_u32 vcc, -1, v190
  s_add_u32 s57, s57, 1
  s_cbranch_vccz ph_24
  buffer_load_dwordx2 v[208:209], v218, s[8:11], s86 offen sc1
  buffer_load_dwordx2 v[210:211], v219, s[8:11], s86 offen sc1
  s_waitcnt vmcnt(2)
  v_max_u32 v190, v213, v215
  v_cmp_eq_u32 vcc, -1, v190
  s_add_u32 s57, s57, 1
  s_cbranch_vccz ph_25
  s_cmp_lt_u32 s57, 0x40000
  s_cbranch_scc1 poll_22
ph_25:
  v_mov_b32 v196, v212
  v_mov_b32 v197, v213
  v_cndmask_b32 v198, 0, v214, s[48:49]
  v_cndmask_b32 v199, 0, v215, s[48:49]
  s_branch polld_23
ph_24:
  v_mov_b32 v196, v208
  v_mov_b32 v197, v209
  v_cndmask_b32 v198, 0, v210, s[48:49]
  v_cndmask_b32 v199, 0, v211, s[48:49]
polld_23:
  v_add_f32 v190, v196, v198
  v_add_f32 v189, v197, v199
  v_mov_b32 v192, v190
  s_nop 1
  v_permlane16_swap_b32 v190, v192
  v_add_f32 v190, v190, v192
  v_mov_b32 v192, v190
  s_nop 1
  v_permlane32_swap_b32 v190, v192
  v_add_f32 v190, v190, v192
  v_mul_f32 v190, 0x3ae38e39, v190
  s_mov_b32 s58, 0x3c2aaaab
  s_mov_b32 s59, 0x42c00000
  v_fma_f32 v191, v196, s58, -v190
  v_fma_f32 v192, v198, s58, -v190
  v_cndmask_b32 v192, 0, v192, s[48:49]
  v_mul_f32 v191, v191, v191
  v_fmac_f32 v191, v192, v192
  v_fma_f32 v191, v191, s59, v189
  v_mov_b32 v192, v191
  s_nop 1
  v_permlane16_swap_b32 v191, v192
  v_add_f32 v191, v191, v192
  v_mov_b32 v192, v191
  s_nop 1
  v_permlane32_swap_b32 v191, v192
  v_add_f32 v191, v191, v192
  v_mul_f32 v191, 0x3ae38e39, v191
  v_cvt_pk_bf16_f32 v190, 0, v190
  v_cvt_pk_bf16_f32 v191, 0, v191
  v_add_f32 v191, 0x3727c5ac, v191
  v_cvt_pk_bf16_f32 v191, 0, v191
  v_sqrt_f32 v191, v191
  s_nop 0
  v_cvt_pk_bf16_f32 v191, 0, v191
  v_rcp_f32 v191, v191
  v_sub_f32 v116, v116, v190
  v_sub_f32 v117, v117, v190
  v_cvt_pk_bf16_f32 v188, v116, v117
  v_lshlrev_b32 v116, 16, v188
  v_and_b32 v117, 0xffff0000, v188
  v_mul_f32 v116, v116, v191
  v_mul_f32 v117, v117, v191
  v_cvt_pk_bf16_f32 v196, v116, v117
  v_sub_f32 v118, v118, v190
  v_sub_f32 v119, v119, v190
  v_cvt_pk_bf16_f32 v188, v118, v119
  v_lshlrev_b32 v118, 16, v188
  v_and_b32 v119, 0xffff0000, v188
  v_mul_f32 v118, v118, v191
  v_mul_f32 v119, v119, v191
  v_cvt_pk_bf16_f32 v197, v118, v119
  v_sub_f32 v120, v120, v190
  v_sub_f32 v121, v121, v190
  v_cvt_pk_bf16_f32 v188, v120, v121
  v_lshlrev_b32 v120, 16, v188
  v_and_b32 v121, 0xffff0000, v188
  v_mul_f32 v120, v120, v191
  v_mul_f32 v121, v121, v191
  v_cvt_pk_bf16_f32 v198, v120, v121
  v_sub_f32 v122, v122, v190
  v_sub_f32 v123, v123, v190
  v_cvt_pk_bf16_f32 v188, v122, v123
  v_lshlrev_b32 v122, 16, v188
  v_and_b32 v123, 0xffff0000, v188
  v_mul_f32 v122, v122, v191
  v_mul_f32 v123, v123, v191
  v_cvt_pk_bf16_f32 v199, v122, v123
  v_sub_f32 v124, v124, v190
  v_sub_f32 v125, v125, v190
  v_cvt_pk_bf16_f32 v188, v124, v125
  v_lshlrev_b32 v124, 16, v188
  v_and_b32 v125, 0xffff0000, v188
  v_mul_f32 v124, v124, v191
  v_mul_f32 v125, v125, v191
  v_cvt_pk_bf16_f32 v200, v124, v125
  v_sub_f32 v126, v126, v190
  v_sub_f32 v127, v127, v190
  v_cvt_pk_bf16_f32 v188, v126, v127
  v_lshlrev_b32 v126, 16, v188
  v_and_b32 v127, 0xffff0000, v188
  v_mul_f32 v126, v126, v191
  v_mul_f32 v127, v127, v191
  v_cvt_pk_bf16_f32 v201, v126, v127
  v_sub_f32 v128, v128, v190
  v_sub_f32 v129, v129, v190
  v_cvt_pk_bf16_f32 v188, v128, v129
  v_lshlrev_b32 v128, 16, v188
  v_and_b32 v129, 0xffff0000, v188
  v_mul_f32 v128, v128, v191
  v_mul_f32 v129, v129, v191
  v_cvt_pk_bf16_f32 v202, v128, v129
  v_sub_f32 v130, v130, v190
  v_sub_f32 v131, v131, v190
  v_cvt_pk_bf16_f32 v188, v130, v131
  v_lshlrev_b32 v130, 16, v188
  v_and_b32 v131, 0xffff0000, v188
  v_mul_f32 v130, v130, v191
  v_mul_f32 v131, v131, v191
  v_cvt_pk_bf16_f32 v203, v130, v131
  v_sub_f32 v132, v132, v190
  v_sub_f32 v133, v133, v190
  v_cvt_pk_bf16_f32 v188, v132, v133
  v_lshlrev_b32 v132, 16, v188
  v_and_b32 v133, 0xffff0000, v188
  v_mul_f32 v132, v132, v191
  v_mul_f32 v133, v133, v191
  v_cvt_pk_bf16_f32 v204, v132, v133
  v_sub_f32 v134, v134, v190
  v_sub_f32 v135, v135, v190
  v_cvt_pk_bf16_f32 v188, v134, v135
  v_lshlrev_b32 v134, 16, v188
  v_and_b32 v135, 0xffff0000, v188
  v_mul_f32 v134, v134, v191
  v_mul_f32 v135, v135, v191
  v_cvt_pk_bf16_f32 v205, v134, v135
  v_sub_f32 v136, v136, v190
  v_sub_f32 v137, v137, v190
  v_cvt_pk_bf16_f32 v188, v136, v137
  v_lshlrev_b32 v136, 16, v188
  v_and_b32 v137, 0xffff0000, v188
  v_mul_f32 v136, v136, v191
  v_mul_f32 v137, v137, v191
  v_cvt_pk_bf16_f32 v206, v136, v137
  v_sub_f32 v138, v138, v190
  v_sub_f32 v139, v139, v190
  v_cvt_pk_bf16_f32 v188, v138, v139
  v_lshlrev_b32 v138, 16, v188
  v_and_b32 v139, 0xffff0000, v188
  v_mul_f32 v138, v138, v191
  v_mul_f32 v139, v139, v191
  v_cvt_pk_bf16_f32 v207, v138, v139
  buffer_store_dwordx4 v[196:199], v5, s[8:11], s85 offen offset:0 sc1
  buffer_store_dwordx4 v[200:203], v5, s[8:11], s85 offen offset:1024 sc1
  buffer_store_dwordx4 v[204:207], v5, s[8:11], s85 offen offset:2048 sc1
  v_mov_b32 v31, 0
  s_mov_b64 exec, 1
  s_waitcnt vmcnt(0)
  buffer_store_dword v31, off, s[8:11], s34 sc1
  s_mov_b64 exec, -1
  v_add_u32 v31, s84, v5
  s_add_u32 m0, s32, 65536
  s_nop 0
  buffer_load_dwordx4 v3, s[12:15], s68 offen offset:0 lds
  s_add_u32 m0, s32, 69632
  s_nop 0
  buffer_load_dwordx4 v3, s[16:19], s68 offen offset:0 lds
  s_add_u32 m0, s32, 73728
  s_nop 0
  buffer_load_dwordx4 v3, s[12:15], s69 offen offset:0 lds
  s_add_u32 m0, s32, 77824
  s_nop 0
  buffer_load_dwordx4 v3, s[16:19], s69 offen offset:0 lds
  s_add_u32 m0, s32, 81920
  s_nop 0
  buffer_load_dwordx4 v3, s[12:15], s70 offen offset:0 lds
  s_add_u32 m0, s32, 86016
  s_nop 0
  buffer_load_dwordx4 v3, s[16:19], s70 offen offset:0 lds
  s_branch xpoll_19
spare_13:
  s_waitcnt vmcnt(0)
  s_barrier
  v_lshrrev_b32 v24, 3, v2
  v_and_b32 v25, 6, v24
  v_xor_b32 v25, v25, v2
  v_and_b32 v25, 7, v25
  v_mul_u32_u24 v3, 9216, v24
  v_lshl_add_u32 v3, v25, 4, v3
  s_mov_b32 s12, s40
  s_mov_b32 s13, s41
  s_mov_b32 s14, 5308416
  s_mov_b32 s15, 0x20000
  s_mov_b32 s16, s42
  s_mov_b32 s17, s43
  s_mov_b32 s18, 5308416
  s_mov_b32 s19, 0x20000
  s_mul_i32 s35, s25, 576
  s_lshl_b32 s30, s27, 6
  s_mul_i32 s31, s24, 73728
  s_add_u32 s30, s30, s31
  v_add_u32 v3, s30, v3
  s_mov_b32 s60, s35
  s_add_u32 s61, s60, 294912
  s_add_u32 s62, s61, 294912
  s_add_u32 s63, s62, 294912
  s_add_u32 s64, s63, 294912
  s_add_u32 s65, s64, 294912
  s_add_u32 s66, s65, 294912
  s_add_u32 s67, s66, 294912
  s_add_u32 s68, s67, 294912
  s_add_u32 s69, s68, 294912
  s_add_u32 s70, s69, 294912
  s_add_u32 s71, s70, 294912
  s_add_u32 s72, s71, 294912
  s_add_u32 s73, s72, 294912
  s_add_u32 s74, s73, 294912
  s_add_u32 s75, s74, 294912
  s_add_u32 s76, s75, 294912
  s_add_u32 s77, s76, 294912
  v_lshrrev_b32 v24, 3, v2
  v_and_b32 v25, 6, v24
  v_xor_b32 v25, v25, v2
  v_and_b32 v25, 7, v25
  v_mul_u32_u24 v4, 1152, v24
  v_lshl_add_u32 v4, v25, 4, v4
  v_lshlrev_b32 v5, 4, v2
  v_lshrrev_b32 v24, 2, v2
  v_lshrrev_b32 v25, 3, v2
  v_and_b32 v25, 2, v25
  v_xor_b32 v25, v25, v2
  v_and_b32 v25, 3, v25
  v_mul_u32_u24 v6, 9216, v24
  v_lshl_add_u32 v6, v25, 4, v6
  v_mul_u32_u24 v22, 1152, v24
  v_lshl_add_u32 v22, v25, 4, v22
  s_lshl_b32 s30, s29, 6
  s_add_u32 s31, s30, 32
  v_lshrrev_b32 v24, 2, v2
  v_and_b32 v25, 6, v24
  v_lshlrev_b32 v25, 4, v25
  v_lshlrev_b32 v24, 7, v24
  v_and_b32 v26, 3, v2
  v_lshl_add_u32 v24, v26, 3, v24
  v_xor_b32 v8, s30, v25
  v_add_u32 v8, v8, v24
  v_xor_b32 v9, s31, v25
  v_add_u32 v9, v9, v24
  v_lshrrev_b32 v24, 2, v2
  v_lshlrev_b32 v24, 6, v24
  v_bfe_u32 v25, v2, 4, 1
  v_xor_b32 v25, s29, v25
  v_lshl_add_u32 v24, v25, 5, v24
  v_and_b32 v25, 3, v2
  v_lshl_add_u32 v14, v25, 3, v24
  s_lshl_b32 s30, s28, 12
  v_add_u32 v17, s30, v5
  v_add_u32 v10, 65536, v8
  v_add_u32 v11, 65536, v9
  v_add_u32 v15, 65536, v14
  v_add_u32 v18, 65536, v17
  v_add_u32 v12, 131072, v8
  v_add_u32 v13, 131072, v9
  v_add_u32 v16, 131072, v14
  v_add_u32 v19, 131072, v17
  s_lshl_b32 s30, s24, 12
  s_add_u32 s30, s30, 65536
  v_add_u32 v20, s30, v5
  s_lshl_b32 s30, s29, 3
  v_add_u32 v21, s30, v18
  s_mov_b32 s33, 0xffff0000
  s_lshl_b32 s32, s24, 10
  s_mov_b32 s20, s44
  s_mov_b32 s21, s45
  s_mov_b32 s22, 5308416
  s_mov_b32 s23, 0x20000
  s_cmp_eq_u32 s29, 0
  s_cselect_b32 s52, s40, s42
  s_cselect_b32 s53, s41, s43
  s_mov_b32 s54, 5308416
  s_mov_b32 s55, 0x20000
  s_xor_b32 s30, s27, 1
  s_lshl_b32 s30, s30, 9
  s_mul_i32 s31, s28, 147456
  s_add_u32 s30, s30, s31
  v_add_u32 v6, s30, v6
  s_lshl_b32 s30, s26, 3
  s_add_u32 s31, s30, s24
  s_mul_i32 s39, s31, 18432
  s_add_u32 s39, s39, 9437184
  v_and_b32 v222, 7, v2
  v_min_u32 v222, 5, v222
  v_lshlrev_b32 v222, 7, v222
  v_bfe_u32 v31, v2, 3, 1
  v_mul_u32_u24 v31, 3072, v31
  v_add_u32 v222, v31, v222
  s_lshl_b32 s56, s26, 3
  s_add_u32 s56, s56, s24
  s_mul_i32 s56, s56, 768
  s_add_u32 s56, s56, 54763520
  s_add_u32 s56, s56, s3
  v_bfrev_b32 v31, 1
  s_cmp_eq_u32 s86, 0
  s_cbranch_scc1 nowt_26
  s_sub_u32 s6, s2, 192
  s_lshr_b32 s6, s6, 3
  s_lshl_b32 s6, s6, 2
  s_add_u32 s6, s6, s24
  s_and_b32 s7, s2, 7
  s_mul_i32 s47, s6, 165888
  s_mul_i32 s48, s7, 1152
  s_add_u32 s47, s47, s48
  s_mul_i32 s48, s6, 20736
  s_mul_i32 s49, s7, 663552
  s_add_u32 s48, s48, s49
  v_add_u32 v40, 0, v2
  v_min_u32 v40, 161, v40
  v_mul_u32_u24 v41, 57, v40
  v_lshrrev_b32 v41, 9, v41
  v_lshlrev_b32 v36, 7, v40
  v_mul_u32_u24 v42, 9, v41
  v_sub_u32 v40, v40, v42
  v_mul_u32_u24 v41, 9216, v41
  v_lshl_add_u32 v32, v40, 7, v41
  v_add_u32 v40, 64, v2
  v_min_u32 v40, 161, v40
  v_mul_u32_u24 v41, 57, v40
  v_lshrrev_b32 v41, 9, v41
  v_lshlrev_b32 v37, 7, v40
  v_mul_u32_u24 v42, 9, v41
  v_sub_u32 v40, v40, v42
  v_mul_u32_u24 v41, 9216, v41
  v_lshl_add_u32 v33, v40, 7, v41
  v_add_u32 v40, 128, v2
  v_min_u32 v40, 161, v40
  v_mul_u32_u24 v41, 57, v40
  v_lshrrev_b32 v41, 9, v41
  v_lshlrev_b32 v38, 7, v40
  v_mul_u32_u24 v42, 9, v41
  v_sub_u32 v40, v40, v42
  v_mul_u32_u24 v41, 9216, v41
  v_lshl_add_u32 v34, v40, 7, v41
  buffer_load_dword v43, v32, s[12:15], s47 offen
  buffer_load_dword v43, v33, s[12:15], s47 offen
  buffer_load_dword v43, v34, s[12:15], s47 offen
  buffer_load_dword v43, v32, s[16:19], s47 offen
  buffer_load_dword v43, v33, s[16:19], s47 offen
  buffer_load_dword v43, v34, s[16:19], s47 offen
nowt_26:
  s_add_u32 m0, s32, 0
  s_nop 0
  buffer_load_dwordx4 v3, s[12:15], s60 offen offset:0 lds
  s_add_u32 m0, s32, 4096
  s_nop 0
  buffer_load_dwordx4 v3, s[16:19], s60 offen offset:0 lds
  s_add_u32 m0, s32, 8192
  s_nop 0
  buffer_load_dwordx4 v3, s[12:15], s61 offen offset:0 lds
  s_add_u32 m0, s32, 12288
  s_nop 0
  buffer_load_dwordx4 v3, s[16:19], s61 offen offset:0 lds
  s_add_u32 m0, s32, 16384
  s_nop 0
  buffer_load_dwordx4 v3, s[12:15], s62 offen offset:0 lds
  s_add_u32 m0, s32, 20480
  s_nop 0
  buffer_load_dwordx4 v3, s[16:19], s62 offen offset:0 lds
  s_add_u32 m0, s32, 24576
  s_nop 0
  buffer_load_dwordx4 v3, s[12:15], s63 offen offset:0 lds
  s_add_u32 m0, s32, 28672
  s_nop 0
  buffer_load_dwordx4 v3, s[16:19], s63 offen offset:0 lds
  s_add_u32 m0, s32, 32768
  s_nop 0
  buffer_load_dwordx4 v3, s[12:15], s64 offen offset:0 lds
  s_add_u32 m0, s32, 36864
  s_nop 0
  buffer_load_dwordx4 v3, s[16:19], s64 offen offset:0 lds
  s_add_u32 m0, s32, 40960
  s_nop 0
  buffer_load_dwordx4 v3, s[12:15], s65 offen offset:0 lds
  s_add_u32 m0, s32, 45056
  s_nop 0
  buffer_load_dwordx4 v3, s[16:19], s65 offen offset:0 lds
  s_add_u32 m0, s32, 49152
  s_nop 0
  buffer_load_dwordx4 v3, s[12:15], s66 offen offset:0 lds
  s_add_u32 m0, s32, 53248
  s_nop 0
  buffer_load_dwordx4 v3, s[16:19], s66 offen offset:0 lds
  s_add_u32 m0, s32, 57344
  s_nop 0
  buffer_load_dwordx4 v3, s[12:15], s67 offen offset:0 lds
  s_add_u32 m0, s32, 61440
  s_nop 0
  buffer_load_dwordx4 v3, s[16:19], s67 offen offset:0 lds
  s_add_u32 m0, s32, 65536
  s_nop 0
  buffer_load_dwordx4 v3, s[12:15], s68 offen offset:0 lds
  s_add_u32 m0, s32, 69632
  s_nop 0
  buffer_load_dwordx4 v3, s[16:19], s68 offen offset:0 lds
  s_add_u32 m0, s32, 73728
  s_nop 0
  buffer_load_dwordx4 v3, s[12:15], s69 offen offset:0 lds
  s_add_u32 m0, s32, 77824
  s_nop 0
  buffer_load_dwordx4 v3, s[16:19], s69 offen offset:0 lds
  s_add_u32 m0, s32, 81920
  s_nop 0
  buffer_load_dwordx4 v3, s[12:15], s70 offen offset:0 lds
  s_add_u32 m0, s32, 86016
  s_nop 0
  buffer_load_dwordx4 v3, s[16:19], s70 offen offset:0 lds
xpoll_19:
  s_mul_i32 s6, s24, 9216
  s_mul_i32 s7, s27, 640
  s_add_u32 s6, s6, s7
  v_add_u32 v4, s6, v4
  s_mul_i32 s6, s28, 18432
  s_lshl_b32 s7, s27, 6
  s_add_u32 s6, s6, s7
  s_add_u32 s6, s6, 512
  v_add_u32 v22, s6, v22
  s_xor_b32 s6, s25, 0
  s_mul_i32 s6, s6, 331776
  s_xor_b32 s7, s27, 0
  s_mul_i32 s7, s7, 36864
  s_add_u32 s78, s6, s7
  s_xor_b32 s7, s27, 1
  s_mul_i32 s7, s7, 294912
  s_add_u32 s86, s6, s7
  s_add_u32 s79, s78, 36864
  s_add_u32 s80, s79, 36864
  s_add_u32 s81, s80, 36864
  s_add_u32 s82, s81, 36864
  s_add_u32 s83, s82, 36864
  s_add_u32 s84, s83, 36864
  s_add_u32 s85, s84, 36864
  s_xor_b32 s6, s25, 1
  s_mul_i32 s6, s6, 331776
  s_xor_b32 s7, s27, 1
  s_mul_i32 s7, s7, 36864
  s_add_u32 s40, s6, s7
  s_xor_b32 s7, s27, 0
  s_mul_i32 s7, s7, 294912
  s_add_u32 s50, s6, s7
  s_add_u32 s41, s40, 36864
  s_add_u32 s42, s41, 36864
  s_add_u32 s43, s42, 36864
  s_add_u32 s44, s43, 36864
  s_add_u32 s45, s44, 36864
  s_add_u32 s48, s45, 36864
  s_add_u32 s49, s48, 36864
  s_cmp_eq_u32 s29, 0
  s_cselect_b32 s34, s78, s40
  s_cselect_b32 s36, s86, s50
  s_lshl_b32 s6, s26, 3
  s_lshl_b32 s7, s28, 2
  s_add_u32 s7, s6, s7
  s_mul_i32 s7, s7, 18432
  s_lshr_b32 s6, s25, 1
  s_mul_i32 s46, s6, 2359296
  s_add_u32 s46, s46, s7
  s_add_u32 s46, s46, 12460032
  s_mul_i32 s7, s29, 18432
  s_add_u32 s51, s46, s7
  s_lshl_b32 s7, s27, 10
  s_add_u32 s51, s51, s7
  s_add_u32 s51, s51, 8192
  s_mul_i32 s7, s27, 10
  s_add_u32 s7, s7, s29
  s_lshl_b32 s7, s7, 10
  s_add_u32 s46, s46, s7
  s_lshl_b32 s6, s26, 4
  s_add_u32 s6, s6, s25
  s_lshl_b32 s7, s6, 7
  s_add_u32 s7, s7, 54730752
  s_add_u32 s7, s7, s3
  v_mov_b32 v7, s7
  v_cmp_eq_u32 vcc, 0, v0
  s_nop 1
  v_cndmask_b32 v7, -1, v7, vcc
  s_xor_b32 s59, s7, 128
  s_mul_i32 s57, s6, 73728
  s_xor_b32 s6, s6, 1
  s_mul_i32 s58, s6, 73728
  s_lshl_b32 s7, s28, 12
  s_add_u32 s7, s7, 31334400
  s_add_u32 s57, s57, s7
  s_add_u32 s37, s58, s32
  s_add_u32 s37, s37, 31334400
  s_add_u32 s58, s58, s7
  s_add_u32 s58, s58, 73728
  s_lshl_b32 s7, s29, 11
  s_add_u32 s38, s57, s7
  s_add_u32 s38, s38, 65536
  s_lshl_b32 s7, s29, 13
  s_add_u32 s57, s57, s7
  s_mov_b32 s47, 0
  s_mov_b64 exec, 0xffff
xp_27:
  buffer_load_dword v220, v222, s[8:11], s56 offen sc1
  s_waitcnt vmcnt(0)
  v_cmp_eq_u32 vcc, -1, v220
  s_add_u32 s47, s47, 1
  s_cbranch_vccz xpd_28
  buffer_load_dword v221, v222, s[8:11], s56 offen sc1
  s_waitcnt vmcnt(0)
  v_cmp_eq_u32 vcc, -1, v221
  s_add_u32 s47, s47, 1
  s_cbranch_vccz xpd_28
  s_cmp_lt_u32 s47, 0x40000
  s_cbranch_scc1 xp_27
xpd_28:
  s_mov_b64 exec, -1
  s_add_u32 s47, s39, 0
  s_add_u32 m0, s32, 90112
  s_nop 0
  buffer_load_dwordx4 v5, s[8:11], s47 offen offset:0 sc1 lds
  s_add_u32 s47, s39, 73728
  s_add_u32 m0, s32, 94208
  s_nop 0
  buffer_load_dwordx4 v5, s[8:11], s47 offen offset:0 sc1 lds
  s_add_u32 s47, s39, 1024
  s_add_u32 m0, s32, 98304
  s_nop 0
  buffer_load_dwordx4 v5, s[8:11], s47 offen offset:0 sc1 lds
  s_add_u32 s47, s39, 74752
  s_add_u32 m0, s32, 102400
  s_nop 0
  buffer_load_dwordx4 v5, s[8:11], s47 offen offset:0 sc1 lds
  s_add_u32 s47, s39, 2048
  s_add_u32 m0, s32, 106496
  s_nop 0
  buffer_load_dwordx4 v5, s[8:11], s47 offen offset:0 sc1 lds
  s_add_u32 s47, s39, 75776
  s_add_u32 m0, s32, 110592
  s_nop 0
  buffer_load_dwordx4 v5, s[8:11], s47 offen offset:0 sc1 lds
  s_add_u32 s47, s39, 3072
  s_add_u32 m0, s32, 114688
  s_nop 0
  buffer_load_dwordx4 v5, s[8:11], s47 offen offset:0 sc1 lds
  s_add_u32 s47, s39, 76800
  s_add_u32 m0, s32, 118784
  s_nop 0
  buffer_load_dwordx4 v5, s[8:11], s47 offen offset:0 sc1 lds
  s_add_u32 s47, s39, 4096
  s_add_u32 m0, s32, 122880
  s_nop 0
  buffer_load_dwordx4 v5, s[8:11], s47 offen offset:0 sc1 lds
  s_add_u32 s47, s39, 77824
  s_add_u32 m0, s32, 126976
  s_nop 0
  buffer_load_dwordx4 v5, s[8:11], s47 offen offset:0 sc1 lds
  s_add_u32 s47, s39, 5120
  s_add_u32 m0, s32, 131072
  s_nop 0
  buffer_load_dwordx4 v5, s[8:11], s47 offen offset:0 sc1 lds
  s_add_u32 s47, s39, 78848
  s_add_u32 m0, s32, 135168
  s_nop 0
  buffer_load_dwordx4 v5, s[8:11], s47 offen offset:0 sc1 lds
  s_add_u32 s47, s39, 6144
  s_add_u32 m0, s32, 139264
  s_nop 0
  buffer_load_dwordx4 v5, s[8:11], s47 offen offset:0 sc1 lds
  s_add_u32 s47, s39, 79872
  s_add_u32 m0, s32, 143360
  s_nop 0
  buffer_load_dwordx4 v5, s[8:11], s47 offen offset:0 sc1 lds
  s_add_u32 s47, s39, 7168
  s_add_u32 m0, s32, 147456
  s_nop 0
  buffer_load_dwordx4 v5, s[8:11], s47 offen offset:0 sc1 lds
  s_add_u32 s47, s39, 80896
  s_add_u32 m0, s32, 151552
  s_nop 0
  buffer_load_dwordx4 v5, s[8:11], s47 offen offset:0 sc1 lds
  s_add_u32 s47, s39, 8192
  s_add_u32 m0, s32, 155648
  s_nop 0
  buffer_load_dwordx4 v5, s[8:11], s47 offen offset:0 sc1 lds
  s_add_u32 s47, s39, 81920
  s_add_u32 m0, s32, 159744
  s_nop 0
  buffer_load_dwordx4 v5, s[8:11], s47 offen offset:0 sc1 lds
  s_waitcnt vmcnt(14)
  s_barrier
  ds_read_b64_tr_b16 v[160:161], v8 offset:0
  ds_read_b64_tr_b16 v[162:163], v8 offset:2048
  ds_read_b128 a[0:3], v18 offset:24576
  ds_read_b128 a[4:7], v18 offset:25600
  ds_read_b128 a[8:11], v18 offset:26624
  ds_read_b128 a[12:15], v18 offset:27648
  ds_read_b128 a[16:19], v18 offset:32768
  ds_read_b64_tr_b16 v[164:165], v9 offset:0
  ds_read_b64_tr_b16 v[166:167], v9 offset:2048
  ds_read_b128 a[20:23], v18 offset:33792
  ds_read_b64_tr_b16 v[168:169], v8 offset:4096
  ds_read_b64_tr_b16 v[170:171], v8 offset:6144
  ds_read_b128 a[24:27], v18 offset:34816
  ds_read_b64_tr_b16 v[172:173], v9 offset:4096
  ds_read_b64_tr_b16 v[174:175], v9 offset:6144
  ds_read_b128 a[28:31], v18 offset:35840
  s_waitcnt lgkmcnt(13)
  v_mfma_f32_16x16x32_bf16 v[32:35], v[160:163], a[0:3], 0
  s_waitcnt vmcnt(12)
  s_barrier
  ds_read_b64_tr_b16 v[176:177], v8 offset:8192
  ds_read_b64_tr_b16 v[178:179], v8 offset:10240
  s_waitcnt lgkmcnt(14)
  v_mfma_f32_16x16x32_bf16 v[36:39], v[160:163], a[4:7], 0
  buffer_store_dwordx4 v[104:107], v31, s[8:11], 0 offen offset:0 sc1
  s_waitcnt lgkmcnt(13)
  v_mfma_f32_16x16x32_bf16 v[40:43], v[160:163], a[8:11], 0
  ds_read_b128 a[32:35], v18 offset:40960
  s_waitcnt lgkmcnt(13)
  v_mfma_f32_16x16x32_bf16 v[44:47], v[160:163], a[12:15], 0
  s_waitcnt lgkmcnt(10)
  v_mfma_f32_16x16x32_bf16 v[48:51], v[164:167], a[0:3], 0
  ds_read_b64_tr_b16 v[180:181], v9 offset:8192
  ds_read_b64_tr_b16 v[182:183], v9 offset:10240
  v_mfma_f32_16x16x32_bf16 v[52:55], v[164:167], a[4:7], 0
  v_mfma_f32_16x16x32_bf16 v[56:59], v[164:167], a[8:11], 0
  ds_read_b128 a[36:39], v18 offset:41984
  v_mfma_f32_16x16x32_bf16 v[60:63], v[164:167], a[12:15], 0
  s_waitcnt lgkmcnt(10)
  v_mfma_f32_16x16x32_bf16 v[64:67], v[168:171], a[0:3], 0
  ds_read_b64_tr_b16 v[184:185], v8 offset:12288
  ds_read_b64_tr_b16 v[186:187], v8 offset:14336
  v_mfma_f32_16x16x32_bf16 v[68:71], v[168:171], a[4:7], 0
  v_mfma_f32_16x16x32_bf16 v[72:75], v[168:171], a[8:11], 0
  ds_read_b128 a[40:43], v18 offset:43008
  v_mfma_f32_16x16x32_bf16 v[76:79], v[168:171], a[12:15], 0
  buffer_store_dwordx4 v[108:111], v31, s[8:11], 0 offen offset:1024 sc1
  s_waitcnt lgkmcnt(10)
  v_mfma_f32_16x16x32_bf16 v[80:83], v[172:175], a[0:3], 0
  ds_read_b64_tr_b16 v[188:189], v9 offset:12288
  ds_read_b64_tr_b16 v[190:191], v9 offset:14336
  v_mfma_f32_16x16x32_bf16 v[84:87], v[172:175], a[4:7], 0
  v_mfma_f32_16x16x32_bf16 v[88:91], v[172:175], a[8:11], 0
  ds_read_b128 a[44:47], v18 offset:44032
  v_mfma_f32_16x16x32_bf16 v[92:95], v[172:175], a[12:15], 0
  s_waitcnt lgkmcnt(10)
  v_mfma_f32_16x16x32_bf16 v[32:35], v[176:179], a[16:19], v[32:35]
  s_waitcnt vmcnt(12)
  s_barrier
  ds_read_b64_tr_b16 v[160:161], v8 offset:16384
  ds_read_b64_tr_b16 v[162:163], v8 offset:18432
  v_mfma_f32_16x16x32_bf16 v[36:39], v[176:179], a[20:23], v[36:39]
  s_add_u32 s47, s39, 9216
  s_add_u32 m0, s32, 90112
  v_mfma_f32_16x16x32_bf16 v[40:43], v[176:179], a[24:27], v[40:43]
  buffer_load_dwordx4 v5, s[8:11], s47 offen offset:0 sc1 lds
  ds_read_b128 a[48:51], v18 offset:49152
  v_mfma_f32_16x16x32_bf16 v[44:47], v[176:179], a[28:31], v[44:47]
  s_waitcnt lgkmcnt(10)
  v_mfma_f32_16x16x32_bf16 v[48:51], v[180:183], a[16:19], v[48:51]
  ds_read_b64_tr_b16 v[164:165], v9 offset:16384
  ds_read_b64_tr_b16 v[166:167], v9 offset:18432
  v_mfma_f32_16x16x32_bf16 v[52:55], v[180:183], a[20:23], v[52:55]
  s_add_u32 s47, s39, 82944
  s_add_u32 m0, s32, 94208
  v_mfma_f32_16x16x32_bf16 v[56:59], v[180:183], a[24:27], v[56:59]
  buffer_load_dwordx4 v5, s[8:11], s47 offen offset:0 sc1 lds
  ds_read_b128 a[52:55], v18 offset:50176
  v_mfma_f32_16x16x32_bf16 v[60:63], v[180:183], a[28:31], v[60:63]
  buffer_store_dwordx4 v[112:115], v31, s[8:11], 0 offen offset:2048 sc1
  s_waitcnt lgkmcnt(10)
  v_mfma_f32_16x16x32_bf16 v[64:67], v[184:187], a[16:19], v[64:67]
  ds_read_b64_tr_b16 v[168:169], v8 offset:20480
  ds_read_b64_tr_b16 v[170:171], v8 offset:22528
  v_mfma_f32_16x16x32_bf16 v[68:71], v[184:187], a[20:23], v[68:71]
  s_add_u32 s47, s39, 10240
  s_add_u32 m0, s32, 0
  v_mfma_f32_16x16x32_bf16 v[72:75], v[184:187], a[24:27], v[72:75]
  buffer_load_dwordx4 v5, s[8:11], s47 offen offset:0 sc1 lds
  ds_read_b128 a[56:59], v18 offset:51200
  v_mfma_f32_16x16x32_bf16 v[76:79], v[184:187], a[28:31], v[76:79]
  s_waitcnt lgkmcnt(10)
  v_mfma_f32_16x16x32_bf16 v[80:83], v[188:191], a[16:19], v[80:83]
  ds_read_b64_tr_b16 v[172:173], v9 offset:20480
  ds_read_b64_tr_b16 v[174:175], v9 offset:22528
  v_mfma_f32_16x16x32_bf16 v[84:87], v[188:191], a[20:23], v[84:87]
  s_add_u32 s47, s39, 83968
  s_add_u32 m0, s32, 4096
  v_mfma_f32_16x16x32_bf16 v[88:91], v[188:191], a[24:27], v[88:91]
  buffer_load_dwordx4 v5, s[8:11], s47 offen offset:0 sc1 lds
  ds_read_b128 a[60:63], v18 offset:52224
  v_mfma_f32_16x16x32_bf16 v[92:95], v[188:191], a[28:31], v[92:95]
  s_waitcnt lgkmcnt(10)
  v_mfma_f32_16x16x32_bf16 v[32:35], v[160:163], a[32:35], v[32:35]
  s_waitcnt vmcnt(13)
  s_barrier
  ds_read_b64_tr_b16 v[176:177], v8 offset:24576
  ds_read_b64_tr_b16 v[178:179], v8 offset:26624
  v_mfma_f32_16x16x32_bf16 v[36:39], v[160:163], a[36:39], v[36:39]
  s_add_u32 s47, s39, 11264
  s_add_u32 m0, s32, 98304
  v_mfma_f32_16x16x32_bf16 v[40:43], v[160:163], a[40:43], v[40:43]
  buffer_load_dwordx4 v5, s[8:11], s47 offen offset:0 sc1 lds
  ds_read_b128 a[64:67], v18 offset:57344
  v_mfma_f32_16x16x32_bf16 v[44:47], v[160:163], a[44:47], v[44:47]
  s_waitcnt lgkmcnt(10)
  v_mfma_f32_16x16x32_bf16 v[48:51], v[164:167], a[32:35], v[48:51]
  ds_read_b64_tr_b16 v[180:181], v9 offset:24576
  ds_read_b64_tr_b16 v[182:183], v9 offset:26624
  v_mfma_f32_16x16x32_bf16 v[52:55], v[164:167], a[36:39], v[52:55]
  s_add_u32 s47, s39, 84992
  s_add_u32 m0, s32, 102400
  v_mfma_f32_16x16x32_bf16 v[56:59], v[164:167], a[40:43], v[56:59]
  buffer_load_dwordx4 v5, s[8:11], s47 offen offset:0 sc1 lds
  ds_read_b128 a[68:71], v18 offset:58368
  v_mfma_f32_16x16x32_bf16 v[60:63], v[164:167], a[44:47], v[60:63]
  s_waitcnt lgkmcnt(10)
  v_mfma_f32_16x16x32_bf16 v[64:67], v[168:171], a[32:35], v[64:67]
  ds_read_b64_tr_b16 v[184:185], v8 offset:28672
  ds_read_b64_tr_b16 v[186:187], v8 offset:30720
  v_mfma_f32_16x16x32_bf16 v[68:71], v[168:171], a[36:39], v[68:71]
  s_add_u32 m0, s32, 8192
  v_mfma_f32_16x16x32_bf16 v[72:75], v[168:171], a[40:43], v[72:75]
  buffer_load_dwordx4 v3, s[12:15], s71 offen offset:0 lds
  ds_read_b128 a[72:75], v18 offset:59392
  v_mfma_f32_16x16x32_bf16 v[76:79], v[168:171], a[44:47], v[76:79]
  s_waitcnt lgkmcnt(10)
  v_mfma_f32_16x16x32_bf16 v[80:83], v[172:175], a[32:35], v[80:83]
  ds_read_b64_tr_b16 v[188:189], v9 offset:28672
  ds_read_b64_tr_b16 v[190:191], v9 offset:30720
  v_mfma_f32_16x16x32_bf16 v[84:87], v[172:175], a[36:39], v[84:87]
  v_mfma_f32_16x16x32_bf16 v[88:91], v[172:175], a[40:43], v[88:91]
  ds_read_b128 a[76:79], v18 offset:60416
  v_mfma_f32_16x16x32_bf16 v[92:95], v[172:175], a[44:47], v[92:95]
  s_waitcnt lgkmcnt(10)
  v_mfma_f32_16x16x32_bf16 v[32:35], v[176:179], a[48:51], v[32:35]
  ds_read_b64_tr_b16 v[160:161], v8 offset:32768
  ds_read_b64_tr_b16 v[162:163], v8 offset:34816
  v_mfma_f32_16x16x32_bf16 v[36:39], v[176:179], a[52:55], v[36:39]
  v_mfma_f32_16x16x32_bf16 v[40:43], v[176:179], a[56:59], v[40:43]
  ds_read_b128 a[80:83], v19 offset:0
  v_mfma_f32_16x16x32_bf16 v[44:47], v[176:179], a[60:63], v[44:47]
  s_waitcnt lgkmcnt(10)
  v_mfma_f32_16x16x32_bf16 v[48:51], v[180:183], a[48:51], v[48:51]
  ds_read_b64_tr_b16 v[164:165], v9 offset:32768
  ds_read_b64_tr_b16 v[166:167], v9 offset:34816
  v_mfma_f32_16x16x32_bf16 v[52:55], v[180:183], a[52:55], v[52:55]
  v_mfma_f32_16x16x32_bf16 v[56:59], v[180:183], a[56:59], v[56:59]
  ds_read_b128 a[84:87], v19 offset:1024
  v_mfma_f32_16x16x32_bf16 v[60:63], v[180:183], a[60:63], v[60:63]
  s_waitcnt lgkmcnt(10)
  v_mfma_f32_16x16x32_bf16 v[64:67], v[184:187], a[48:51], v[64:67]
  s_waitcnt vmcnt(14)
  s_barrier
  ds_read_b64_tr_b16 v[168:169], v8 offset:36864
  ds_read_b64_tr_b16 v[170:171], v8 offset:38912
  v_mfma_f32_16x16x32_bf16 v[68:71], v[184:187], a[52:55], v[68:71]
  s_add_u32 s47, s39, 12288
  s_add_u32 m0, s32, 106496
  v_mfma_f32_16x16x32_bf16 v[72:75], v[184:187], a[56:59], v[72:75]
  buffer_load_dwordx4 v5, s[8:11], s47 offen offset:0 sc1 lds
  ds_read_b128 a[88:91], v19 offset:2048
  v_mfma_f32_16x16x32_bf16 v[76:79], v[184:187], a[60:63], v[76:79]
  s_add_u32 s47, s39, 86016
  s_add_u32 m0, s32, 110592
  s_waitcnt lgkmcnt(10)
  v_mfma_f32_16x16x32_bf16 v[80:83], v[188:191], a[48:51], v[80:83]
  buffer_load_dwordx4 v5, s[8:11], s47 offen offset:0 sc1 lds
  ds_read_b64_tr_b16 v[172:173], v9 offset:36864
  ds_read_b64_tr_b16 v[174:175], v9 offset:38912
  v_mfma_f32_16x16x32_bf16 v[84:87], v[188:191], a[52:55], v[84:87]
  s_add_u32 m0, s32, 114688
  v_mfma_f32_16x16x32_bf16 v[88:91], v[188:191], a[56:59], v[88:91]
  buffer_load_dwordx4 v3, s[16:19], s71 offen offset:0 lds
  ds_read_b128 a[92:95], v19 offset:3072
  v_mfma_f32_16x16x32_bf16 v[92:95], v[188:191], a[60:63], v[92:95]
  s_add_u32 m0, s32, 118784
  s_waitcnt lgkmcnt(10)
  v_mfma_f32_16x16x32_bf16 v[32:35], v[160:163], a[64:67], v[32:35]
  buffer_load_dwordx4 v3, s[12:15], s72 offen offset:0 lds
  ds_read_b64_tr_b16 v[176:177], v8 offset:40960
  ds_read_b64_tr_b16 v[178:179], v8 offset:43008
  v_mfma_f32_16x16x32_bf16 v[36:39], v[160:163], a[68:71], v[36:39]
  s_add_u32 s47, s39, 13312
  s_add_u32 m0, s32, 16384
  v_mfma_f32_16x16x32_bf16 v[40:43], v[160:163], a[72:75], v[40:43]
  buffer_load_dwordx4 v5, s[8:11], s47 offen offset:0 sc1 lds
  ds_read_b128 a[96:99], v19 offset:8192
  v_mfma_f32_16x16x32_bf16 v[44:47], v[160:163], a[76:79], v[44:47]
  s_waitcnt lgkmcnt(10)
  v_mfma_f32_16x16x32_bf16 v[48:51], v[164:167], a[64:67], v[48:51]
  ds_read_b64_tr_b16 v[180:181], v9 offset:40960
  ds_read_b64_tr_b16 v[182:183], v9 offset:43008
  v_mfma_f32_16x16x32_bf16 v[52:55], v[164:167], a[68:71], v[52:55]
  s_add_u32 s47, s39, 87040
  s_add_u32 m0, s32, 20480
  v_mfma_f32_16x16x32_bf16 v[56:59], v[164:167], a[72:75], v[56:59]
  buffer_load_dwordx4 v5, s[8:11], s47 offen offset:0 sc1 lds
  ds_read_b128 a[100:103], v19 offset:9216
  v_mfma_f32_16x16x32_bf16 v[60:63], v[164:167], a[76:79], v[60:63]
  s_waitcnt lgkmcnt(10)
  v_mfma_f32_16x16x32_bf16 v[64:67], v[168:171], a[64:67], v[64:67]
  ds_read_b64_tr_b16 v[184:185], v8 offset:45056
  ds_read_b64_tr_b16 v[186:187], v8 offset:47104
  v_mfma_f32_16x16x32_bf16 v[68:71], v[168:171], a[68:71], v[68:71]
  s_add_u32 m0, s32, 12288
  v_mfma_f32_16x16x32_bf16 v[72:75], v[168:171], a[72:75], v[72:75]
  buffer_load_dwordx4 v3, s[16:19], s72 offen offset:0 lds
  ds_read_b128 a[104:107], v19 offset:10240
  v_mfma_f32_16x16x32_bf16 v[76:79], v[168:171], a[76:79], v[76:79]
  s_waitcnt lgkmcnt(10)
  v_mfma_f32_16x16x32_bf16 v[80:83], v[172:175], a[64:67], v[80:83]
  ds_read_b64_tr_b16 v[188:189], v9 offset:45056
  ds_read_b64_tr_b16 v[190:191], v9 offset:47104
  v_mfma_f32_16x16x32_bf16 v[84:87], v[172:175], a[68:71], v[84:87]
  s_add_u32 m0, s32, 24576
  v_mfma_f32_16x16x32_bf16 v[88:91], v[172:175], a[72:75], v[88:91]
  buffer_load_dwordx4 v3, s[12:15], s73 offen offset:0 lds
  ds_read_b128 a[108:111], v19 offset:11264
  v_mfma_f32_16x16x32_bf16 v[92:95], v[172:175], a[76:79], v[92:95]
  s_waitcnt lgkmcnt(10)
  v_mfma_f32_16x16x32_bf16 v[32:35], v[176:179], a[80:83], v[32:35]
  s_waitcnt vmcnt(14)
  s_barrier
  ds_read_b64_tr_b16 v[160:161], v8 offset:49152
  ds_read_b64_tr_b16 v[162:163], v8 offset:51200
  v_mfma_f32_16x16x32_bf16 v[36:39], v[176:179], a[84:87], v[36:39]
  s_add_u32 s47, s39, 14336
  s_add_u32 m0, s32, 122880
  v_mfma_f32_16x16x32_bf16 v[40:43], v[176:179], a[88:91], v[40:43]
  buffer_load_dwordx4 v5, s[8:11], s47 offen offset:0 sc1 lds
  ds_read_b128 a[112:115], v19 offset:16384
  v_mfma_f32_16x16x32_bf16 v[44:47], v[176:179], a[92:95], v[44:47]
  s_waitcnt lgkmcnt(10)
  v_mfma_f32_16x16x32_bf16 v[48:51], v[180:183], a[80:83], v[48:51]
  ds_read_b64_tr_b16 v[164:165], v9 offset:49152
  ds_read_b64_tr_b16 v[166:167], v9 offset:51200
  v_mfma_f32_16x16x32_bf16 v[52:55], v[180:183], a[84:87], v[52:55]
  s_add_u32 s47, s39, 88064
  s_add_u32 m0, s32, 126976
  v_mfma_f32_16x16x32_bf16 v[56:59], v[180:183], a[88:91], v[56:59]
  buffer_load_dwordx4 v5, s[8:11], s47 offen offset:0 sc1 lds
  ds_read_b128 a[116:119], v19 offset:17408
  v_mfma_f32_16x16x32_bf16 v[60:63], v[180:183], a[92:95], v[60:63]
  s_waitcnt lgkmcnt(10)
  v_mfma_f32_16x16x32_bf16 v[64:67], v[184:187], a[80:83], v[64:67]
  ds_read_b64_tr_b16 v[168:169], v8 offset:53248
  ds_read_b64_tr_b16 v[170:171], v8 offset:55296
  v_mfma_f32_16x16x32_bf16 v[68:71], v[184:187], a[84:87], v[68:71]
  s_add_u32 m0, s32, 28672
  v_mfma_f32_16x16x32_bf16 v[72:75], v[184:187], a[88:91], v[72:75]
  buffer_load_dwordx4 v3, s[16:19], s73 offen offset:0 lds
  ds_read_b128 a[120:123], v19 offset:18432
  v_mfma_f32_16x16x32_bf16 v[76:79], v[184:187], a[92:95], v[76:79]
  s_waitcnt lgkmcnt(10)
  v_mfma_f32_16x16x32_bf16 v[80:83], v[188:191], a[80:83], v[80:83]
  ds_read_b64_tr_b16 v[172:173], v9 offset:53248
  ds_read_b64_tr_b16 v[174:175], v9 offset:55296
  v_mfma_f32_16x16x32_bf16 v[84:87], v[188:191], a[84:87], v[84:87]
  s_add_u32 m0, s32, 32768
  v_mfma_f32_16x16x32_bf16 v[88:91], v[188:191], a[88:91], v[88:91]
  buffer_load_dwordx4 v3, s[12:15], s74 offen offset:0 lds
  ds_read_b128 a[124:127], v19 offset:19456
  v_mfma_f32_16x16x32_bf16 v[92:95], v[188:191], a[92:95], v[92:95]
  s_waitcnt lgkmcnt(10)
  v_mfma_f32_16x16x32_bf16 v[32:35], v[160:163], a[96:99], v[32:35]
  ds_read_b64_tr_b16 v[176:177], v8 offset:57344
  ds_read_b64_tr_b16 v[178:179], v8 offset:59392
  v_mfma_f32_16x16x32_bf16 v[36:39], v[160:163], a[100:103], v[36:39]
  v_mfma_f32_16x16x32_bf16 v[40:43], v[160:163], a[104:107], v[40:43]
  ds_read_b128 a[128:131], v19 offset:24576
  v_mfma_f32_16x16x32_bf16 v[44:47], v[160:163], a[108:111], v[44:47]
  s_waitcnt lgkmcnt(10)
  v_mfma_f32_16x16x32_bf16 v[48:51], v[164:167], a[96:99], v[48:51]
  ds_read_b64_tr_b16 v[180:181], v9 offset:57344
  ds_read_b64_tr_b16 v[182:183], v9 offset:59392
  v_mfma_f32_16x16x32_bf16 v[52:55], v[164:167], a[100:103], v[52:55]
  v_mfma_f32_16x16x32_bf16 v[56:59], v[164:167], a[104:107], v[56:59]
  ds_read_b128 a[132:135], v19 offset:25600
  v_mfma_f32_16x16x32_bf16 v[60:63], v[164:167], a[108:111], v[60:63]
  s_waitcnt lgkmcnt(10)
  v_mfma_f32_16x16x32_bf16 v[64:67], v[168:171], a[96:99], v[64:67]
  ds_read_b64_tr_b16 v[184:185], v8 offset:61440
  ds_read_b64_tr_b16 v[186:187], v8 offset:63488
  v_mfma_f32_16x16x32_bf16 v[68:71], v[168:171], a[100:103], v[68:71]
  v_mfma_f32_16x16x32_bf16 v[72:75], v[168:171], a[104:107], v[72:75]
  ds_read_b128 a[136:139], v19 offset:26624
  v_mfma_f32_16x16x32_bf16 v[76:79], v[168:171], a[108:111], v[76:79]
  s_waitcnt lgkmcnt(10)
  v_mfma_f32_16x16x32_bf16 v[80:83], v[172:175], a[96:99], v[80:83]
  ds_read_b64_tr_b16 v[188:189], v9 offset:61440
  ds_read_b64_tr_b16 v[190:191], v9 offset:63488
  v_mfma_f32_16x16x32_bf16 v[84:87], v[172:175], a[100:103], v[84:87]
  v_mfma_f32_16x16x32_bf16 v[88:91], v[172:175], a[104:107], v[88:91]
  ds_read_b128 a[140:143], v19 offset:27648
  v_mfma_f32_16x16x32_bf16 v[92:95], v[172:175], a[108:111], v[92:95]
  s_waitcnt lgkmcnt(10)
  v_mfma_f32_16x16x32_bf16 v[32:35], v[176:179], a[112:115], v[32:35]
  ds_read_b64_tr_b16 v[160:161], v10 offset:0
  ds_read_b64_tr_b16 v[162:163], v10 offset:2048
  v_mfma_f32_16x16x32_bf16 v[36:39], v[176:179], a[116:119], v[36:39]
  v_mfma_f32_16x16x32_bf16 v[40:43], v[176:179], a[120:123], v[40:43]
  ds_read_b128 a[144:147], v18 offset:24576
  v_mfma_f32_16x16x32_bf16 v[44:47], v[176:179], a[124:127], v[44:47]
  s_waitcnt lgkmcnt(10)
  v_mfma_f32_16x16x32_bf16 v[48:51], v[180:183], a[112:115], v[48:51]
  ds_read_b64_tr_b16 v[164:165], v11 offset:0
  ds_read_b64_tr_b16 v[166:167], v11 offset:2048
  v_mfma_f32_16x16x32_bf16 v[52:55], v[180:183], a[116:119], v[52:55]
  v_mfma_f32_16x16x32_bf16 v[56:59], v[180:183], a[120:123], v[56:59]
  ds_read_b128 a[148:151], v18 offset:25600
  v_mfma_f32_16x16x32_bf16 v[60:63], v[180:183], a[124:127], v[60:63]
  s_waitcnt lgkmcnt(10)
  v_mfma_f32_16x16x32_bf16 v[64:67], v[184:187], a[112:115], v[64:67]
  ds_read_b64_tr_b16 v[168:169], v10 offset:4096
  ds_read_b64_tr_b16 v[170:171], v10 offset:6144
  v_mfma_f32_16x16x32_bf16 v[68:71], v[184:187], a[116:119], v[68:71]
  v_mfma_f32_16x16x32_bf16 v[72:75], v[184:187], a[120:123], v[72:75]
  ds_read_b128 a[152:155], v18 offset:26624
  v_mfma_f32_16x16x32_bf16 v[76:79], v[184:187], a[124:127], v[76:79]
  s_waitcnt lgkmcnt(10)
  v_mfma_f32_16x16x32_bf16 v[80:83], v[188:191], a[112:115], v[80:83]
  ds_read_b64_tr_b16 v[172:173], v11 offset:4096
  ds_read_b64_tr_b16 v[174:175], v11 offset:6144
  v_mfma_f32_16x16x32_bf16 v[84:87], v[188:191], a[116:119], v[84:87]
  v_mfma_f32_16x16x32_bf16 v[88:91], v[188:191], a[120:123], v[88:91]
  ds_read_b128 a[156:159], v18 offset:27648
  v_mfma_f32_16x16x32_bf16 v[92:95], v[188:191], a[124:127], v[92:95]
  s_waitcnt lgkmcnt(10)
  v_mfma_f32_16x16x32_bf16 v[32:35], v[160:163], a[128:131], v[32:35]
  s_waitcnt vmcnt(9)
  s_barrier
  ds_read_b64_tr_b16 v[176:177], v10 offset:8192
  ds_read_b64_tr_b16 v[178:179], v10 offset:10240
  v_mfma_f32_16x16x32_bf16 v[36:39], v[160:163], a[132:135], v[36:39]
  s_add_u32 s47, s39, 15360
  s_add_u32 m0, s32, 131072
  v_mfma_f32_16x16x32_bf16 v[40:43], v[160:163], a[136:139], v[40:43]
  buffer_load_dwordx4 v5, s[8:11], s47 offen offset:0 sc1 lds
  ds_read_b128 a[160:163], v17 offset:0
  v_mfma_f32_16x16x32_bf16 v[44:47], v[160:163], a[140:143], v[44:47]
  s_add_u32 s47, s39, 89088
  s_add_u32 m0, s32, 135168
  s_waitcnt lgkmcnt(10)
  v_mfma_f32_16x16x32_bf16 v[48:51], v[164:167], a[128:131], v[48:51]
  buffer_load_dwordx4 v5, s[8:11], s47 offen offset:0 sc1 lds
  ds_read_b64_tr_b16 v[180:181], v11 offset:8192
  ds_read_b64_tr_b16 v[182:183], v11 offset:10240
  v_mfma_f32_16x16x32_bf16 v[52:55], v[164:167], a[132:135], v[52:55]
  s_add_u32 m0, s32, 139264
  v_mfma_f32_16x16x32_bf16 v[56:59], v[164:167], a[136:139], v[56:59]
  buffer_load_dwordx4 v3, s[16:19], s74 offen offset:0 lds
  ds_read_b128 a[164:167], v17 offset:1024
  v_mfma_f32_16x16x32_bf16 v[60:63], v[164:167], a[140:143], v[60:63]
  s_waitcnt lgkmcnt(10)
  v_mfma_f32_16x16x32_bf16 v[64:67], v[168:171], a[128:131], v[64:67]
  ds_read_b64_tr_b16 v[184:185], v10 offset:12288
  ds_read_b64_tr_b16 v[186:187], v10 offset:14336
  v_mfma_f32_16x16x32_bf16 v[68:71], v[168:171], a[132:135], v[68:71]
  s_add_u32 m0, s32, 143360
  v_mfma_f32_16x16x32_bf16 v[72:75], v[168:171], a[136:139], v[72:75]
  buffer_load_dwordx4 v3, s[12:15], s75 offen offset:0 lds
  ds_read_b128 a[168:171], v17 offset:2048
  v_mfma_f32_16x16x32_bf16 v[76:79], v[168:171], a[140:143], v[76:79]
  s_waitcnt lgkmcnt(10)
  v_mfma_f32_16x16x32_bf16 v[80:83], v[172:175], a[128:131], v[80:83]
  ds_read_b64_tr_b16 v[188:189], v11 offset:12288
  ds_read_b64_tr_b16 v[190:191], v11 offset:14336
  v_mfma_f32_16x16x32_bf16 v[84:87], v[172:175], a[132:135], v[84:87]
  s_add_u32 s47, s39, 16384
  s_add_u32 m0, s32, 147456
  v_mfma_f32_16x16x32_bf16 v[88:91], v[172:175], a[136:139], v[88:91]
  buffer_load_dwordx4 v5, s[8:11], s47 offen offset:0 sc1 lds
  ds_read_b128 a[172:175], v17 offset:3072
  v_mfma_f32_16x16x32_bf16 v[92:95], v[172:175], a[140:143], v[92:95]
  s_waitcnt lgkmcnt(10)
  v_mfma_f32_16x16x32_bf16 v[32:35], v[176:179], a[144:147], v[32:35]
  ds_read_b64_tr_b16 v[160:161], v10 offset:16384
  ds_read_b64_tr_b16 v[162:163], v10 offset:18432
  v_mfma_f32_16x16x32_bf16 v[36:39], v[176:179], a[148:151], v[36:39]
  s_add_u32 s47, s39, 90112
  s_add_u32 m0, s32, 151552
  v_mfma_f32_16x16x32_bf16 v[40:43], v[176:179], a[152:155], v[40:43]
  buffer_load_dwordx4 v5, s[8:11], s47 offen offset:0 sc1 lds
  ds_read_b128 a[176:179], v18 offset:32768
  v_mfma_f32_16x16x32_bf16 v[44:47], v[176:179], a[156:159], v[44:47]
  s_waitcnt lgkmcnt(10)
  v_mfma_f32_16x16x32_bf16 v[48:51], v[180:183], a[144:147], v[48:51]
  ds_read_b64_tr_b16 v[164:165], v11 offset:16384
  ds_read_b64_tr_b16 v[166:167], v11 offset:18432
  v_mfma_f32_16x16x32_bf16 v[52:55], v[180:183], a[148:151], v[52:55]
  s_add_u32 m0, s32, 36864
  v_mfma_f32_16x16x32_bf16 v[56:59], v[180:183], a[152:155], v[56:59]
  buffer_load_dwordx4 v3, s[16:19], s75 offen offset:0 lds
  ds_read_b128 a[180:183], v18 offset:33792
  v_mfma_f32_16x16x32_bf16 v[60:63], v[180:183], a[156:159], v[60:63]
  s_waitcnt lgkmcnt(10)
  v_mfma_f32_16x16x32_bf16 v[64:67], v[184:187], a[144:147], v[64:67]
  ds_read_b64_tr_b16 v[168:169], v10 offset:20480
  ds_read_b64_tr_b16 v[170:171], v10 offset:22528
  v_mfma_f32_16x16x32_bf16 v[68:71], v[184:187], a[148:151], v[68:71]
  s_add_u32 m0, s32, 40960
  v_mfma_f32_16x16x32_bf16 v[72:75], v[184:187], a[152:155], v[72:75]
  buffer_load_dwordx4 v3, s[12:15], s76 offen offset:0 lds
  ds_read_b128 a[184:187], v18 offset:34816
  v_mfma_f32_16x16x32_bf16 v[76:79], v[184:187], a[156:159], v[76:79]
  s_waitcnt lgkmcnt(10)
  v_mfma_f32_16x16x32_bf16 v[80:83], v[188:191], a[144:147], v[80:83]
  ds_read_b64_tr_b16 v[172:173], v11 offset:20480
  ds_read_b64_tr_b16 v[174:175], v11 offset:22528
  v_mfma_f32_16x16x32_bf16 v[84:87], v[188:191], a[148:151], v[84:87]
  s_add_u32 s47, s39, 17408
  s_add_u32 m0, s32, 49152
  v_mfma_f32_16x16x32_bf16 v[88:91], v[188:191], a[152:155], v[88:91]
  buffer_load_dwordx4 v5, s[8:11], s47 offen offset:0 sc1 lds
  ds_read_b128 a[188:191], v18 offset:35840
  v_mfma_f32_16x16x32_bf16 v[92:95], v[188:191], a[156:159], v[92:95]
  v_and_b32 v193, 127, v0
  v_min_u32 v193, 71, v193
  v_and_b32 v194, 1, v193
  v_lshrrev_b32 v193, 1, v193
  v_mul_u32_u24 v193, 9216, v193
  v_lshl_add_u32 v193, v194, 7, v193
  s_mul_i32 s30, s26, 331776
  s_add_u32 s30, s30, s35
  s_and_b32 s30, s30, 0xffffff80
  s_lshl_b32 s31, s27, 7
  s_add_u32 s30, s30, s31
  s_add_u32 s30, s30, 256
  buffer_load_dword v195, v193, s[52:55], s30 offen
  s_waitcnt lgkmcnt(10)
  v_mfma_f32_16x16x32_bf16 v[32:35], v[160:163], a[160:163], v[32:35]
  ds_read_b64_tr_b16 v[176:177], v8 offset:8192
  ds_read_b64_tr_b16 v[178:179], v8 offset:10240
  v_mfma_f32_16x16x32_bf16 v[36:39], v[160:163], a[164:167], v[36:39]
  s_add_u32 s47, s39, 91136
  s_add_u32 m0, s32, 53248
  v_mfma_f32_16x16x32_bf16 v[40:43], v[160:163], a[168:171], v[40:43]
  buffer_load_dwordx4 v5, s[8:11], s47 offen offset:0 sc1 lds
  ds_read_b128 a[192:195], v18 offset:40960
  v_mfma_f32_16x16x32_bf16 v[44:47], v[160:163], a[172:175], v[44:47]
  s_waitcnt lgkmcnt(10)
  v_mfma_f32_16x16x32_bf16 v[48:51], v[164:167], a[160:163], v[48:51]
  ds_read_b64_tr_b16 v[180:181], v9 offset:8192
  ds_read_b64_tr_b16 v[182:183], v9 offset:10240
  v_mfma_f32_16x16x32_bf16 v[52:55], v[164:167], a[164:167], v[52:55]
  s_add_u32 m0, s32, 45056
  v_mfma_f32_16x16x32_bf16 v[56:59], v[164:167], a[168:171], v[56:59]
  buffer_load_dwordx4 v3, s[16:19], s76 offen offset:0 lds
  ds_read_b128 a[196:199], v18 offset:41984
  v_mfma_f32_16x16x32_bf16 v[60:63], v[164:167], a[172:175], v[60:63]
  s_waitcnt lgkmcnt(10)
  v_mfma_f32_16x16x32_bf16 v[64:67], v[168:171], a[160:163], v[64:67]
  ds_read_b64_tr_b16 v[184:185], v10 offset:49152
  ds_read_b64_tr_b16 v[186:187], v10 offset:51200
  v_mfma_f32_16x16x32_bf16 v[68:71], v[168:171], a[164:167], v[68:71]
  s_add_u32 m0, s32, 57344
  v_mfma_f32_16x16x32_bf16 v[72:75], v[168:171], a[168:171], v[72:75]
  buffer_load_dwordx4 v3, s[12:15], s77 offen offset:0 lds
  ds_read_b128 a[200:203], v18 offset:43008
  v_mfma_f32_16x16x32_bf16 v[76:79], v[168:171], a[172:175], v[76:79]
  s_waitcnt lgkmcnt(10)
  v_mfma_f32_16x16x32_bf16 v[80:83], v[172:175], a[160:163], v[80:83]
  ds_read_b64_tr_b16 v[188:189], v11 offset:49152
  ds_read_b64_tr_b16 v[190:191], v11 offset:51200
  v_mfma_f32_16x16x32_bf16 v[84:87], v[172:175], a[164:167], v[84:87]
  s_add_u32 m0, s32, 61440
  v_mfma_f32_16x16x32_bf16 v[88:91], v[172:175], a[168:171], v[88:91]
  buffer_load_dwordx4 v3, s[16:19], s77 offen offset:0 lds
  ds_read_b128 a[204:207], v18 offset:44032
  v_mfma_f32_16x16x32_bf16 v[92:95], v[172:175], a[172:175], v[92:95]
  s_waitcnt lgkmcnt(10)
  v_mfma_f32_16x16x32_bf16 v[32:35], v[176:179], a[176:179], v[32:35]
  s_waitcnt vmcnt(11)
  s_barrier
  ds_read_b64_tr_b16 v[160:161], v10 offset:53248
  ds_read_b64_tr_b16 v[162:163], v10 offset:55296
  v_mfma_f32_16x16x32_bf16 v[36:39], v[176:179], a[180:183], v[36:39]
  s_add_u32 m0, s32, 155520
  v_mfma_f32_16x16x32_bf16 v[40:43], v[176:179], a[184:187], v[40:43]
  buffer_load_dwordx4 v3, s[12:15], s60 offen offset:128 lds
  ds_read_b128 a[208:211], v17 offset:16384
  v_mfma_f32_16x16x32_bf16 v[44:47], v[176:179], a[188:191], v[44:47]
  s_waitcnt lgkmcnt(10)
  v_mfma_f32_16x16x32_bf16 v[48:51], v[180:183], a[176:179], v[48:51]
  ds_read_b64_tr_b16 v[164:165], v11 offset:53248
  ds_read_b64_tr_b16 v[166:167], v11 offset:55296
  v_mfma_f32_16x16x32_bf16 v[52:55], v[180:183], a[180:183], v[52:55]
  s_add_u32 m0, s32, 159616
  v_mfma_f32_16x16x32_bf16 v[56:59], v[180:183], a[184:187], v[56:59]
  buffer_load_dwordx4 v3, s[16:19], s60 offen offset:128 lds
  ds_read_b128 a[212:215], v17 offset:17408
  v_mfma_f32_16x16x32_bf16 v[60:63], v[180:183], a[188:191], v[60:63]
  s_waitcnt lgkmcnt(10)
  v_mfma_f32_16x16x32_bf16 v[64:67], v[184:187], a[176:179], v[64:67]
  ds_read_b64_tr_b16 v[168:169], v8 offset:12288
  ds_read_b64_tr_b16 v[170:171], v8 offset:14336
  v_mfma_f32_16x16x32_bf16 v[68:71], v[184:187], a[180:183], v[68:71]
  s_add_u32 s47, s61, 128
  s_add_u32 m0, s32, 0
  v_mfma_f32_16x16x32_bf16 v[72:75], v[184:187], a[184:187], v[72:75]
  buffer_load_dwordx4 v3, s[12:15], s47 offen offset:0 lds
  ds_read_b128 a[216:219], v17 offset:18432
  v_mfma_f32_16x16x32_bf16 v[76:79], v[184:187], a[188:191], v[76:79]
  s_waitcnt lgkmcnt(10)
  v_mfma_f32_16x16x32_bf16 v[80:83], v[188:191], a[176:179], v[80:83]
  ds_read_b64_tr_b16 v[172:173], v9 offset:12288
  ds_read_b64_tr_b16 v[174:175], v9 offset:14336
  v_mfma_f32_16x16x32_bf16 v[84:87], v[188:191], a[180:183], v[84:87]
  s_add_u32 m0, s32, 3968
  v_mfma_f32_16x16x32_bf16 v[88:91], v[188:191], a[184:187], v[88:91]
  buffer_load_dwordx4 v3, s[16:19], s61 offen offset:128 lds
  ds_read_b128 a[220:223], v17 offset:19456
  v_mfma_f32_16x16x32_bf16 v[92:95], v[188:191], a[188:191], v[92:95]
  s_waitcnt lgkmcnt(10)
  v_mfma_f32_16x16x32_bf16 v[32:35], v[160:163], a[192:195], v[32:35]
  ds_read_b64_tr_b16 v[176:177], v8 offset:24576
  ds_read_b64_tr_b16 v[178:179], v8 offset:26624
  v_mfma_f32_16x16x32_bf16 v[36:39], v[160:163], a[196:199], v[36:39]
  s_add_u32 m0, s32, 65408
  v_mfma_f32_16x16x32_bf16 v[40:43], v[160:163], a[200:203], v[40:43]
  buffer_load_dwordx4 v3, s[12:15], s62 offen offset:128 lds
  ds_read_b128 a[224:227], v18 offset:57344
  v_mfma_f32_16x16x32_bf16 v[44:47], v[160:163], a[204:207], v[44:47]
  s_waitcnt lgkmcnt(10)
  v_mfma_f32_16x16x32_bf16 v[48:51], v[164:167], a[192:195], v[48:51]
  ds_read_b64_tr_b16 v[180:181], v9 offset:24576
  ds_read_b64_tr_b16 v[182:183], v9 offset:26624
  v_mfma_f32_16x16x32_bf16 v[52:55], v[164:167], a[196:199], v[52:55]
  s_add_u32 m0, s32, 69504
  v_mfma_f32_16x16x32_bf16 v[56:59], v[164:167], a[200:203], v[56:59]
  buffer_load_dwordx4 v3, s[16:19], s62 offen offset:128 lds
  ds_read_b128 a[228:231], v18 offset:58368
  v_mfma_f32_16x16x32_bf16 v[60:63], v[164:167], a[204:207], v[60:63]
  s_waitcnt lgkmcnt(10)
  v_mfma_f32_16x16x32_bf16 v[64:67], v[168:171], a[192:195], v[64:67]
  ds_read_b64_tr_b16 v[184:185], v8 offset:28672
  ds_read_b64_tr_b16 v[186:187], v8 offset:30720
  v_mfma_f32_16x16x32_bf16 v[68:71], v[168:171], a[196:199], v[68:71]
  s_add_u32 m0, s32, 73600
  v_mfma_f32_16x16x32_bf16 v[72:75], v[168:171], a[200:203], v[72:75]
  buffer_load_dwordx4 v3, s[12:15], s63 offen offset:128 lds
  ds_read_b128 a[232:235], v18 offset:59392
  v_mfma_f32_16x16x32_bf16 v[76:79], v[168:171], a[204:207], v[76:79]
  s_waitcnt lgkmcnt(10)
  v_mfma_f32_16x16x32_bf16 v[80:83], v[172:175], a[192:195], v[80:83]
  ds_read_b64_tr_b16 v[188:189], v9 offset:28672
  ds_read_b64_tr_b16 v[190:191], v9 offset:30720
  v_mfma_f32_16x16x32_bf16 v[84:87], v[172:175], a[196:199], v[84:87]
  s_add_u32 m0, s32, 77696
  v_mfma_f32_16x16x32_bf16 v[88:91], v[172:175], a[200:203], v[88:91]
  buffer_load_dwordx4 v3, s[16:19], s63 offen offset:128 lds
  ds_read_b128 a[236:239], v18 offset:60416
  v_mfma_f32_16x16x32_bf16 v[92:95], v[172:175], a[204:207], v[92:95]
  s_waitcnt lgkmcnt(10)
  v_mfma_f32_16x16x32_bf16 v[32:35], v[176:179], a[208:211], v[32:35]
  ds_read_b64_tr_b16 v[160:161], v8 offset:32768
  ds_read_b64_tr_b16 v[162:163], v8 offset:34816
  v_mfma_f32_16x16x32_bf16 v[36:39], v[176:179], a[212:215], v[36:39]
  s_add_u32 m0, s32, 81792
  v_mfma_f32_16x16x32_bf16 v[40:43], v[176:179], a[216:219], v[40:43]
  buffer_load_dwordx4 v3, s[12:15], s64 offen offset:128 lds
  ds_read_b128 a[240:243], v19 offset:0
  v_mfma_f32_16x16x32_bf16 v[44:47], v[176:179], a[220:223], v[44:47]
  s_waitcnt lgkmcnt(10)
  v_mfma_f32_16x16x32_bf16 v[48:51], v[180:183], a[208:211], v[48:51]
  ds_read_b64_tr_b16 v[164:165], v9 offset:32768
  ds_read_b64_tr_b16 v[166:167], v9 offset:34816
  v_mfma_f32_16x16x32_bf16 v[52:55], v[180:183], a[212:215], v[52:55]
  s_add_u32 m0, s32, 85888
  v_mfma_f32_16x16x32_bf16 v[56:59], v[180:183], a[216:219], v[56:59]
  buffer_load_dwordx4 v3, s[16:19], s64 offen offset:128 lds
  ds_read_b128 a[244:247], v19 offset:1024
  v_mfma_f32_16x16x32_bf16 v[60:63], v[180:183], a[220:223], v[60:63]
  s_waitcnt lgkmcnt(10)
  v_mfma_f32_16x16x32_bf16 v[64:67], v[184:187], a[208:211], v[64:67]
  ds_read_b64_tr_b16 v[168:169], v12 offset:8192
  ds_read_b64_tr_b16 v[170:171], v12 offset:10240
  v_mfma_f32_16x16x32_bf16 v[68:71], v[184:187], a[212:215], v[68:71]
  v_mfma_f32_16x16x32_bf16 v[72:75], v[184:187], a[216:219], v[72:75]
  ds_read_b128 a[248:251], v19 offset:2048
  v_mfma_f32_16x16x32_bf16 v[76:79], v[184:187], a[220:223], v[76:79]
  s_waitcnt lgkmcnt(10)
  v_mfma_f32_16x16x32_bf16 v[80:83], v[188:191], a[208:211], v[80:83]
  ds_read_b64_tr_b16 v[172:173], v13 offset:8192
  ds_read_b64_tr_b16 v[174:175], v13 offset:10240
  v_mfma_f32_16x16x32_bf16 v[84:87], v[188:191], a[212:215], v[84:87]
  v_mfma_f32_16x16x32_bf16 v[88:91], v[188:191], a[216:219], v[88:91]
  ds_read_b128 a[252:255], v19 offset:3072
  v_mfma_f32_16x16x32_bf16 v[92:95], v[188:191], a[220:223], v[92:95]
  s_waitcnt lgkmcnt(10)
  v_mfma_f32_16x16x32_bf16 v[32:35], v[160:163], a[224:227], v[32:35]
  s_waitcnt vmcnt(10)
  s_barrier
  ds_read_b64_tr_b16 v[176:177], v12 offset:12288
  ds_read_b64_tr_b16 v[178:179], v12 offset:14336
  v_mfma_f32_16x16x32_bf16 v[36:39], v[160:163], a[228:231], v[36:39]
  s_add_u32 m0, s32, 106368
  v_mfma_f32_16x16x32_bf16 v[40:43], v[160:163], a[232:235], v[40:43]
  buffer_load_dwordx4 v3, s[12:15], s65 offen offset:128 lds
  ds_read_b128 v[224:227], v19 offset:16384
  v_mfma_f32_16x16x32_bf16 v[44:47], v[160:163], a[236:239], v[44:47]
  s_waitcnt lgkmcnt(10)
  v_mfma_f32_16x16x32_bf16 v[48:51], v[164:167], a[224:227], v[48:51]
  ds_read_b64_tr_b16 v[180:181], v13 offset:12288
  ds_read_b64_tr_b16 v[182:183], v13 offset:14336
  v_mfma_f32_16x16x32_bf16 v[52:55], v[164:167], a[228:231], v[52:55]
  s_add_u32 m0, s32, 110464
  v_mfma_f32_16x16x32_bf16 v[56:59], v[164:167], a[232:235], v[56:59]
  buffer_load_dwordx4 v3, s[16:19], s65 offen offset:128 lds
  ds_read_b128 v[228:231], v19 offset:17408
  v_mfma_f32_16x16x32_bf16 v[60:63], v[164:167], a[236:239], v[60:63]
  s_waitcnt lgkmcnt(10)
  v_mfma_f32_16x16x32_bf16 v[64:67], v[168:171], a[224:227], v[64:67]
  ds_read_b64_tr_b16 v[184:185], v8 offset:36864
  ds_read_b64_tr_b16 v[186:187], v8 offset:38912
  v_mfma_f32_16x16x32_bf16 v[68:71], v[168:171], a[228:231], v[68:71]
  s_add_u32 m0, s32, 114560
  v_mfma_f32_16x16x32_bf16 v[72:75], v[168:171], a[232:235], v[72:75]
  buffer_load_dwordx4 v3, s[12:15], s66 offen offset:128 lds
  ds_read_b128 v[232:235], v19 offset:18432
  v_mfma_f32_16x16x32_bf16 v[76:79], v[168:171], a[236:239], v[76:79]
  s_waitcnt lgkmcnt(10)
  v_mfma_f32_16x16x32_bf16 v[80:83], v[172:175], a[224:227], v[80:83]
  ds_read_b64_tr_b16 v[188:189], v9 offset:36864
  ds_read_b64_tr_b16 v[190:191], v9 offset:38912
  v_mfma_f32_16x16x32_bf16 v[84:87], v[172:175], a[228:231], v[84:87]
  s_add_u32 m0, s32, 118656
  v_mfma_f32_16x16x32_bf16 v[88:91], v[172:175], a[232:235], v[88:91]
  buffer_load_dwordx4 v3, s[16:19], s66 offen offset:128 lds
  ds_read_b128 v[236:239], v19 offset:19456
  v_mfma_f32_16x16x32_bf16 v[92:95], v[172:175], a[236:239], v[92:95]
  s_waitcnt lgkmcnt(10)
  v_mfma_f32_16x16x32_bf16 v[32:35], v[176:179], a[240:243], v[32:35]
  ds_read_b64_tr_b16 v[160:161], v8 offset:40960
  ds_read_b64_tr_b16 v[162:163], v8 offset:43008
  v_mfma_f32_16x16x32_bf16 v[36:39], v[176:179], a[244:247], v[36:39]
  s_add_u32 m0, s32, 8064
  v_mfma_f32_16x16x32_bf16 v[40:43], v[176:179], a[248:251], v[40:43]
  buffer_load_dwordx4 v3, s[12:15], s67 offen offset:128 lds
  ds_read_b128 v[240:243], v17 offset:49152
  v_mfma_f32_16x16x32_bf16 v[44:47], v[176:179], a[252:255], v[44:47]
  s_waitcnt lgkmcnt(10)
  v_mfma_f32_16x16x32_bf16 v[48:51], v[180:183], a[240:243], v[48:51]
  ds_read_b64_tr_b16 v[164:165], v9 offset:40960
  ds_read_b64_tr_b16 v[166:167], v9 offset:43008
  v_mfma_f32_16x16x32_bf16 v[52:55], v[180:183], a[244:247], v[52:55]
  s_add_u32 m0, s32, 12160
  v_mfma_f32_16x16x32_bf16 v[56:59], v[180:183], a[248:251], v[56:59]
  buffer_load_dwordx4 v3, s[16:19], s67 offen offset:128 lds
  ds_read_b128 v[244:247], v17 offset:50176
  v_mfma_f32_16x16x32_bf16 v[60:63], v[180:183], a[252:255], v[60:63]
  s_waitcnt lgkmcnt(10)
  v_mfma_f32_16x16x32_bf16 v[64:67], v[184:187], a[240:243], v[64:67]
  ds_read_b64_tr_b16 v[168:169], v8 offset:45056
  ds_read_b64_tr_b16 v[170:171], v8 offset:47104
  v_mfma_f32_16x16x32_bf16 v[68:71], v[184:187], a[244:247], v[68:71]
  s_add_u32 m0, s32, 16256
  v_mfma_f32_16x16x32_bf16 v[72:75], v[184:187], a[248:251], v[72:75]
  buffer_load_dwordx4 v3, s[12:15], s68 offen offset:128 lds
  ds_read_b128 v[248:251], v17 offset:51200
  v_mfma_f32_16x16x32_bf16 v[76:79], v[184:187], a[252:255], v[76:79]
  s_waitcnt lgkmcnt(10)
  v_mfma_f32_16x16x32_bf16 v[80:83], v[188:191], a[240:243], v[80:83]
  ds_read_b64_tr_b16 v[172:173], v9 offset:45056
  ds_read_b64_tr_b16 v[174:175], v9 offset:47104
  v_mfma_f32_16x16x32_bf16 v[84:87], v[188:191], a[244:247], v[84:87]
  s_add_u32 m0, s32, 20352
  v_mfma_f32_16x16x32_bf16 v[88:91], v[188:191], a[248:251], v[88:91]
  buffer_load_dwordx4 v3, s[16:19], s68 offen offset:128 lds
  ds_read_b128 v[252:255], v17 offset:52224
  v_mfma_f32_16x16x32_bf16 v[92:95], v[188:191], a[252:255], v[92:95]
  s_waitcnt lgkmcnt(10)
  v_mfma_f32_16x16x32_bf16 v[32:35], v[160:163], v[224:227], v[32:35]
  ds_read_b64_tr_b16 v[176:177], v8 offset:57344
  ds_read_b64_tr_b16 v[178:179], v8 offset:59392
  v_mfma_f32_16x16x32_bf16 v[36:39], v[160:163], v[228:231], v[36:39]
  s_add_u32 m0, s32, 24448
  v_mfma_f32_16x16x32_bf16 v[40:43], v[160:163], v[232:235], v[40:43]
  buffer_load_dwordx4 v3, s[12:15], s69 offen offset:128 lds
  v_mfma_f32_16x16x32_bf16 v[44:47], v[160:163], v[236:239], v[44:47]
  s_waitcnt lgkmcnt(9)
  v_mfma_f32_16x16x32_bf16 v[48:51], v[164:167], v[224:227], v[48:51]
  ds_read_b64_tr_b16 v[180:181], v9 offset:57344
  ds_read_b64_tr_b16 v[182:183], v9 offset:59392
  v_mfma_f32_16x16x32_bf16 v[52:55], v[164:167], v[228:231], v[52:55]
  s_add_u32 m0, s32, 28544
  v_mfma_f32_16x16x32_bf16 v[56:59], v[164:167], v[232:235], v[56:59]
  buffer_load_dwordx4 v3, s[16:19], s69 offen offset:128 lds
  v_mfma_f32_16x16x32_bf16 v[60:63], v[164:167], v[236:239], v[60:63]
  s_waitcnt lgkmcnt(8)
  v_mfma_f32_16x16x32_bf16 v[64:67], v[168:171], v[224:227], v[64:67]
  ds_read_b64_tr_b16 v[184:185], v8 offset:61440
  ds_read_b64_tr_b16 v[186:187], v8 offset:63488
  v_mfma_f32_16x16x32_bf16 v[68:71], v[168:171], v[228:231], v[68:71]
  v_mfma_f32_16x16x32_bf16 v[72:75], v[168:171], v[232:235], v[72:75]
  v_mfma_f32_16x16x32_bf16 v[76:79], v[168:171], v[236:239], v[76:79]
  s_waitcnt lgkmcnt(7)
  v_mfma_f32_16x16x32_bf16 v[80:83], v[172:175], v[224:227], v[80:83]
  ds_read_b64_tr_b16 v[188:189], v9 offset:61440
  ds_read_b64_tr_b16 v[190:191], v9 offset:63488
  v_mfma_f32_16x16x32_bf16 v[84:87], v[172:175], v[228:231], v[84:87]
  v_mfma_f32_16x16x32_bf16 v[88:91], v[172:175], v[232:235], v[88:91]
  v_mfma_f32_16x16x32_bf16 v[92:95], v[172:175], v[236:239], v[92:95]
  s_waitcnt lgkmcnt(6)
  v_mfma_f32_16x16x32_bf16 v[32:35], v[176:179], v[240:243], v[32:35]
  s_waitcnt vmcnt(14)
  s_barrier
  ds_read_b64_tr_b16 v[160:161], v12 offset:24576
  ds_read_b64_tr_b16 v[162:163], v12 offset:26624
  v_mfma_f32_16x16x32_bf16 v[36:39], v[176:179], v[244:247], v[36:39]
  s_add_u32 m0, s32, 122752
  v_mfma_f32_16x16x32_bf16 v[40:43], v[176:179], v[248:251], v[40:43]
  buffer_load_dwordx4 v3, s[12:15], s70 offen offset:128 lds
  v_mfma_f32_16x16x32_bf16 v[44:47], v[176:179], v[252:255], v[44:47]
  s_waitcnt lgkmcnt(6)
  v_mfma_f32_16x16x32_bf16 v[48:51], v[180:183], v[240:243], v[48:51]
  ds_read_b64_tr_b16 v[164:165], v13 offset:24576
  ds_read_b64_tr_b16 v[166:167], v13 offset:26624
  v_mfma_f32_16x16x32_bf16 v[52:55], v[180:183], v[244:247], v[52:55]
  s_add_u32 m0, s32, 126848
  v_mfma_f32_16x16x32_bf16 v[56:59], v[180:183], v[248:251], v[56:59]
  buffer_load_dwordx4 v3, s[16:19], s70 offen offset:128 lds
  v_mfma_f32_16x16x32_bf16 v[60:63], v[180:183], v[252:255], v[60:63]
  v_cvt_pk_bf16_f32 v128, v32, v33
  v_cvt_pk_bf16_f32 v129, v34, v35
  s_waitcnt lgkmcnt(6)
  v_mfma_f32_16x16x32_bf16 v[64:67], v[184:187], v[240:243], v[64:67]
  v_cvt_pk_bf16_f32 v132, v36, v37
  v_cvt_pk_bf16_f32 v133, v38, v39
  ds_read_b64_tr_b16 v[168:169], v12 offset:28672
  ds_read_b64_tr_b16 v[170:171], v12 offset:30720
  v_mfma_f32_16x16x32_bf16 v[68:71], v[184:187], v[244:247], v[68:71]
  v_cvt_pk_bf16_f32 v136, v40, v41
  v_cvt_pk_bf16_f32 v137, v42, v43
  s_add_u32 m0, s32, 130944
  v_mfma_f32_16x16x32_bf16 v[72:75], v[184:187], v[248:251], v[72:75]
  buffer_load_dwordx4 v3, s[12:15], s71 offen offset:128 lds
  v_cvt_pk_bf16_f32 v140, v44, v45
  v_cvt_pk_bf16_f32 v141, v46, v47
  v_mfma_f32_16x16x32_bf16 v[76:79], v[184:187], v[252:255], v[76:79]
  v_cvt_pk_bf16_f32 v130, v48, v49
  v_cvt_pk_bf16_f32 v131, v50, v51
  s_waitcnt lgkmcnt(6)
  v_mfma_f32_16x16x32_bf16 v[80:83], v[188:191], v[240:243], v[80:83]
  v_cvt_pk_bf16_f32 v134, v52, v53
  v_cvt_pk_bf16_f32 v135, v54, v55
  ds_read_b64_tr_b16 v[172:173], v13 offset:28672
  ds_read_b64_tr_b16 v[174:175], v13 offset:30720
  v_mfma_f32_16x16x32_bf16 v[84:87], v[188:191], v[244:247], v[84:87]
  v_cvt_pk_bf16_f32 v138, v56, v57
  v_cvt_pk_bf16_f32 v139, v58, v59
  s_add_u32 m0, s32, 135040
  v_mfma_f32_16x16x32_bf16 v[88:91], v[188:191], v[248:251], v[88:91]
  buffer_load_dwordx4 v3, s[16:19], s71 offen offset:128 lds
  v_cvt_pk_bf16_f32 v142, v60, v61
  v_cvt_pk_bf16_f32 v143, v62, v63
  v_mfma_f32_16x16x32_bf16 v[92:95], v[188:191], v[252:255], v[92:95]
  v_cvt_pk_bf16_f32 v144, v64, v65
  v_cvt_pk_bf16_f32 v145, v66, v67
  s_waitcnt lgkmcnt(6)
  v_mfma_f32_16x16x32_bf16 v[32:35], v[160:163], a[0:3], 0
  v_cvt_pk_bf16_f32 v148, v68, v69
  v_cvt_pk_bf16_f32 v149, v70, v71
  ds_read_b64_tr_b16 v[176:177], v8 offset:0
  ds_read_b64_tr_b16 v[178:179], v8 offset:2048
  v_mfma_f32_16x16x32_bf16 v[36:39], v[160:163], a[4:7], 0
  v_cvt_pk_bf16_f32 v152, v72, v73
  v_cvt_pk_bf16_f32 v153, v74, v75
  s_add_u32 m0, s32, 139136
  v_mfma_f32_16x16x32_bf16 v[40:43], v[160:163], a[8:11], 0
  buffer_load_dwordx4 v3, s[12:15], s72 offen offset:128 lds
  v_cvt_pk_bf16_f32 v156, v76, v77
  v_cvt_pk_bf16_f32 v157, v78, v79
  v_mfma_f32_16x16x32_bf16 v[44:47], v[160:163], a[12:15], 0
  v_cvt_pk_bf16_f32 v146, v80, v81
  v_cvt_pk_bf16_f32 v147, v82, v83
  s_waitcnt lgkmcnt(6)
  v_mfma_f32_16x16x32_bf16 v[48:51], v[164:167], a[0:3], 0
  v_cvt_pk_bf16_f32 v150, v84, v85
  v_cvt_pk_bf16_f32 v151, v86, v87
  ds_read_b64_tr_b16 v[180:181], v9 offset:0
  ds_read_b64_tr_b16 v[182:183], v9 offset:2048
  v_mfma_f32_16x16x32_bf16 v[52:55], v[164:167], a[4:7], 0
  v_cvt_pk_bf16_f32 v154, v88, v89
  v_cvt_pk_bf16_f32 v155, v90, v91
  s_add_u32 m0, s32, 143232
  v_mfma_f32_16x16x32_bf16 v[56:59], v[164:167], a[8:11], 0
  buffer_load_dwordx4 v3, s[16:19], s72 offen offset:128 lds
  v_cvt_pk_bf16_f32 v158, v92, v93
  v_cvt_pk_bf16_f32 v159, v94, v95
  v_mfma_f32_16x16x32_bf16 v[60:63], v[164:167], a[12:15], 0
  v_pk_max_i16 v128, v128, 0
  s_waitcnt lgkmcnt(6)
  v_mfma_f32_16x16x32_bf16 v[64:67], v[168:171], a[0:3], 0
  ds_read_b64_tr_b16 v[184:185], v8 offset:4096
  ds_read_b64_tr_b16 v[186:187], v8 offset:6144
  v_mfma_f32_16x16x32_bf16 v[68:71], v[168:171], a[4:7], 0
  s_add_u32 m0, s32, 147328
  v_lshlrev_b32 v25, 16, v144
  v_mfma_f32_16x16x32_bf16 v[72:75], v[168:171], a[8:11], 0
  buffer_load_dwordx4 v3, s[12:15], s73 offen offset:128 lds
  v_and_b32 v27, s33, v144
  v_mfma_f32_16x16x32_bf16 v[76:79], v[168:171], a[12:15], 0
  v_lshlrev_b32 v24, 16, v128
  s_waitcnt lgkmcnt(6)
  v_mfma_f32_16x16x32_bf16 v[80:83], v[172:175], a[0:3], 0
  ds_read_b64_tr_b16 v[188:189], v9 offset:4096
  ds_read_b64_tr_b16 v[190:191], v9 offset:6144
  v_mfma_f32_16x16x32_bf16 v[84:87], v[172:175], a[4:7], 0
  s_add_u32 m0, s32, 151424
  v_and_b32 v26, s33, v128
  v_mfma_f32_16x16x32_bf16 v[88:91], v[172:175], a[8:11], 0
  buffer_load_dwordx4 v3, s[16:19], s73 offen offset:128 lds
  v_mul_f32 v24, v24, v25
  v_mfma_f32_16x16x32_bf16 v[92:95], v[172:175], a[12:15], 0
  v_mul_f32 v26, v26, v27
  s_waitcnt lgkmcnt(6)
  v_mfma_f32_16x16x32_bf16 v[32:35], v[176:179], a[16:19], v[32:35]
  ds_read_b64_tr_b16 v[160:161], v10 offset:0
  ds_read_b64_tr_b16 v[162:163], v10 offset:2048
  v_mfma_f32_16x16x32_bf16 v[36:39], v[176:179], a[20:23], v[36:39]
  s_add_u32 m0, s32, 32640
  v_cvt_pk_bf16_f32 v128, v24, v26
  v_mfma_f32_16x16x32_bf16 v[40:43], v[176:179], a[24:27], v[40:43]
  buffer_load_dwordx4 v3, s[12:15], s74 offen offset:128 lds
  v_pk_max_i16 v129, v129, 0
  v_mfma_f32_16x16x32_bf16 v[44:47], v[176:179], a[28:31], v[44:47]
  v_lshlrev_b32 v29, 16, v145
  s_waitcnt lgkmcnt(6)
  v_mfma_f32_16x16x32_bf16 v[48:51], v[180:183], a[16:19], v[48:51]
  ds_read_b64_tr_b16 v[164:165], v11 offset:0
  ds_read_b64_tr_b16 v[166:167], v11 offset:2048
  v_mfma_f32_16x16x32_bf16 v[52:55], v[180:183], a[20:23], v[52:55]
  s_add_u32 m0, s32, 36736
  v_and_b32 v31, s33, v145
  v_mfma_f32_16x16x32_bf16 v[56:59], v[180:183], a[24:27], v[56:59]
  buffer_load_dwordx4 v3, s[16:19], s74 offen offset:128 lds
  v_lshlrev_b32 v28, 16, v129
  v_mfma_f32_16x16x32_bf16 v[60:63], v[180:183], a[28:31], v[60:63]
  v_and_b32 v30, s33, v129
  s_waitcnt lgkmcnt(6)
  v_mfma_f32_16x16x32_bf16 v[64:67], v[184:187], a[16:19], v[64:67]
  ds_read_b64_tr_b16 v[168:169], v10 offset:4096
  ds_read_b64_tr_b16 v[170:171], v10 offset:6144
  v_mfma_f32_16x16x32_bf16 v[68:71], v[184:187], a[20:23], v[68:71]
  s_add_u32 m0, s32, 40832
  v_mul_f32 v28, v28, v29
  v_mfma_f32_16x16x32_bf16 v[72:75], v[184:187], a[24:27], v[72:75]
  buffer_load_dwordx4 v3, s[12:15], s75 offen offset:128 lds
  v_mul_f32 v30, v30, v31
  v_mfma_f32_16x16x32_bf16 v[76:79], v[184:187], a[28:31], v[76:79]
  v_cvt_pk_bf16_f32 v129, v28, v30
  s_waitcnt lgkmcnt(6)
  v_mfma_f32_16x16x32_bf16 v[80:83], v[188:191], a[16:19], v[80:83]
  ds_read_b64_tr_b16 v[172:173], v11 offset:4096
  ds_read_b64_tr_b16 v[174:175], v11 offset:6144
  v_mfma_f32_16x16x32_bf16 v[84:87], v[188:191], a[20:23], v[84:87]
  s_add_u32 m0, s32, 44928
  v_pk_max_i16 v130, v130, 0
  v_mfma_f32_16x16x32_bf16 v[88:91], v[188:191], a[24:27], v[88:91]
  buffer_load_dwordx4 v3, s[16:19], s75 offen offset:128 lds
  v_lshlrev_b32 v25, 16, v146
  v_mfma_f32_16x16x32_bf16 v[92:95], v[188:191], a[28:31], v[92:95]
  v_and_b32 v27, s33, v146
  s_waitcnt lgkmcnt(6)
  v_mfma_f32_16x16x32_bf16 v[32:35], v[160:163], a[32:35], v[32:35]
  s_waitcnt vmcnt(20)
  s_barrier
  ds_read_b64_tr_b16 v[176:177], v10 offset:8192
  ds_read_b64_tr_b16 v[178:179], v10 offset:10240
  v_mfma_f32_16x16x32_bf16 v[36:39], v[160:163], a[36:39], v[36:39]
  s_add_u32 m0, s32, 155520
  v_lshlrev_b32 v24, 16, v130
  v_mfma_f32_16x16x32_bf16 v[40:43], v[160:163], a[40:43], v[40:43]
  buffer_load_dwordx4 v3, s[12:15], s76 offen offset:128 lds
  v_and_b32 v26, s33, v130
  v_mfma_f32_16x16x32_bf16 v[44:47], v[160:163], a[44:47], v[44:47]
  v_mul_f32 v24, v24, v25
  s_waitcnt lgkmcnt(6)
  v_mfma_f32_16x16x32_bf16 v[48:51], v[164:167], a[32:35], v[48:51]
  ds_read_b64_tr_b16 v[180:181], v11 offset:8192
  ds_read_b64_tr_b16 v[182:183], v11 offset:10240
  v_mfma_f32_16x16x32_bf16 v[52:55], v[164:167], a[36:39], v[52:55]
  s_add_u32 m0, s32, 159616
  v_mul_f32 v26, v26, v27
  v_mfma_f32_16x16x32_bf16 v[56:59], v[164:167], a[40:43], v[56:59]
  buffer_load_dwordx4 v3, s[16:19], s76 offen offset:128 lds
  v_cvt_pk_bf16_f32 v130, v24, v26
  v_mfma_f32_16x16x32_bf16 v[60:63], v[164:167], a[44:47], v[60:63]
  v_pk_max_i16 v131, v131, 0
  s_waitcnt lgkmcnt(6)
  v_mfma_f32_16x16x32_bf16 v[64:67], v[168:171], a[32:35], v[64:67]
  ds_read_b64_tr_b16 v[184:185], v10 offset:12288
  ds_read_b64_tr_b16 v[186:187], v10 offset:14336
  v_mfma_f32_16x16x32_bf16 v[68:71], v[168:171], a[36:39], v[68:71]
  s_add_u32 s47, s77, 128
  s_add_u32 m0, s32, 0
  v_mfma_f32_16x16x32_bf16 v[72:75], v[168:171], a[40:43], v[72:75]
  buffer_load_dwordx4 v3, s[12:15], s47 offen offset:0 lds
  v_lshlrev_b32 v29, 16, v147
  v_mfma_f32_16x16x32_bf16 v[76:79], v[168:171], a[44:47], v[76:79]
  v_and_b32 v31, s33, v147
  s_waitcnt lgkmcnt(6)
  v_mfma_f32_16x16x32_bf16 v[80:83], v[172:175], a[32:35], v[80:83]
  ds_read_b64_tr_b16 v[188:189], v11 offset:12288
  ds_read_b64_tr_b16 v[190:191], v11 offset:14336
  v_mfma_f32_16x16x32_bf16 v[84:87], v[172:175], a[36:39], v[84:87]
  s_add_u32 m0, s32, 3968
  v_lshlrev_b32 v28, 16, v131
  v_mfma_f32_16x16x32_bf16 v[88:91], v[172:175], a[40:43], v[88:91]
  buffer_load_dwordx4 v3, s[16:19], s77 offen offset:128 lds
  v_and_b32 v30, s33, v131
  v_mfma_f32_16x16x32_bf16 v[92:95], v[172:175], a[44:47], v[92:95]
  v_mul_f32 v28, v28, v29
  s_waitcnt lgkmcnt(6)
  v_mfma_f32_16x16x32_bf16 v[32:35], v[176:179], a[48:51], v[32:35]
  ds_read_b64_tr_b16 v[160:161], v10 offset:16384
  ds_read_b64_tr_b16 v[162:163], v10 offset:18432
  v_mfma_f32_16x16x32_bf16 v[36:39], v[176:179], a[52:55], v[36:39]
  s_add_u32 m0, s32, 48896
  v_mul_f32 v30, v30, v31
  v_mfma_f32_16x16x32_bf16 v[40:43], v[176:179], a[56:59], v[40:43]
  buffer_load_dwordx4 v3, s[12:15], s60 offen offset:256 lds
  v_cvt_pk_bf16_f32 v131, v28, v30
  v_mfma_f32_16x16x32_bf16 v[44:47], v[176:179], a[60:63], v[44:47]
  ds_write_b128 v20, v[128:131] offset:24576
  s_waitcnt lgkmcnt(7)
  v_mfma_f32_16x16x32_bf16 v[48:51], v[180:183], a[48:51], v[48:51]
  ds_read_b64_tr_b16 v[164:165], v11 offset:16384
  ds_read_b64_tr_b16 v[166:167], v11 offset:18432
  v_mfma_f32_16x16x32_bf16 v[52:55], v[180:183], a[52:55], v[52:55]
  s_add_u32 m0, s32, 52992
  buffer_store_dwordx4 v[128:131], v5, s[8:11], s57 offen offset:0 sc1
  v_mfma_f32_16x16x32_bf16 v[56:59], v[180:183], a[56:59], v[56:59]
  buffer_load_dwordx4 v3, s[16:19], s60 offen offset:256 lds
  v_pk_max_i16 v132, v132, 0
  v_mfma_f32_16x16x32_bf16 v[60:63], v[180:183], a[60:63], v[60:63]
  v_lshlrev_b32 v25, 16, v148
  s_waitcnt lgkmcnt(7)
  v_mfma_f32_16x16x32_bf16 v[64:67], v[184:187], a[48:51], v[64:67]
  ds_read_b64_tr_b16 v[168:169], v10 offset:20480
  ds_read_b64_tr_b16 v[170:171], v10 offset:22528
  v_mfma_f32_16x16x32_bf16 v[68:71], v[184:187], a[52:55], v[68:71]
  s_add_u32 m0, s32, 57088
  v_and_b32 v27, s33, v148
  v_mfma_f32_16x16x32_bf16 v[72:75], v[184:187], a[56:59], v[72:75]
  buffer_load_dwordx4 v3, s[12:15], s61 offen offset:256 lds
  v_lshlrev_b32 v24, 16, v132
  v_mfma_f32_16x16x32_bf16 v[76:79], v[184:187], a[60:63], v[76:79]
  v_and_b32 v26, s33, v132
  s_waitcnt lgkmcnt(7)
  v_mfma_f32_16x16x32_bf16 v[80:83], v[188:191], a[48:51], v[80:83]
  ds_read_b64_tr_b16 v[172:173], v11 offset:20480
  ds_read_b64_tr_b16 v[174:175], v11 offset:22528
  v_mfma_f32_16x16x32_bf16 v[84:87], v[188:191], a[52:55], v[84:87]
  s_add_u32 m0, s32, 61184
  v_mul_f32 v24, v24, v25
  v_mfma_f32_16x16x32_bf16 v[88:91], v[188:191], a[56:59], v[88:91]
  buffer_load_dwordx4 v3, s[16:19], s61 offen offset:256 lds
  v_mul_f32 v26, v26, v27
  v_mfma_f32_16x16x32_bf16 v[92:95], v[188:191], a[60:63], v[92:95]
  v_cvt_pk_bf16_f32 v132, v24, v26
  s_waitcnt lgkmcnt(7)
  v_mfma_f32_16x16x32_bf16 v[32:35], v[160:163], a[64:67], v[32:35]
  ds_read_b64_tr_b16 v[176:177], v10 offset:40960
  ds_read_b64_tr_b16 v[178:179], v10 offset:43008
  v_mfma_f32_16x16x32_bf16 v[36:39], v[160:163], a[68:71], v[36:39]
  v_pk_max_i16 v133, v133, 0
  v_lshlrev_b32 v29, 16, v149
  v_mfma_f32_16x16x32_bf16 v[40:43], v[160:163], a[72:75], v[40:43]
  v_and_b32 v31, s33, v149
  v_lshlrev_b32 v28, 16, v133
  v_mfma_f32_16x16x32_bf16 v[44:47], v[160:163], a[76:79], v[44:47]
  v_and_b32 v30, s33, v133
  s_waitcnt lgkmcnt(6)
  v_mfma_f32_16x16x32_bf16 v[48:51], v[164:167], a[64:67], v[48:51]
  ds_read_b64_tr_b16 v[180:181], v11 offset:40960
  ds_read_b64_tr_b16 v[182:183], v11 offset:43008
  v_mfma_f32_16x16x32_bf16 v[52:55], v[164:167], a[68:71], v[52:55]
  v_mul_f32 v28, v28, v29
  v_mul_f32 v30, v30, v31
  v_mfma_f32_16x16x32_bf16 v[56:59], v[164:167], a[72:75], v[56:59]
  v_cvt_pk_bf16_f32 v133, v28, v30
  v_pk_max_i16 v134, v134, 0
  v_mfma_f32_16x16x32_bf16 v[60:63], v[164:167], a[76:79], v[60:63]
  v_lshlrev_b32 v25, 16, v150
  v_and_b32 v193, 127, v0
  v_min_u32 v193, 35, v193
  v_mul_u32_u24 v193, 9216, v193
  s_mul_i32 s30, s26, 331776
  s_add_u32 s30, s30, s35
  s_and_b32 s30, s30, 0xffffff80
  s_xor_b32 s31, s27, 1
  s_lshl_b32 s31, s31, 9
  s_add_u32 s30, s30, s31
  buffer_load_dword v195, v193, s[52:55], s30 offen
  s_waitcnt lgkmcnt(6)
  v_mfma_f32_16x16x32_bf16 v[64:67], v[168:171], a[64:67], v[64:67]
  ds_read_b64_tr_b16 v[184:185], v10 offset:45056
  ds_read_b64_tr_b16 v[186:187], v10 offset:47104
  v_mfma_f32_16x16x32_bf16 v[68:71], v[168:171], a[68:71], v[68:71]
  v_and_b32 v27, s33, v150
  v_lshlrev_b32 v24, 16, v134
  v_mfma_f32_16x16x32_bf16 v[72:75], v[168:171], a[72:75], v[72:75]
  v_and_b32 v26, s33, v134
  v_mul_f32 v24, v24, v25
  v_mfma_f32_16x16x32_bf16 v[76:79], v[168:171], a[76:79], v[76:79]
  v_mul_f32 v26, v26, v27
  s_waitcnt lgkmcnt(6)
  v_mfma_f32_16x16x32_bf16 v[80:83], v[172:175], a[64:67], v[80:83]
  ds_read_b64_tr_b16 v[188:189], v11 offset:45056
  ds_read_b64_tr_b16 v[190:191], v11 offset:47104
  v_mfma_f32_16x16x32_bf16 v[84:87], v[172:175], a[68:71], v[84:87]
  v_cvt_pk_bf16_f32 v134, v24, v26
  v_pk_max_i16 v135, v135, 0
  v_mfma_f32_16x16x32_bf16 v[88:91], v[172:175], a[72:75], v[88:91]
  v_lshlrev_b32 v29, 16, v151
  v_and_b32 v31, s33, v151
  v_mfma_f32_16x16x32_bf16 v[92:95], v[172:175], a[76:79], v[92:95]
  v_lshlrev_b32 v28, 16, v135
  s_waitcnt lgkmcnt(6)
  v_mfma_f32_16x16x32_bf16 v[32:35], v[176:179], a[80:83], v[32:35]
  s_waitcnt vmcnt(24)
  s_barrier
  ds_read_b64_tr_b16 v[160:161], v10 offset:49152
  ds_read_b64_tr_b16 v[162:163], v10 offset:51200
  v_mfma_f32_16x16x32_bf16 v[36:39], v[176:179], a[84:87], v[36:39]
  s_add_u32 m0, s32, 65280
  v_and_b32 v30, s33, v135
  v_mfma_f32_16x16x32_bf16 v[40:43], v[176:179], a[88:91], v[40:43]
  buffer_load_dwordx4 v3, s[12:15], s62 offen offset:256 lds
  v_mul_f32 v28, v28, v29
  v_mfma_f32_16x16x32_bf16 v[44:47], v[176:179], a[92:95], v[44:47]
  v_mul_f32 v30, v30, v31
  s_waitcnt lgkmcnt(6)
  v_mfma_f32_16x16x32_bf16 v[48:51], v[180:183], a[80:83], v[48:51]
  ds_read_b64_tr_b16 v[164:165], v11 offset:49152
  ds_read_b64_tr_b16 v[166:167], v11 offset:51200
  v_mfma_f32_16x16x32_bf16 v[52:55], v[180:183], a[84:87], v[52:55]
  s_add_u32 m0, s32, 69376
  v_cvt_pk_bf16_f32 v135, v28, v30
  v_mfma_f32_16x16x32_bf16 v[56:59], v[180:183], a[88:91], v[56:59]
  buffer_load_dwordx4 v3, s[16:19], s62 offen offset:256 lds
  ds_write_b128 v20, v[132:135] offset:25600
  v_mfma_f32_16x16x32_bf16 v[60:63], v[180:183], a[92:95], v[60:63]
  buffer_store_dwordx4 v[132:135], v5, s[8:11], s57 offen offset:1024 sc1
  s_waitcnt lgkmcnt(7)
  v_mfma_f32_16x16x32_bf16 v[64:67], v[184:187], a[80:83], v[64:67]
  ds_read_b64_tr_b16 v[168:169], v10 offset:53248
  ds_read_b64_tr_b16 v[170:171], v10 offset:55296
  v_mfma_f32_16x16x32_bf16 v[68:71], v[184:187], a[84:87], v[68:71]
  s_add_u32 m0, s32, 73472
  v_pk_max_i16 v136, v136, 0
  v_mfma_f32_16x16x32_bf16 v[72:75], v[184:187], a[88:91], v[72:75]
  buffer_load_dwordx4 v3, s[12:15], s63 offen offset:256 lds
  v_lshlrev_b32 v25, 16, v152
  v_mfma_f32_16x16x32_bf16 v[76:79], v[184:187], a[92:95], v[76:79]
  v_and_b32 v27, s33, v152
  s_waitcnt lgkmcnt(7)
  v_mfma_f32_16x16x32_bf16 v[80:83], v[188:191], a[80:83], v[80:83]
  ds_read_b64_tr_b16 v[172:173], v11 offset:53248
  ds_read_b64_tr_b16 v[174:175], v11 offset:55296
  v_mfma_f32_16x16x32_bf16 v[84:87], v[188:191], a[84:87], v[84:87]
  s_add_u32 m0, s32, 77568
  v_lshlrev_b32 v24, 16, v136
  v_mfma_f32_16x16x32_bf16 v[88:91], v[188:191], a[88:91], v[88:91]
  buffer_load_dwordx4 v3, s[16:19], s63 offen offset:256 lds
  v_and_b32 v26, s33, v136
  v_mfma_f32_16x16x32_bf16 v[92:95], v[188:191], a[92:95], v[92:95]
  v_mul_f32 v24, v24, v25
  s_waitcnt lgkmcnt(7)
  v_mfma_f32_16x16x32_bf16 v[32:35], v[160:163], a[96:99], v[32:35]
  ds_read_b64_tr_b16 v[176:177], v8 offset:8192
  ds_read_b64_tr_b16 v[178:179], v8 offset:10240
  v_mfma_f32_16x16x32_bf16 v[36:39], v[160:163], a[100:103], v[36:39]
  s_add_u32 m0, s32, 81664
  v_mul_f32 v26, v26, v27
  v_mfma_f32_16x16x32_bf16 v[40:43], v[160:163], a[104:107], v[40:43]
  buffer_load_dwordx4 v3, s[12:15], s64 offen offset:256 lds
  v_cvt_pk_bf16_f32 v136, v24, v26
  v_mfma_f32_16x16x32_bf16 v[44:47], v[160:163], a[108:111], v[44:47]
  v_pk_max_i16 v137, v137, 0
  s_waitcnt lgkmcnt(7)
  v_mfma_f32_16x16x32_bf16 v[48:51], v[164:167], a[96:99], v[48:51]
  ds_read_b64_tr_b16 v[180:181], v9 offset:8192
  ds_read_b64_tr_b16 v[182:183], v9 offset:10240
  v_mfma_f32_16x16x32_bf16 v[52:55], v[164:167], a[100:103], v[52:55]
  s_add_u32 m0, s32, 85760
  v_lshlrev_b32 v29, 16, v153
  v_mfma_f32_16x16x32_bf16 v[56:59], v[164:167], a[104:107], v[56:59]
  buffer_load_dwordx4 v3, s[16:19], s64 offen offset:256 lds
  v_and_b32 v31, s33, v153
  v_mfma_f32_16x16x32_bf16 v[60:63], v[164:167], a[108:111], v[60:63]
  v_lshlrev_b32 v28, 16, v137
  s_waitcnt lgkmcnt(6)
  v_mfma_f32_16x16x32_bf16 v[64:67], v[168:171], a[96:99], v[64:67]
  ds_read_b64_tr_b16 v[184:185], v8 offset:12288
  ds_read_b64_tr_b16 v[186:187], v8 offset:14336
  v_mfma_f32_16x16x32_bf16 v[68:71], v[168:171], a[100:103], v[68:71]
  v_and_b32 v30, s33, v137
  v_mul_f32 v28, v28, v29
  v_mfma_f32_16x16x32_bf16 v[72:75], v[168:171], a[104:107], v[72:75]
  v_mul_f32 v30, v30, v31
  v_cvt_pk_bf16_f32 v137, v28, v30
  v_mfma_f32_16x16x32_bf16 v[76:79], v[168:171], a[108:111], v[76:79]
  v_pk_max_i16 v138, v138, 0
  s_waitcnt lgkmcnt(6)
  v_mfma_f32_16x16x32_bf16 v[80:83], v[172:175], a[96:99], v[80:83]
  ds_read_b64_tr_b16 v[188:189], v9 offset:12288
  ds_read_b64_tr_b16 v[190:191], v9 offset:14336
  v_mfma_f32_16x16x32_bf16 v[84:87], v[172:175], a[100:103], v[84:87]
  v_lshlrev_b32 v25, 16, v154
  v_and_b32 v27, s33, v154
  v_mfma_f32_16x16x32_bf16 v[88:91], v[172:175], a[104:107], v[88:91]
  v_lshlrev_b32 v24, 16, v138
  v_and_b32 v26, s33, v138
  v_mfma_f32_16x16x32_bf16 v[92:95], v[172:175], a[108:111], v[92:95]
  v_mul_f32 v24, v24, v25
  v_min_u32 v193, 161, v0
  v_lshlrev_b32 v193, 7, v193
  s_mul_i32 s30, s25, 288
  s_mul_i32 s31, s26, 18
  s_add_u32 s30, s30, s31
  s_mul_i32 s30, s30, 1152
  buffer_load_dword v192, v193, s[20:23], s30 offen
  s_waitcnt lgkmcnt(6)
  v_mfma_f32_16x16x32_bf16 v[32:35], v[176:179], a[112:115], v[32:35]
  ds_read_b64_tr_b16 v[160:161], v8 offset:16384
  ds_read_b64_tr_b16 v[162:163], v8 offset:18432
  v_mfma_f32_16x16x32_bf16 v[36:39], v[176:179], a[116:119], v[36:39]
  v_mul_f32 v26, v26, v27
  v_cvt_pk_bf16_f32 v138, v24, v26
  v_mfma_f32_16x16x32_bf16 v[40:43], v[176:179], a[120:123], v[40:43]
  v_pk_max_i16 v139, v139, 0
  v_lshlrev_b32 v29, 16, v155
  v_mfma_f32_16x16x32_bf16 v[44:47], v[176:179], a[124:127], v[44:47]
  v_and_b32 v31, s33, v155
  s_waitcnt lgkmcnt(6)
  v_mfma_f32_16x16x32_bf16 v[48:51], v[180:183], a[112:115], v[48:51]
  ds_read_b64_tr_b16 v[164:165], v9 offset:16384
  ds_read_b64_tr_b16 v[166:167], v9 offset:18432
  v_mfma_f32_16x16x32_bf16 v[52:55], v[180:183], a[116:119], v[52:55]
  v_lshlrev_b32 v28, 16, v139
  v_and_b32 v30, s33, v139
  v_mfma_f32_16x16x32_bf16 v[56:59], v[180:183], a[120:123], v[56:59]
  v_mul_f32 v28, v28, v29
  v_mul_f32 v30, v30, v31
  v_mfma_f32_16x16x32_bf16 v[60:63], v[180:183], a[124:127], v[60:63]
  v_cvt_pk_bf16_f32 v139, v28, v30
  s_waitcnt lgkmcnt(6)
  v_mfma_f32_16x16x32_bf16 v[64:67], v[184:187], a[112:115], v[64:67]
  ds_read_b64_tr_b16 v[168:169], v8 offset:20480
  ds_read_b64_tr_b16 v[170:171], v8 offset:22528
  v_mfma_f32_16x16x32_bf16 v[68:71], v[184:187], a[116:119], v[68:71]
  ds_write_b128 v20, v[136:139] offset:26624
  buffer_store_dwordx4 v[136:139], v5, s[8:11], s57 offen offset:2048 sc1
  v_mfma_f32_16x16x32_bf16 v[72:75], v[184:187], a[120:123], v[72:75]
  v_pk_max_i16 v140, v140, 0
  v_lshlrev_b32 v25, 16, v156
  v_mfma_f32_16x16x32_bf16 v[76:79], v[184:187], a[124:127], v[76:79]
  v_and_b32 v27, s33, v156
  s_waitcnt lgkmcnt(7)
  v_mfma_f32_16x16x32_bf16 v[80:83], v[188:191], a[112:115], v[80:83]
  ds_read_b64_tr_b16 v[172:173], v9 offset:20480
  ds_read_b64_tr_b16 v[174:175], v9 offset:22528
  v_mfma_f32_16x16x32_bf16 v[84:87], v[188:191], a[116:119], v[84:87]
  v_lshlrev_b32 v24, 16, v140
  v_and_b32 v26, s33, v140
  v_mfma_f32_16x16x32_bf16 v[88:91], v[188:191], a[120:123], v[88:91]
  v_mul_f32 v24, v24, v25
  v_mul_f32 v26, v26, v27
  v_mfma_f32_16x16x32_bf16 v[92:95], v[188:191], a[124:127], v[92:95]
  v_cvt_pk_bf16_f32 v140, v24, v26
  s_waitcnt lgkmcnt(7)
  v_mfma_f32_16x16x32_bf16 v[32:35], v[160:163], a[128:131], v[32:35]
  s_waitcnt vmcnt(27)
  s_waitcnt lgkmcnt(2)
  s_barrier
  ds_read_b64_tr_b16 v[176:177], v8 offset:24576
  ds_read_b64_tr_b16 v[178:179], v8 offset:26624
  v_mfma_f32_16x16x32_bf16 v[36:39], v[160:163], a[132:135], v[36:39]
  s_add_u32 m0, s32, 7936
  v_pk_max_i16 v141, v141, 0
  v_mfma_f32_16x16x32_bf16 v[40:43], v[160:163], a[136:139], v[40:43]
  buffer_load_dwordx4 v3, s[12:15], s65 offen offset:256 lds
  v_lshlrev_b32 v29, 16, v157
  v_mfma_f32_16x16x32_bf16 v[44:47], v[160:163], a[140:143], v[44:47]
  v_and_b32 v31, s33, v157
  v_mfma_f32_16x16x32_bf16 v[48:51], v[164:167], a[128:131], v[48:51]
  ds_read_b64_tr_b16 v[180:181], v9 offset:24576
  ds_read_b64_tr_b16 v[182:183], v9 offset:26624
  v_mfma_f32_16x16x32_bf16 v[52:55], v[164:167], a[132:135], v[52:55]
  s_add_u32 m0, s32, 12032
  v_lshlrev_b32 v28, 16, v141
  v_mfma_f32_16x16x32_bf16 v[56:59], v[164:167], a[136:139], v[56:59]
  buffer_load_dwordx4 v3, s[16:19], s65 offen offset:256 lds
  v_and_b32 v30, s33, v141
  v_mfma_f32_16x16x32_bf16 v[60:63], v[164:167], a[140:143], v[60:63]
  v_mul_f32 v28, v28, v29
  v_mfma_f32_16x16x32_bf16 v[64:67], v[168:171], a[128:131], v[64:67]
  ds_read_b64_tr_b16 v[184:185], v8 offset:28672
  ds_read_b64_tr_b16 v[186:187], v8 offset:30720
  v_mfma_f32_16x16x32_bf16 v[68:71], v[168:171], a[132:135], v[68:71]
  v_mul_f32 v30, v30, v31
  v_cvt_pk_bf16_f32 v141, v28, v30
  v_mfma_f32_16x16x32_bf16 v[72:75], v[168:171], a[136:139], v[72:75]
  v_pk_max_i16 v142, v142, 0
  v_lshlrev_b32 v25, 16, v158
  v_mfma_f32_16x16x32_bf16 v[76:79], v[168:171], a[140:143], v[76:79]
  v_and_b32 v27, s33, v158
  s_waitcnt lgkmcnt(6)
  v_mfma_f32_16x16x32_bf16 v[80:83], v[172:175], a[128:131], v[80:83]
  ds_read_b64_tr_b16 v[188:189], v9 offset:28672
  ds_read_b64_tr_b16 v[190:191], v9 offset:30720
  v_mfma_f32_16x16x32_bf16 v[84:87], v[172:175], a[132:135], v[84:87]
  v_lshlrev_b32 v24, 16, v142
  v_and_b32 v26, s33, v142
  v_mfma_f32_16x16x32_bf16 v[88:91], v[172:175], a[136:139], v[88:91]
  v_mul_f32 v24, v24, v25
  v_mul_f32 v26, v26, v27
  v_mfma_f32_16x16x32_bf16 v[92:95], v[172:175], a[140:143], v[92:95]
  v_cvt_pk_bf16_f32 v142, v24, v26
  s_waitcnt lgkmcnt(6)
  v_mfma_f32_16x16x32_bf16 v[32:35], v[176:179], a[144:147], v[32:35]
  ds_read_b64_tr_b16 v[160:161], v10 offset:57344
  ds_read_b64_tr_b16 v[162:163], v10 offset:59392
  v_mfma_f32_16x16x32_bf16 v[36:39], v[176:179], a[148:151], v[36:39]
  v_pk_max_i16 v143, v143, 0
  v_lshlrev_b32 v29, 16, v159
  v_mfma_f32_16x16x32_bf16 v[40:43], v[176:179], a[152:155], v[40:43]
  v_and_b32 v31, s33, v159
  v_lshlrev_b32 v28, 16, v143
  v_mfma_f32_16x16x32_bf16 v[44:47], v[176:179], a[156:159], v[44:47]
  v_and_b32 v30, s33, v143
  s_waitcnt lgkmcnt(6)
  v_mfma_f32_16x16x32_bf16 v[48:51], v[180:183], a[144:147], v[48:51]
  ds_read_b64_tr_b16 v[164:165], v11 offset:57344
  ds_read_b64_tr_b16 v[166:167], v11 offset:59392
  v_mfma_f32_16x16x32_bf16 v[52:55], v[180:183], a[148:151], v[52:55]
  v_mul_f32 v28, v28, v29
  v_mul_f32 v30, v30, v31
  v_mfma_f32_16x16x32_bf16 v[56:59], v[180:183], a[152:155], v[56:59]
  v_cvt_pk_bf16_f32 v143, v28, v30
  ds_write_b128 v20, v[140:143] offset:27648
  v_mfma_f32_16x16x32_bf16 v[60:63], v[180:183], a[156:159], v[60:63]
  buffer_store_dwordx4 v[140:143], v5, s[8:11], s57 offen offset:3072 sc1
  s_waitcnt lgkmcnt(7)
  v_mfma_f32_16x16x32_bf16 v[64:67], v[184:187], a[144:147], v[64:67]
  ds_read_b64_tr_b16 v[168:169], v10 offset:61440
  ds_read_b64_tr_b16 v[170:171], v10 offset:63488
  v_mfma_f32_16x16x32_bf16 v[68:71], v[184:187], a[148:151], v[68:71]
  s_add_u32 s57, s57, 16384
  v_mfma_f32_16x16x32_bf16 v[72:75], v[184:187], a[152:155], v[72:75]
  v_mfma_f32_16x16x32_bf16 v[76:79], v[184:187], a[156:159], v[76:79]
  s_waitcnt lgkmcnt(7)
  v_mfma_f32_16x16x32_bf16 v[80:83], v[188:191], a[144:147], v[80:83]
  ds_read_b64_tr_b16 v[172:173], v11 offset:61440
  ds_read_b64_tr_b16 v[174:175], v11 offset:63488
  v_mfma_f32_16x16x32_bf16 v[84:87], v[188:191], a[148:151], v[84:87]
  v_mfma_f32_16x16x32_bf16 v[88:91], v[188:191], a[152:155], v[88:91]
  v_mfma_f32_16x16x32_bf16 v[92:95], v[188:191], a[156:159], v[92:95]
  s_waitcnt lgkmcnt(7)
  v_mfma_f32_16x16x32_bf16 v[32:35], v[160:163], a[160:163], v[32:35]
  ds_read_b64_tr_b16 v[176:177], v12 offset:0
  ds_read_b64_tr_b16 v[178:179], v12 offset:2048
  v_mfma_f32_16x16x32_bf16 v[36:39], v[160:163], a[164:167], v[36:39]
  v_mfma_f32_16x16x32_bf16 v[40:43], v[160:163], a[168:171], v[40:43]
  v_mfma_f32_16x16x32_bf16 v[44:47], v[160:163], a[172:175], v[44:47]
  s_waitcnt lgkmcnt(7)
  v_mfma_f32_16x16x32_bf16 v[48:51], v[164:167], a[160:163], v[48:51]
  ds_read_b64_tr_b16 v[180:181], v13 offset:0
  ds_read_b64_tr_b16 v[182:183], v13 offset:2048
  v_mfma_f32_16x16x32_bf16 v[52:55], v[164:167], a[164:167], v[52:55]
  v_mfma_f32_16x16x32_bf16 v[56:59], v[164:167], a[168:171], v[56:59]
  v_mfma_f32_16x16x32_bf16 v[60:63], v[164:167], a[172:175], v[60:63]
  s_waitcnt lgkmcnt(6)
  v_mfma_f32_16x16x32_bf16 v[64:67], v[168:171], a[160:163], v[64:67]
  ds_read_b64_tr_b16 v[184:185], v12 offset:4096
  ds_read_b64_tr_b16 v[186:187], v12 offset:6144
  v_mfma_f32_16x16x32_bf16 v[68:71], v[168:171], a[164:167], v[68:71]
  v_mfma_f32_16x16x32_bf16 v[72:75], v[168:171], a[168:171], v[72:75]
  v_mfma_f32_16x16x32_bf16 v[76:79], v[168:171], a[172:175], v[76:79]
  s_waitcnt lgkmcnt(6)
  v_mfma_f32_16x16x32_bf16 v[80:83], v[172:175], a[160:163], v[80:83]
  ds_read_b64_tr_b16 v[188:189], v13 offset:4096
  ds_read_b64_tr_b16 v[190:191], v13 offset:6144
  v_mfma_f32_16x16x32_bf16 v[84:87], v[172:175], a[164:167], v[84:87]
  v_mfma_f32_16x16x32_bf16 v[88:91], v[172:175], a[168:171], v[88:91]
  v_mfma_f32_16x16x32_bf16 v[92:95], v[172:175], a[172:175], v[92:95]
  s_waitcnt lgkmcnt(6)
  v_mfma_f32_16x16x32_bf16 v[32:35], v[176:179], a[176:179], v[32:35]
  s_waitcnt vmcnt(24)
  s_barrier
  ds_read_b64_tr_b16 v[160:161], v12 offset:8192
  ds_read_b64_tr_b16 v[162:163], v12 offset:10240
  v_mfma_f32_16x16x32_bf16 v[36:39], v[176:179], a[180:183], v[36:39]
  s_add_u32 m0, s32, 122624
  v_mfma_f32_16x16x32_bf16 v[40:43], v[176:179], a[184:187], v[40:43]
  buffer_load_dwordx4 v3, s[12:15], s66 offen offset:256 lds
  v_mfma_f32_16x16x32_bf16 v[44:47], v[176:179], a[188:191], v[44:47]
  s_waitcnt lgkmcnt(6)
  v_mfma_f32_16x16x32_bf16 v[48:51], v[180:183], a[176:179], v[48:51]
  ds_read_b64_tr_b16 v[164:165], v13 offset:8192
  ds_read_b64_tr_b16 v[166:167], v13 offset:10240
  v_mfma_f32_16x16x32_bf16 v[52:55], v[180:183], a[180:183], v[52:55]
  s_add_u32 m0, s32, 126720
  v_mfma_f32_16x16x32_bf16 v[56:59], v[180:183], a[184:187], v[56:59]
  buffer_load_dwordx4 v3, s[16:19], s66 offen offset:256 lds
  v_mfma_f32_16x16x32_bf16 v[60:63], v[180:183], a[188:191], v[60:63]
  s_waitcnt lgkmcnt(6)
  v_mfma_f32_16x16x32_bf16 v[64:67], v[184:187], a[176:179], v[64:67]
  ds_read_b64_tr_b16 v[168:169], v12 offset:12288
  ds_read_b64_tr_b16 v[170:171], v12 offset:14336
  v_mfma_f32_16x16x32_bf16 v[68:71], v[184:187], a[180:183], v[68:71]
  s_add_u32 m0, s32, 16128
  v_mfma_f32_16x16x32_bf16 v[72:75], v[184:187], a[184:187], v[72:75]
  buffer_load_dwordx4 v3, s[12:15], s67 offen offset:256 lds
  v_mfma_f32_16x16x32_bf16 v[76:79], v[184:187], a[188:191], v[76:79]
  s_waitcnt lgkmcnt(6)
  v_mfma_f32_16x16x32_bf16 v[80:83], v[188:191], a[176:179], v[80:83]
  ds_read_b64_tr_b16 v[172:173], v13 offset:12288
  ds_read_b64_tr_b16 v[174:175], v13 offset:14336
  v_mfma_f32_16x16x32_bf16 v[84:87], v[188:191], a[180:183], v[84:87]
  s_add_u32 m0, s32, 20224
  v_mfma_f32_16x16x32_bf16 v[88:91], v[188:191], a[184:187], v[88:91]
  buffer_load_dwordx4 v3, s[16:19], s67 offen offset:256 lds
  v_mfma_f32_16x16x32_bf16 v[92:95], v[188:191], a[188:191], v[92:95]
  s_waitcnt lgkmcnt(6)
  v_mfma_f32_16x16x32_bf16 v[32:35], v[160:163], a[192:195], v[32:35]
  ds_read_b64_tr_b16 v[176:177], v12 offset:16384
  ds_read_b64_tr_b16 v[178:179], v12 offset:18432
  v_mfma_f32_16x16x32_bf16 v[36:39], v[160:163], a[196:199], v[36:39]
  s_add_u32 m0, s32, 24320
  v_mov_b32 v200, -1
  v_mfma_f32_16x16x32_bf16 v[40:43], v[160:163], a[200:203], v[40:43]
  buffer_load_dwordx4 v3, s[12:15], s68 offen offset:256 lds
  v_mov_b32 v201, -1
  v_mfma_f32_16x16x32_bf16 v[44:47], v[160:163], a[204:207], v[44:47]
  v_mov_b32 v202, -1
  s_waitcnt lgkmcnt(6)
  v_mfma_f32_16x16x32_bf16 v[48:51], v[164:167], a[192:195], v[48:51]
  ds_read_b64_tr_b16 v[180:181], v13 offset:16384
  ds_read_b64_tr_b16 v[182:183], v13 offset:18432
  v_mfma_f32_16x16x32_bf16 v[52:55], v[164:167], a[196:199], v[52:55]
  s_add_u32 m0, s32, 28416
  v_mov_b32 v203, -1
  v_mfma_f32_16x16x32_bf16 v[56:59], v[164:167], a[200:203], v[56:59]
  buffer_load_dwordx4 v3, s[16:19], s68 offen offset:256 lds
  v_lshlrev_b32 v204, 4, v0
  v_mfma_f32_16x16x32_bf16 v[60:63], v[164:167], a[204:207], v[60:63]
  s_cmp_eq_u32 s3, 0
  s_cselect_b32 s6, 0, 0x7f000000
  s_waitcnt lgkmcnt(6)
  v_mfma_f32_16x16x32_bf16 v[64:67], v[168:171], a[192:195], v[64:67]
  ds_read_b64_tr_b16 v[184:185], v12 offset:20480
  ds_read_b64_tr_b16 v[186:187], v12 offset:22528
  v_mfma_f32_16x16x32_bf16 v[68:71], v[168:171], a[196:199], v[68:71]
  v_add_u32 v204, s6, v204
  v_add_u32 v205, 4096, v204
  v_mfma_f32_16x16x32_bf16 v[72:75], v[168:171], a[200:203], v[72:75]
  s_lshl_b32 s6, s24, 28
  v_add_u32 v206, s6, v205
  v_mfma_f32_16x16x32_bf16 v[76:79], v[168:171], a[204:207], v[76:79]
  s_mul_i32 s7, s2, 9216
  s_waitcnt lgkmcnt(6)
  v_mfma_f32_16x16x32_bf16 v[80:83], v[172:175], a[192:195], v[80:83]
  ds_read_b64_tr_b16 v[188:189], v13 offset:20480
  ds_read_b64_tr_b16 v[190:191], v13 offset:22528
  v_mfma_f32_16x16x32_bf16 v[84:87], v[172:175], a[196:199], v[84:87]
  s_add_u32 s7, s7, 54861824
  buffer_store_dwordx4 v[200:203], v204, s[8:11], s7 offen sc1
  v_mfma_f32_16x16x32_bf16 v[88:91], v[172:175], a[200:203], v[88:91]
  v_mfma_f32_16x16x32_bf16 v[92:95], v[172:175], a[204:207], v[92:95]
  s_waitcnt lgkmcnt(6)
  v_mfma_f32_16x16x32_bf16 v[32:35], v[176:179], a[208:211], v[32:35]
  ds_read_b64_tr_b16 v[160:161], v8 offset:32768
  ds_read_b64_tr_b16 v[162:163], v8 offset:34816
  v_mfma_f32_16x16x32_bf16 v[36:39], v[176:179], a[212:215], v[36:39]
  v_mfma_f32_16x16x32_bf16 v[40:43], v[176:179], a[216:219], v[40:43]
  v_mfma_f32_16x16x32_bf16 v[44:47], v[176:179], a[220:223], v[44:47]
  s_waitcnt lgkmcnt(6)
  v_mfma_f32_16x16x32_bf16 v[48:51], v[180:183], a[208:211], v[48:51]
  ds_read_b64_tr_b16 v[164:165], v9 offset:32768
  ds_read_b64_tr_b16 v[166:167], v9 offset:34816
  v_mfma_f32_16x16x32_bf16 v[52:55], v[180:183], a[212:215], v[52:55]
  v_mfma_f32_16x16x32_bf16 v[56:59], v[180:183], a[216:219], v[56:59]
  v_mfma_f32_16x16x32_bf16 v[60:63], v[180:183], a[220:223], v[60:63]
  buffer_store_dwordx4 v[200:203], v205, s[8:11], s7 offen sc1
  s_waitcnt lgkmcnt(6)
  v_mfma_f32_16x16x32_bf16 v[64:67], v[184:187], a[208:211], v[64:67]
  ds_read_b64_tr_b16 v[168:169], v8 offset:36864
  ds_read_b64_tr_b16 v[170:171], v8 offset:38912
  v_mfma_f32_16x16x32_bf16 v[68:71], v[184:187], a[212:215], v[68:71]
  s_add_u32 s7, s7, 4096
  v_mfma_f32_16x16x32_bf16 v[72:75], v[184:187], a[216:219], v[72:75]
  v_mfma_f32_16x16x32_bf16 v[76:79], v[184:187], a[220:223], v[76:79]
  s_waitcnt lgkmcnt(6)
  v_mfma_f32_16x16x32_bf16 v[80:83], v[188:191], a[208:211], v[80:83]
  ds_read_b64_tr_b16 v[172:173], v9 offset:36864
  ds_read_b64_tr_b16 v[174:175], v9 offset:38912
  v_mfma_f32_16x16x32_bf16 v[84:87], v[188:191], a[212:215], v[84:87]
  v_mfma_f32_16x16x32_bf16 v[88:91], v[188:191], a[216:219], v[88:91]
  v_mfma_f32_16x16x32_bf16 v[92:95], v[188:191], a[220:223], v[92:95]
  s_waitcnt lgkmcnt(6)
  v_mfma_f32_16x16x32_bf16 v[32:35], v[160:163], a[224:227], v[32:35]
  s_waitcnt vmcnt(26)
  s_barrier
  ds_read_b64_tr_b16 v[176:177], v8 offset:40960
  ds_read_b64_tr_b16 v[178:179], v8 offset:43008
  v_mfma_f32_16x16x32_bf16 v[36:39], v[160:163], a[228:231], v[36:39]
  s_add_u32 m0, s32, 130816
  buffer_store_dwordx4 v[200:203], v206, s[8:11], s7 offen sc1
  v_mfma_f32_16x16x32_bf16 v[40:43], v[160:163], a[232:235], v[40:43]
  buffer_load_dwordx4 v3, s[12:15], s69 offen offset:256 lds
  v_mfma_f32_16x16x32_bf16 v[44:47], v[160:163], a[236:239], v[44:47]
  s_waitcnt lgkmcnt(6)
  v_mfma_f32_16x16x32_bf16 v[48:51], v[164:167], a[224:227], v[48:51]
  ds_read_b64_tr_b16 v[180:181], v9 offset:40960
  ds_read_b64_tr_b16 v[182:183], v9 offset:43008
  v_mfma_f32_16x16x32_bf16 v[52:55], v[164:167], a[228:231], v[52:55]
  s_add_u32 m0, s32, 134912
  v_mfma_f32_16x16x32_bf16 v[56:59], v[164:167], a[232:235], v[56:59]
  buffer_load_dwordx4 v3, s[16:19], s69 offen offset:256 lds
  v_mfma_f32_16x16x32_bf16 v[60:63], v[164:167], a[236:239], v[60:63]
  s_waitcnt lgkmcnt(6)
  v_mfma_f32_16x16x32_bf16 v[64:67], v[168:171], a[224:227], v[64:67]
  ds_read_b64_tr_b16 v[184:185], v8 offset:45056
  ds_read_b64_tr_b16 v[186:187], v8 offset:47104
  v_mfma_f32_16x16x32_bf16 v[68:71], v[168:171], a[228:231], v[68:71]
  s_add_u32 m0, s32, 139008
  v_mfma_f32_16x16x32_bf16 v[72:75], v[168:171], a[232:235], v[72:75]
  buffer_load_dwordx4 v3, s[12:15], s70 offen offset:256 lds
  v_mfma_f32_16x16x32_bf16 v[76:79], v[168:171], a[236:239], v[76:79]
  s_waitcnt lgkmcnt(6)
  v_mfma_f32_16x16x32_bf16 v[80:83], v[172:175], a[224:227], v[80:83]
  ds_read_b64_tr_b16 v[188:189], v9 offset:45056
  ds_read_b64_tr_b16 v[190:191], v9 offset:47104
  v_mfma_f32_16x16x32_bf16 v[84:87], v[172:175], a[228:231], v[84:87]
  s_add_u32 m0, s32, 143104
  v_mfma_f32_16x16x32_bf16 v[88:91], v[172:175], a[232:235], v[88:91]
  buffer_load_dwordx4 v3, s[16:19], s70 offen offset:256 lds
  v_mfma_f32_16x16x32_bf16 v[92:95], v[172:175], a[236:239], v[92:95]
  s_waitcnt lgkmcnt(6)
  v_mfma_f32_16x16x32_bf16 v[32:35], v[176:179], a[240:243], v[32:35]
  ds_read_b64_tr_b16 v[160:161], v12 offset:24576
  ds_read_b64_tr_b16 v[162:163], v12 offset:26624
  v_mfma_f32_16x16x32_bf16 v[36:39], v[176:179], a[244:247], v[36:39]
  s_add_u32 m0, s32, 147200
  v_mfma_f32_16x16x32_bf16 v[40:43], v[176:179], a[248:251], v[40:43]
  buffer_load_dwordx4 v3, s[12:15], s71 offen offset:256 lds
  v_mfma_f32_16x16x32_bf16 v[44:47], v[176:179], a[252:255], v[44:47]
  s_waitcnt lgkmcnt(6)
  v_mfma_f32_16x16x32_bf16 v[48:51], v[180:183], a[240:243], v[48:51]
  ds_read_b64_tr_b16 v[164:165], v13 offset:24576
  ds_read_b64_tr_b16 v[166:167], v13 offset:26624
  v_mfma_f32_16x16x32_bf16 v[52:55], v[180:183], a[244:247], v[52:55]
  s_add_u32 m0, s32, 151296
  v_mfma_f32_16x16x32_bf16 v[56:59], v[180:183], a[248:251], v[56:59]
  buffer_load_dwordx4 v3, s[16:19], s71 offen offset:256 lds
  v_mfma_f32_16x16x32_bf16 v[60:63], v[180:183], a[252:255], v[60:63]
  s_waitcnt lgkmcnt(6)
  v_mfma_f32_16x16x32_bf16 v[64:67], v[184:187], a[240:243], v[64:67]
  ds_read_b64_tr_b16 v[168:169], v12 offset:28672
  ds_read_b64_tr_b16 v[170:171], v12 offset:30720
  v_mfma_f32_16x16x32_bf16 v[68:71], v[184:187], a[244:247], v[68:71]
  v_mfma_f32_16x16x32_bf16 v[72:75], v[184:187], a[248:251], v[72:75]
  v_mfma_f32_16x16x32_bf16 v[76:79], v[184:187], a[252:255], v[76:79]
  s_waitcnt lgkmcnt(6)
  v_mfma_f32_16x16x32_bf16 v[80:83], v[188:191], a[240:243], v[80:83]
  ds_read_b64_tr_b16 v[172:173], v13 offset:28672
  ds_read_b64_tr_b16 v[174:175], v13 offset:30720
  v_mfma_f32_16x16x32_bf16 v[84:87], v[188:191], a[244:247], v[84:87]
  v_mfma_f32_16x16x32_bf16 v[88:91], v[188:191], a[248:251], v[88:91]
  v_mfma_f32_16x16x32_bf16 v[92:95], v[188:191], a[252:255], v[92:95]
  s_waitcnt lgkmcnt(6)
  v_mfma_f32_16x16x32_bf16 v[32:35], v[160:163], v[224:227], v[32:35]
  ds_read_b64_tr_b16 v[176:177], v8 offset:0
  ds_read_b64_tr_b16 v[178:179], v8 offset:2048
  v_mfma_f32_16x16x32_bf16 v[36:39], v[160:163], v[228:231], v[36:39]
  v_mfma_f32_16x16x32_bf16 v[40:43], v[160:163], v[232:235], v[40:43]
  v_mfma_f32_16x16x32_bf16 v[44:47], v[160:163], v[236:239], v[44:47]
  s_waitcnt lgkmcnt(6)
  v_mfma_f32_16x16x32_bf16 v[48:51], v[164:167], v[224:227], v[48:51]
  ds_read_b64_tr_b16 v[180:181], v9 offset:0
  ds_read_b64_tr_b16 v[182:183], v9 offset:2048
  v_mfma_f32_16x16x32_bf16 v[52:55], v[164:167], v[228:231], v[52:55]
  v_mfma_f32_16x16x32_bf16 v[56:59], v[164:167], v[232:235], v[56:59]
  v_mfma_f32_16x16x32_bf16 v[60:63], v[164:167], v[236:239], v[60:63]
  s_waitcnt lgkmcnt(6)
  v_mfma_f32_16x16x32_bf16 v[64:67], v[168:171], v[224:227], v[64:67]
  ds_read_b64_tr_b16 v[184:185], v8 offset:4096
  ds_read_b64_tr_b16 v[186:187], v8 offset:6144
  v_mfma_f32_16x16x32_bf16 v[68:71], v[168:171], v[228:231], v[68:71]
  v_mfma_f32_16x16x32_bf16 v[72:75], v[168:171], v[232:235], v[72:75]
  v_mfma_f32_16x16x32_bf16 v[76:79], v[168:171], v[236:239], v[76:79]
  s_waitcnt lgkmcnt(6)
  v_mfma_f32_16x16x32_bf16 v[80:83], v[172:175], v[224:227], v[80:83]
  ds_read_b64_tr_b16 v[188:189], v9 offset:4096
  ds_read_b64_tr_b16 v[190:191], v9 offset:6144
  v_mfma_f32_16x16x32_bf16 v[84:87], v[172:175], v[228:231], v[84:87]
  v_mfma_f32_16x16x32_bf16 v[88:91], v[172:175], v[232:235], v[88:91]
  v_mfma_f32_16x16x32_bf16 v[92:95], v[172:175], v[236:239], v[92:95]
  s_waitcnt lgkmcnt(6)
  v_mfma_f32_16x16x32_bf16 v[32:35], v[176:179], v[240:243], v[32:35]
  s_waitcnt vmcnt(25)
  s_barrier
  ds_read_b64_tr_b16 v[160:161], v8 offset:49152
  ds_read_b64_tr_b16 v[162:163], v8 offset:51200
  v_mfma_f32_16x16x32_bf16 v[36:39], v[176:179], v[244:247], v[36:39]
  s_add_u32 m0, s32, 155392
  v_mfma_f32_16x16x32_bf16 v[40:43], v[176:179], v[248:251], v[40:43]
  buffer_load_dwordx4 v3, s[12:15], s72 offen offset:256 lds
  v_mfma_f32_16x16x32_bf16 v[44:47], v[176:179], v[252:255], v[44:47]
  s_waitcnt lgkmcnt(6)
  v_mfma_f32_16x16x32_bf16 v[48:51], v[180:183], v[240:243], v[48:51]
  ds_read_b64_tr_b16 v[164:165], v9 offset:49152
  ds_read_b64_tr_b16 v[166:167], v9 offset:51200
  v_mfma_f32_16x16x32_bf16 v[52:55], v[180:183], v[244:247], v[52:55]
  s_add_u32 m0, s32, 159488
  v_mfma_f32_16x16x32_bf16 v[56:59], v[180:183], v[248:251], v[56:59]
  buffer_load_dwordx4 v3, s[16:19], s72 offen offset:256 lds
  v_mfma_f32_16x16x32_bf16 v[60:63], v[180:183], v[252:255], v[60:63]
  v_cvt_pk_bf16_f32 v128, v32, v33
  v_cvt_pk_bf16_f32 v129, v34, v35
  s_waitcnt lgkmcnt(6)
  v_mfma_f32_16x16x32_bf16 v[64:67], v[184:187], v[240:243], v[64:67]
  v_cvt_pk_bf16_f32 v132, v36, v37
  v_cvt_pk_bf16_f32 v133, v38, v39
  ds_read_b64_tr_b16 v[168:169], v8 offset:53248
  ds_read_b64_tr_b16 v[170:171], v8 offset:55296
  v_mfma_f32_16x16x32_bf16 v[68:71], v[184:187], v[244:247], v[68:71]
  v_cvt_pk_bf16_f32 v136, v40, v41
  v_cvt_pk_bf16_f32 v137, v42, v43
  s_add_u32 m0, s32, 32512
  v_mfma_f32_16x16x32_bf16 v[72:75], v[184:187], v[248:251], v[72:75]
  buffer_load_dwordx4 v3, s[12:15], s73 offen offset:256 lds
  v_cvt_pk_bf16_f32 v140, v44, v45
  v_cvt_pk_bf16_f32 v141, v46, v47
  v_mfma_f32_16x16x32_bf16 v[76:79], v[184:187], v[252:255], v[76:79]
  v_cvt_pk_bf16_f32 v130, v48, v49
  v_cvt_pk_bf16_f32 v131, v50, v51
  s_waitcnt lgkmcnt(6)
  v_mfma_f32_16x16x32_bf16 v[80:83], v[188:191], v[240:243], v[80:83]
  v_cvt_pk_bf16_f32 v134, v52, v53
  v_cvt_pk_bf16_f32 v135, v54, v55
  ds_read_b64_tr_b16 v[172:173], v9 offset:53248
  ds_read_b64_tr_b16 v[174:175], v9 offset:55296
  v_mfma_f32_16x16x32_bf16 v[84:87], v[188:191], v[244:247], v[84:87]
  v_cvt_pk_bf16_f32 v138, v56, v57
  v_cvt_pk_bf16_f32 v139, v58, v59
  s_add_u32 m0, s32, 36608
  v_mfma_f32_16x16x32_bf16 v[88:91], v[188:191], v[248:251], v[88:91]
  buffer_load_dwordx4 v3, s[16:19], s73 offen offset:256 lds
  v_cvt_pk_bf16_f32 v142, v60, v61
  v_cvt_pk_bf16_f32 v143, v62, v63
  v_mfma_f32_16x16x32_bf16 v[92:95], v[188:191], v[252:255], v[92:95]
  v_cvt_pk_bf16_f32 v144, v64, v65
  v_cvt_pk_bf16_f32 v145, v66, v67
  s_waitcnt lgkmcnt(6)
  v_mfma_f32_16x16x32_bf16 v[32:35], v[160:163], a[0:3], 0
  v_cvt_pk_bf16_f32 v148, v68, v69
  v_cvt_pk_bf16_f32 v149, v70, v71
  ds_read_b64_tr_b16 v[176:177], v8 offset:57344
  ds_read_b64_tr_b16 v[178:179], v8 offset:59392
  v_mfma_f32_16x16x32_bf16 v[36:39], v[160:163], a[4:7], 0
  v_cvt_pk_bf16_f32 v152, v72, v73
  v_cvt_pk_bf16_f32 v153, v74, v75
  s_add_u32 m0, s32, 40704
  v_mfma_f32_16x16x32_bf16 v[40:43], v[160:163], a[8:11], 0
  buffer_load_dwordx4 v3, s[12:15], s74 offen offset:256 lds
  v_cvt_pk_bf16_f32 v156, v76, v77
  v_cvt_pk_bf16_f32 v157, v78, v79
  v_mfma_f32_16x16x32_bf16 v[44:47], v[160:163], a[12:15], 0
  v_cvt_pk_bf16_f32 v146, v80, v81
  v_cvt_pk_bf16_f32 v147, v82, v83
  s_waitcnt lgkmcnt(6)
  v_mfma_f32_16x16x32_bf16 v[48:51], v[164:167], a[0:3], 0
  v_cvt_pk_bf16_f32 v150, v84, v85
  v_cvt_pk_bf16_f32 v151, v86, v87
  ds_read_b64_tr_b16 v[180:181], v9 offset:57344
  ds_read_b64_tr_b16 v[182:183], v9 offset:59392
  v_mfma_f32_16x16x32_bf16 v[52:55], v[164:167], a[4:7], 0
  v_cvt_pk_bf16_f32 v154, v88, v89
  v_cvt_pk_bf16_f32 v155, v90, v91
  s_add_u32 m0, s32, 44800
  v_mfma_f32_16x16x32_bf16 v[56:59], v[164:167], a[8:11], 0
  buffer_load_dwordx4 v3, s[16:19], s74 offen offset:256 lds
  v_cvt_pk_bf16_f32 v158, v92, v93
  v_cvt_pk_bf16_f32 v159, v94, v95
  v_mfma_f32_16x16x32_bf16 v[60:63], v[164:167], a[12:15], 0
  v_pk_max_i16 v128, v128, 0
  s_waitcnt lgkmcnt(6)
  v_mfma_f32_16x16x32_bf16 v[64:67], v[168:171], a[0:3], 0
  ds_read_b64_tr_b16 v[184:185], v8 offset:61440
  ds_read_b64_tr_b16 v[186:187], v8 offset:63488
  v_mfma_f32_16x16x32_bf16 v[68:71], v[168:171], a[4:7], 0
  v_lshlrev_b32 v25, 16, v144
  v_and_b32 v27, s33, v144
  v_mfma_f32_16x16x32_bf16 v[72:75], v[168:171], a[8:11], 0
  v_lshlrev_b32 v24, 16, v128
  v_and_b32 v26, s33, v128
  v_mfma_f32_16x16x32_bf16 v[76:79], v[168:171], a[12:15], 0
  v_mul_f32 v24, v24, v25
  s_waitcnt lgkmcnt(6)
  v_mfma_f32_16x16x32_bf16 v[80:83], v[172:175], a[0:3], 0
  ds_read_b64_tr_b16 v[188:189], v9 offset:61440
  ds_read_b64_tr_b16 v[190:191], v9 offset:63488
  v_mfma_f32_16x16x32_bf16 v[84:87], v[172:175], a[4:7], 0
  v_mul_f32 v26, v26, v27
  v_cvt_pk_bf16_f32 v128, v24, v26
  v_mfma_f32_16x16x32_bf16 v[88:91], v[172:175], a[8:11], 0
  v_pk_max_i16 v129, v129, 0
  v_lshlrev_b32 v29, 16, v145
  v_mfma_f32_16x16x32_bf16 v[92:95], v[172:175], a[12:15], 0
  v_and_b32 v31, s33, v145
  s_waitcnt lgkmcnt(6)
  v_mfma_f32_16x16x32_bf16 v[32:35], v[176:179], a[16:19], v[32:35]
  ds_read_b64_tr_b16 v[160:161], v10 offset:0
  ds_read_b64_tr_b16 v[162:163], v10 offset:2048
  v_mfma_f32_16x16x32_bf16 v[36:39], v[176:179], a[20:23], v[36:39]
  v_lshlrev_b32 v28, 16, v129
  v_and_b32 v30, s33, v129
  v_mfma_f32_16x16x32_bf16 v[40:43], v[176:179], a[24:27], v[40:43]
  v_mul_f32 v28, v28, v29
  v_mul_f32 v30, v30, v31
  v_mfma_f32_16x16x32_bf16 v[44:47], v[176:179], a[28:31], v[44:47]
  v_cvt_pk_bf16_f32 v129, v28, v30
  s_waitcnt lgkmcnt(6)
  v_mfma_f32_16x16x32_bf16 v[48:51], v[180:183], a[16:19], v[48:51]
  ds_read_b64_tr_b16 v[164:165], v11 offset:0
  ds_read_b64_tr_b16 v[166:167], v11 offset:2048
  v_mfma_f32_16x16x32_bf16 v[52:55], v[180:183], a[20:23], v[52:55]
  v_pk_max_i16 v130, v130, 0
  v_lshlrev_b32 v25, 16, v146
  v_mfma_f32_16x16x32_bf16 v[56:59], v[180:183], a[24:27], v[56:59]
  v_and_b32 v27, s33, v146
  v_lshlrev_b32 v24, 16, v130
  v_mfma_f32_16x16x32_bf16 v[60:63], v[180:183], a[28:31], v[60:63]
  v_and_b32 v26, s33, v130
  s_waitcnt lgkmcnt(6)
  v_mfma_f32_16x16x32_bf16 v[64:67], v[184:187], a[16:19], v[64:67]
  ds_read_b64_tr_b16 v[168:169], v10 offset:4096
  ds_read_b64_tr_b16 v[170:171], v10 offset:6144
  v_mfma_f32_16x16x32_bf16 v[68:71], v[184:187], a[20:23], v[68:71]
  v_mul_f32 v24, v24, v25
  v_mul_f32 v26, v26, v27
  v_mfma_f32_16x16x32_bf16 v[72:75], v[184:187], a[24:27], v[72:75]
  v_cvt_pk_bf16_f32 v130, v24, v26
  v_pk_max_i16 v131, v131, 0
  v_mfma_f32_16x16x32_bf16 v[76:79], v[184:187], a[28:31], v[76:79]
  v_lshlrev_b32 v29, 16, v147
  s_waitcnt lgkmcnt(6)
  v_mfma_f32_16x16x32_bf16 v[80:83], v[188:191], a[16:19], v[80:83]
  ds_read_b64_tr_b16 v[172:173], v11 offset:4096
  ds_read_b64_tr_b16 v[174:175], v11 offset:6144
  v_mfma_f32_16x16x32_bf16 v[84:87], v[188:191], a[20:23], v[84:87]
  v_and_b32 v31, s33, v147
  v_lshlrev_b32 v28, 16, v131
  v_mfma_f32_16x16x32_bf16 v[88:91], v[188:191], a[24:27], v[88:91]
  v_and_b32 v30, s33, v131
  v_mul_f32 v28, v28, v29
  v_mfma_f32_16x16x32_bf16 v[92:95], v[188:191], a[28:31], v[92:95]
  v_mul_f32 v30, v30, v31
  s_waitcnt lgkmcnt(6)
  v_mfma_f32_16x16x32_bf16 v[32:35], v[160:163], a[32:35], v[32:35]
  s_waitcnt vmcnt(22)
  s_barrier
  ds_read_b64_tr_b16 v[176:177], v10 offset:8192
  ds_read_b64_tr_b16 v[178:179], v10 offset:10240
  v_mfma_f32_16x16x32_bf16 v[36:39], v[160:163], a[36:39], v[36:39]
  s_add_u32 s47, s75, 256
  s_add_u32 m0, s32, 0
  v_mfma_f32_16x16x32_bf16 v[40:43], v[160:163], a[40:43], v[40:43]
  buffer_load_dwordx4 v3, s[12:15], s47 offen offset:0 lds
  v_cvt_pk_bf16_f32 v131, v28, v30
  v_mfma_f32_16x16x32_bf16 v[44:47], v[160:163], a[44:47], v[44:47]
  ds_write_b128 v20, v[128:131] offset:40960
  s_waitcnt lgkmcnt(7)
  v_mfma_f32_16x16x32_bf16 v[48:51], v[164:167], a[32:35], v[48:51]
  ds_read_b64_tr_b16 v[180:181], v11 offset:8192
  ds_read_b64_tr_b16 v[182:183], v11 offset:10240
  v_mfma_f32_16x16x32_bf16 v[52:55], v[164:167], a[36:39], v[52:55]
  s_add_u32 m0, s32, 3840
  buffer_store_dwordx4 v[128:131], v5, s[8:11], s57 offen offset:0 sc1
  v_mfma_f32_16x16x32_bf16 v[56:59], v[164:167], a[40:43], v[56:59]
  buffer_load_dwordx4 v3, s[16:19], s75 offen offset:256 lds
  v_pk_max_i16 v132, v132, 0
  v_mfma_f32_16x16x32_bf16 v[60:63], v[164:167], a[44:47], v[60:63]
  v_lshlrev_b32 v25, 16, v148
  s_waitcnt lgkmcnt(7)
  v_mfma_f32_16x16x32_bf16 v[64:67], v[168:171], a[32:35], v[64:67]
  ds_read_b64_tr_b16 v[184:185], v10 offset:12288
  ds_read_b64_tr_b16 v[186:187], v10 offset:14336
  v_mfma_f32_16x16x32_bf16 v[68:71], v[168:171], a[36:39], v[68:71]
  s_add_u32 m0, s32, 48896
  v_and_b32 v27, s33, v148
  v_mfma_f32_16x16x32_bf16 v[72:75], v[168:171], a[40:43], v[72:75]
  buffer_load_dwordx4 v3, s[12:15], s76 offen offset:256 lds
  v_lshlrev_b32 v24, 16, v132
  v_mfma_f32_16x16x32_bf16 v[76:79], v[168:171], a[44:47], v[76:79]
  v_and_b32 v26, s33, v132
  s_waitcnt lgkmcnt(7)
  v_mfma_f32_16x16x32_bf16 v[80:83], v[172:175], a[32:35], v[80:83]
  ds_read_b64_tr_b16 v[188:189], v11 offset:12288
  ds_read_b64_tr_b16 v[190:191], v11 offset:14336
  v_mfma_f32_16x16x32_bf16 v[84:87], v[172:175], a[36:39], v[84:87]
  s_add_u32 m0, s32, 52992
  v_mul_f32 v24, v24, v25
  v_mfma_f32_16x16x32_bf16 v[88:91], v[172:175], a[40:43], v[88:91]
  buffer_load_dwordx4 v3, s[16:19], s76 offen offset:256 lds
  v_mul_f32 v26, v26, v27
  v_mfma_f32_16x16x32_bf16 v[92:95], v[172:175], a[44:47], v[92:95]
  v_cvt_pk_bf16_f32 v132, v24, v26
  s_waitcnt lgkmcnt(7)
  v_mfma_f32_16x16x32_bf16 v[32:35], v[176:179], a[48:51], v[32:35]
  ds_read_b64_tr_b16 v[160:161], v10 offset:16384
  ds_read_b64_tr_b16 v[162:163], v10 offset:18432
  v_mfma_f32_16x16x32_bf16 v[36:39], v[176:179], a[52:55], v[36:39]
  s_add_u32 m0, s32, 57088
  v_pk_max_i16 v133, v133, 0
  v_mfma_f32_16x16x32_bf16 v[40:43], v[176:179], a[56:59], v[40:43]
  buffer_load_dwordx4 v3, s[12:15], s77 offen offset:256 lds
  v_lshlrev_b32 v29, 16, v149
  v_mfma_f32_16x16x32_bf16 v[44:47], v[176:179], a[60:63], v[44:47]
  v_and_b32 v31, s33, v149
  s_waitcnt lgkmcnt(6)
  v_mfma_f32_16x16x32_bf16 v[48:51], v[180:183], a[48:51], v[48:51]
  ds_read_b64_tr_b16 v[164:165], v11 offset:16384
  ds_read_b64_tr_b16 v[166:167], v11 offset:18432
  v_mfma_f32_16x16x32_bf16 v[52:55], v[180:183], a[52:55], v[52:55]
  s_add_u32 m0, s32, 61184
  v_lshlrev_b32 v28, 16, v133
  v_mfma_f32_16x16x32_bf16 v[56:59], v[180:183], a[56:59], v[56:59]
  buffer_load_dwordx4 v3, s[16:19], s77 offen offset:256 lds
  v_and_b32 v30, s33, v133
  v_mfma_f32_16x16x32_bf16 v[60:63], v[180:183], a[60:63], v[60:63]
  v_mul_f32 v28, v28, v29
  s_waitcnt lgkmcnt(6)
  v_mfma_f32_16x16x32_bf16 v[64:67], v[184:187], a[48:51], v[64:67]
  ds_read_b64_tr_b16 v[168:169], v10 offset:20480
  ds_read_b64_tr_b16 v[170:171], v10 offset:22528
  v_mfma_f32_16x16x32_bf16 v[68:71], v[184:187], a[52:55], v[68:71]
  v_mul_f32 v30, v30, v31
  v_cvt_pk_bf16_f32 v133, v28, v30
  v_mfma_f32_16x16x32_bf16 v[72:75], v[184:187], a[56:59], v[72:75]
  v_pk_max_i16 v134, v134, 0
  v_lshlrev_b32 v25, 16, v150
  v_mfma_f32_16x16x32_bf16 v[76:79], v[184:187], a[60:63], v[76:79]
  v_and_b32 v27, s33, v150
  s_waitcnt lgkmcnt(6)
  v_mfma_f32_16x16x32_bf16 v[80:83], v[188:191], a[48:51], v[80:83]
  ds_read_b64_tr_b16 v[172:173], v11 offset:20480
  ds_read_b64_tr_b16 v[174:175], v11 offset:22528
  v_mfma_f32_16x16x32_bf16 v[84:87], v[188:191], a[52:55], v[84:87]
  v_lshlrev_b32 v24, 16, v134
  v_and_b32 v26, s33, v134
  v_mfma_f32_16x16x32_bf16 v[88:91], v[188:191], a[56:59], v[88:91]
  v_mul_f32 v24, v24, v25
  v_mul_f32 v26, v26, v27
  v_mfma_f32_16x16x32_bf16 v[92:95], v[188:191], a[60:63], v[92:95]
  v_cvt_pk_bf16_f32 v134, v24, v26
  s_waitcnt lgkmcnt(6)
  v_mfma_f32_16x16x32_bf16 v[32:35], v[160:163], a[64:67], v[32:35]
  ds_read_b64_tr_b16 v[176:177], v8 offset:8192
  ds_read_b64_tr_b16 v[178:179], v8 offset:10240
  v_mfma_f32_16x16x32_bf16 v[36:39], v[160:163], a[68:71], v[36:39]
  v_pk_max_i16 v135, v135, 0
  v_lshlrev_b32 v29, 16, v151
  v_mfma_f32_16x16x32_bf16 v[40:43], v[160:163], a[72:75], v[40:43]
  v_and_b32 v31, s33, v151
  v_lshlrev_b32 v28, 16, v135
  v_mfma_f32_16x16x32_bf16 v[44:47], v[160:163], a[76:79], v[44:47]
  v_and_b32 v30, s33, v135
  s_waitcnt lgkmcnt(6)
  v_mfma_f32_16x16x32_bf16 v[48:51], v[164:167], a[64:67], v[48:51]
  ds_read_b64_tr_b16 v[180:181], v9 offset:8192
  ds_read_b64_tr_b16 v[182:183], v9 offset:10240
  v_mfma_f32_16x16x32_bf16 v[52:55], v[164:167], a[68:71], v[52:55]
  v_mul_f32 v28, v28, v29
  v_mul_f32 v30, v30, v31
  v_mfma_f32_16x16x32_bf16 v[56:59], v[164:167], a[72:75], v[56:59]
  v_cvt_pk_bf16_f32 v135, v28, v30
  ds_write_b128 v20, v[132:135] offset:41984
  v_mfma_f32_16x16x32_bf16 v[60:63], v[164:167], a[76:79], v[60:63]
  buffer_store_dwordx4 v[132:135], v5, s[8:11], s57 offen offset:1024 sc1
  s_waitcnt lgkmcnt(7)
  v_mfma_f32_16x16x32_bf16 v[64:67], v[168:171], a[64:67], v[64:67]
  ds_read_b64_tr_b16 v[184:185], v8 offset:12288
  ds_read_b64_tr_b16 v[186:187], v8 offset:14336
  v_mfma_f32_16x16x32_bf16 v[68:71], v[168:171], a[68:71], v[68:71]
  v_pk_max_i16 v136, v136, 0
  v_lshlrev_b32 v25, 16, v152
  v_mfma_f32_16x16x32_bf16 v[72:75], v[168:171], a[72:75], v[72:75]
  v_and_b32 v27, s33, v152
  v_lshlrev_b32 v24, 16, v136
  v_mfma_f32_16x16x32_bf16 v[76:79], v[168:171], a[76:79], v[76:79]
  v_and_b32 v26, s33, v136
  s_waitcnt lgkmcnt(7)
  v_mfma_f32_16x16x32_bf16 v[80:83], v[172:175], a[64:67], v[80:83]
  ds_read_b64_tr_b16 v[188:189], v9 offset:12288
  ds_read_b64_tr_b16 v[190:191], v9 offset:14336
  v_mfma_f32_16x16x32_bf16 v[84:87], v[172:175], a[68:71], v[84:87]
  v_mul_f32 v24, v24, v25
  v_mul_f32 v26, v26, v27
  v_mfma_f32_16x16x32_bf16 v[88:91], v[172:175], a[72:75], v[88:91]
  v_cvt_pk_bf16_f32 v136, v24, v26
  v_pk_max_i16 v137, v137, 0
  v_mfma_f32_16x16x32_bf16 v[92:95], v[172:175], a[76:79], v[92:95]
  v_lshlrev_b32 v29, 16, v153
  s_waitcnt lgkmcnt(7)
  v_mfma_f32_16x16x32_bf16 v[32:35], v[176:179], a[80:83], v[32:35]
  s_waitcnt vmcnt(23)
  s_waitcnt lgkmcnt(4)
  s_barrier
  ds_read_b64_tr_b16 v[160:161], v10 offset:57344
  ds_read_b64_tr_b16 v[162:163], v10 offset:59392
  v_mfma_f32_16x16x32_bf16 v[36:39], v[176:179], a[84:87], v[36:39]
  s_add_u32 m0, s32, 65152
  v_and_b32 v31, s33, v153
  v_mfma_f32_16x16x32_bf16 v[40:43], v[176:179], a[88:91], v[40:43]
  buffer_load_dwordx4 v3, s[12:15], s60 offen offset:384 lds
  v_lshlrev_b32 v28, 16, v137
  v_mfma_f32_16x16x32_bf16 v[44:47], v[176:179], a[92:95], v[44:47]
  v_and_b32 v30, s33, v137
  v_mfma_f32_16x16x32_bf16 v[48:51], v[180:183], a[80:83], v[48:51]
  ds_read_b64_tr_b16 v[164:165], v11 offset:57344
  ds_read_b64_tr_b16 v[166:167], v11 offset:59392
  v_mfma_f32_16x16x32_bf16 v[52:55], v[180:183], a[84:87], v[52:55]
  s_add_u32 m0, s32, 69248
  v_mul_f32 v28, v28, v29
  v_mfma_f32_16x16x32_bf16 v[56:59], v[180:183], a[88:91], v[56:59]
  buffer_load_dwordx4 v3, s[16:19], s60 offen offset:384 lds
  v_mul_f32 v30, v30, v31
  v_mfma_f32_16x16x32_bf16 v[60:63], v[180:183], a[92:95], v[60:63]
  v_cvt_pk_bf16_f32 v137, v28, v30
  s_waitcnt lgkmcnt(6)
  v_mfma_f32_16x16x32_bf16 v[64:67], v[184:187], a[80:83], v[64:67]
  ds_read_b64_tr_b16 v[168:169], v10 offset:61440
  ds_read_b64_tr_b16 v[170:171], v10 offset:63488
  v_mfma_f32_16x16x32_bf16 v[68:71], v[184:187], a[84:87], v[68:71]
  s_add_u32 m0, s32, 73344
  v_pk_max_i16 v138, v138, 0
  v_mfma_f32_16x16x32_bf16 v[72:75], v[184:187], a[88:91], v[72:75]
  buffer_load_dwordx4 v3, s[12:15], s61 offen offset:384 lds
  v_lshlrev_b32 v25, 16, v154
  v_mfma_f32_16x16x32_bf16 v[76:79], v[184:187], a[92:95], v[76:79]
  v_and_b32 v27, s33, v154
  s_waitcnt lgkmcnt(6)
  v_mfma_f32_16x16x32_bf16 v[80:83], v[188:191], a[80:83], v[80:83]
  ds_read_b64_tr_b16 v[172:173], v11 offset:61440
  ds_read_b64_tr_b16 v[174:175], v11 offset:63488
  v_mfma_f32_16x16x32_bf16 v[84:87], v[188:191], a[84:87], v[84:87]
  s_add_u32 m0, s32, 77440
  v_lshlrev_b32 v24, 16, v138
  v_mfma_f32_16x16x32_bf16 v[88:91], v[188:191], a[88:91], v[88:91]
  buffer_load_dwordx4 v3, s[16:19], s61 offen offset:384 lds
  v_and_b32 v26, s33, v138
  v_mfma_f32_16x16x32_bf16 v[92:95], v[188:191], a[92:95], v[92:95]
  v_mul_f32 v24, v24, v25
  s_waitcnt lgkmcnt(6)
  v_mfma_f32_16x16x32_bf16 v[32:35], v[160:163], a[96:99], v[32:35]
  ds_read_b64_tr_b16 v[176:177], v8 offset:16384
  ds_read_b64_tr_b16 v[178:179], v8 offset:18432
  v_mfma_f32_16x16x32_bf16 v[36:39], v[160:163], a[100:103], v[36:39]
  s_add_u32 m0, s32, 81536
  v_mul_f32 v26, v26, v27
  v_mfma_f32_16x16x32_bf16 v[40:43], v[160:163], a[104:107], v[40:43]
  buffer_load_dwordx4 v3, s[12:15], s62 offen offset:384 lds
  v_cvt_pk_bf16_f32 v138, v24, v26
  v_mfma_f32_16x16x32_bf16 v[44:47], v[160:163], a[108:111], v[44:47]
  v_pk_max_i16 v139, v139, 0
  s_waitcnt lgkmcnt(6)
  v_mfma_f32_16x16x32_bf16 v[48:51], v[164:167], a[96:99], v[48:51]
  ds_read_b64_tr_b16 v[180:181], v9 offset:16384
  ds_read_b64_tr_b16 v[182:183], v9 offset:18432
  v_mfma_f32_16x16x32_bf16 v[52:55], v[164:167], a[100:103], v[52:55]
  s_add_u32 m0, s32, 85632
  v_lshlrev_b32 v29, 16, v155
  v_mfma_f32_16x16x32_bf16 v[56:59], v[164:167], a[104:107], v[56:59]
  buffer_load_dwordx4 v3, s[16:19], s62 offen offset:384 lds
  v_and_b32 v31, s33, v155
  v_mfma_f32_16x16x32_bf16 v[60:63], v[164:167], a[108:111], v[60:63]
  v_lshlrev_b32 v28, 16, v139
  s_waitcnt lgkmcnt(6)
  v_mfma_f32_16x16x32_bf16 v[64:67], v[168:171], a[96:99], v[64:67]
  ds_read_b64_tr_b16 v[184:185], v8 offset:20480
  ds_read_b64_tr_b16 v[186:187], v8 offset:22528
  v_mfma_f32_16x16x32_bf16 v[68:71], v[168:171], a[100:103], v[68:71]
  v_and_b32 v30, s33, v139
  v_mul_f32 v28, v28, v29
  v_mfma_f32_16x16x32_bf16 v[72:75], v[168:171], a[104:107], v[72:75]
  v_mul_f32 v30, v30, v31
  v_cvt_pk_bf16_f32 v139, v28, v30
  v_mfma_f32_16x16x32_bf16 v[76:79], v[168:171], a[108:111], v[76:79]
  ds_write_b128 v20, v[136:139] offset:43008
  s_waitcnt lgkmcnt(7)
  v_mfma_f32_16x16x32_bf16 v[80:83], v[172:175], a[96:99], v[80:83]
  ds_read_b64_tr_b16 v[188:189], v9 offset:20480
  ds_read_b64_tr_b16 v[190:191], v9 offset:22528
  v_mfma_f32_16x16x32_bf16 v[84:87], v[172:175], a[100:103], v[84:87]
  buffer_store_dwordx4 v[136:139], v5, s[8:11], s57 offen offset:2048 sc1
  v_pk_max_i16 v140, v140, 0
  v_mfma_f32_16x16x32_bf16 v[88:91], v[172:175], a[104:107], v[88:91]
  v_lshlrev_b32 v25, 16, v156
  v_and_b32 v27, s33, v156
  v_mfma_f32_16x16x32_bf16 v[92:95], v[172:175], a[108:111], v[92:95]
  v_lshlrev_b32 v24, 16, v140
  s_waitcnt lgkmcnt(7)
  v_mfma_f32_16x16x32_bf16 v[32:35], v[176:179], a[112:115], v[32:35]
  ds_read_b64_tr_b16 v[160:161], v8 offset:24576
  ds_read_b64_tr_b16 v[162:163], v8 offset:26624
  v_mfma_f32_16x16x32_bf16 v[36:39], v[176:179], a[116:119], v[36:39]
  v_and_b32 v26, s33, v140
  v_mul_f32 v24, v24, v25
  v_mfma_f32_16x16x32_bf16 v[40:43], v[176:179], a[120:123], v[40:43]
  v_mul_f32 v26, v26, v27
  v_cvt_pk_bf16_f32 v140, v24, v26
  v_mfma_f32_16x16x32_bf16 v[44:47], v[176:179], a[124:127], v[44:47]
  v_pk_max_i16 v141, v141, 0
  s_waitcnt lgkmcnt(7)
  v_mfma_f32_16x16x32_bf16 v[48:51], v[180:183], a[112:115], v[48:51]
  ds_read_b64_tr_b16 v[164:165], v9 offset:24576
  ds_read_b64_tr_b16 v[166:167], v9 offset:26624
  v_mfma_f32_16x16x32_bf16 v[52:55], v[180:183], a[116:119], v[52:55]
  v_lshlrev_b32 v29, 16, v157
  v_and_b32 v31, s33, v157
  v_mfma_f32_16x16x32_bf16 v[56:59], v[180:183], a[120:123], v[56:59]
  v_lshlrev_b32 v28, 16, v141
  v_and_b32 v30, s33, v141
  v_mfma_f32_16x16x32_bf16 v[60:63], v[180:183], a[124:127], v[60:63]
  v_mul_f32 v28, v28, v29
  s_waitcnt lgkmcnt(7)
  v_mfma_f32_16x16x32_bf16 v[64:67], v[184:187], a[112:115], v[64:67]
  ds_read_b64_tr_b16 v[168:169], v8 offset:28672
  ds_read_b64_tr_b16 v[170:171], v8 offset:30720
  v_mfma_f32_16x16x32_bf16 v[68:71], v[184:187], a[116:119], v[68:71]
  v_mul_f32 v30, v30, v31
  v_cvt_pk_bf16_f32 v141, v28, v30
  v_mfma_f32_16x16x32_bf16 v[72:75], v[184:187], a[120:123], v[72:75]
  v_pk_max_i16 v142, v142, 0
  v_lshlrev_b32 v25, 16, v158
  v_mfma_f32_16x16x32_bf16 v[76:79], v[184:187], a[124:127], v[76:79]
  v_and_b32 v27, s33, v158
  s_waitcnt lgkmcnt(6)
  v_mfma_f32_16x16x32_bf16 v[80:83], v[188:191], a[112:115], v[80:83]
  ds_read_b64_tr_b16 v[172:173], v9 offset:28672
  ds_read_b64_tr_b16 v[174:175], v9 offset:30720
  v_mfma_f32_16x16x32_bf16 v[84:87], v[188:191], a[116:119], v[84:87]
  v_lshlrev_b32 v24, 16, v142
  v_and_b32 v26, s33, v142
  v_mfma_f32_16x16x32_bf16 v[88:91], v[188:191], a[120:123], v[88:91]
  v_mul_f32 v24, v24, v25
  v_mul_f32 v26, v26, v27
  v_mfma_f32_16x16x32_bf16 v[92:95], v[188:191], a[124:127], v[92:95]
  v_cvt_pk_bf16_f32 v142, v24, v26
  s_waitcnt lgkmcnt(6)
  v_mfma_f32_16x16x32_bf16 v[32:35], v[160:163], a[128:131], v[32:35]
  s_waitcnt vmcnt(21)
  s_barrier
  ds_read_b64_tr_b16 v[176:177], v12 offset:0
  ds_read_b64_tr_b16 v[178:179], v12 offset:2048
  v_mfma_f32_16x16x32_bf16 v[36:39], v[160:163], a[132:135], v[36:39]
  s_add_u32 m0, s32, 7808
  v_pk_max_i16 v143, v143, 0
  v_mfma_f32_16x16x32_bf16 v[40:43], v[160:163], a[136:139], v[40:43]
  buffer_load_dwordx4 v3, s[12:15], s63 offen offset:384 lds
  v_lshlrev_b32 v29, 16, v159
  v_mfma_f32_16x16x32_bf16 v[44:47], v[160:163], a[140:143], v[44:47]
  v_and_b32 v31, s33, v159
  s_waitcnt lgkmcnt(6)
  v_mfma_f32_16x16x32_bf16 v[48:51], v[164:167], a[128:131], v[48:51]
  ds_read_b64_tr_b16 v[180:181], v13 offset:0
  ds_read_b64_tr_b16 v[182:183], v13 offset:2048
  v_mfma_f32_16x16x32_bf16 v[52:55], v[164:167], a[132:135], v[52:55]
  s_add_u32 m0, s32, 11904
  v_lshlrev_b32 v28, 16, v143
  v_mfma_f32_16x16x32_bf16 v[56:59], v[164:167], a[136:139], v[56:59]
  buffer_load_dwordx4 v3, s[16:19], s63 offen offset:384 lds
  v_and_b32 v30, s33, v143
  v_mfma_f32_16x16x32_bf16 v[60:63], v[164:167], a[140:143], v[60:63]
  v_mul_f32 v28, v28, v29
  s_waitcnt lgkmcnt(6)
  v_mfma_f32_16x16x32_bf16 v[64:67], v[168:171], a[128:131], v[64:67]
  ds_read_b64_tr_b16 v[184:185], v12 offset:4096
  ds_read_b64_tr_b16 v[186:187], v12 offset:6144
  v_mfma_f32_16x16x32_bf16 v[68:71], v[168:171], a[132:135], v[68:71]
  s_add_u32 m0, s32, 16000
  v_mul_f32 v30, v30, v31
  v_mfma_f32_16x16x32_bf16 v[72:75], v[168:171], a[136:139], v[72:75]
  buffer_load_dwordx4 v3, s[12:15], s64 offen offset:384 lds
  v_cvt_pk_bf16_f32 v143, v28, v30
  v_mfma_f32_16x16x32_bf16 v[76:79], v[168:171], a[140:143], v[76:79]
  ds_write_b128 v20, v[140:143] offset:44032
  s_waitcnt lgkmcnt(7)
  v_mfma_f32_16x16x32_bf16 v[80:83], v[172:175], a[128:131], v[80:83]
  ds_read_b64_tr_b16 v[188:189], v13 offset:4096
  ds_read_b64_tr_b16 v[190:191], v13 offset:6144
  v_mfma_f32_16x16x32_bf16 v[84:87], v[172:175], a[132:135], v[84:87]
  s_add_u32 m0, s32, 20096
  buffer_store_dwordx4 v[140:143], v5, s[8:11], s57 offen offset:3072 sc1
  v_mfma_f32_16x16x32_bf16 v[88:91], v[172:175], a[136:139], v[88:91]
  buffer_load_dwordx4 v3, s[16:19], s64 offen offset:384 lds
  s_add_u32 s57, s57, 16384
  v_mfma_f32_16x16x32_bf16 v[92:95], v[172:175], a[140:143], v[92:95]
  s_waitcnt lgkmcnt(7)
  v_mfma_f32_16x16x32_bf16 v[32:35], v[176:179], a[144:147], v[32:35]
  ds_read_b64_tr_b16 v[160:161], v12 offset:8192
  ds_read_b64_tr_b16 v[162:163], v12 offset:10240
  v_mfma_f32_16x16x32_bf16 v[36:39], v[176:179], a[148:151], v[36:39]
  v_mfma_f32_16x16x32_bf16 v[40:43], v[176:179], a[152:155], v[40:43]
  v_mfma_f32_16x16x32_bf16 v[44:47], v[176:179], a[156:159], v[44:47]
  s_waitcnt lgkmcnt(7)
  v_mfma_f32_16x16x32_bf16 v[48:51], v[180:183], a[144:147], v[48:51]
  ds_read_b64_tr_b16 v[164:165], v13 offset:8192
  ds_read_b64_tr_b16 v[166:167], v13 offset:10240
  v_mfma_f32_16x16x32_bf16 v[52:55], v[180:183], a[148:151], v[52:55]
  v_mfma_f32_16x16x32_bf16 v[56:59], v[180:183], a[152:155], v[56:59]
  v_mfma_f32_16x16x32_bf16 v[60:63], v[180:183], a[156:159], v[60:63]
  s_waitcnt lgkmcnt(7)
  v_mfma_f32_16x16x32_bf16 v[64:67], v[184:187], a[144:147], v[64:67]
  ds_read_b64_tr_b16 v[168:169], v12 offset:12288
  ds_read_b64_tr_b16 v[170:171], v12 offset:14336
  v_mfma_f32_16x16x32_bf16 v[68:71], v[184:187], a[148:151], v[68:71]
  v_mfma_f32_16x16x32_bf16 v[72:75], v[184:187], a[152:155], v[72:75]
  v_mfma_f32_16x16x32_bf16 v[76:79], v[184:187], a[156:159], v[76:79]
  s_waitcnt lgkmcnt(6)
  v_mfma_f32_16x16x32_bf16 v[80:83], v[188:191], a[144:147], v[80:83]
  ds_read_b64_tr_b16 v[172:173], v13 offset:12288
  ds_read_b64_tr_b16 v[174:175], v13 offset:14336
  v_mfma_f32_16x16x32_bf16 v[84:87], v[188:191], a[148:151], v[84:87]
  v_mfma_f32_16x16x32_bf16 v[88:91], v[188:191], a[152:155], v[88:91]
  v_mfma_f32_16x16x32_bf16 v[92:95], v[188:191], a[156:159], v[92:95]
  s_waitcnt lgkmcnt(6)
  v_mfma_f32_16x16x32_bf16 v[32:35], v[160:163], a[160:163], v[32:35]
  ds_read_b64_tr_b16 v[176:177], v12 offset:16384
  ds_read_b64_tr_b16 v[178:179], v12 offset:18432
  v_mfma_f32_16x16x32_bf16 v[36:39], v[160:163], a[164:167], v[36:39]
  v_mfma_f32_16x16x32_bf16 v[40:43], v[160:163], a[168:171], v[40:43]
  v_mfma_f32_16x16x32_bf16 v[44:47], v[160:163], a[172:175], v[44:47]
  s_waitcnt lgkmcnt(6)
  v_mfma_f32_16x16x32_bf16 v[48:51], v[164:167], a[160:163], v[48:51]
  ds_read_b64_tr_b16 v[180:181], v13 offset:16384
  ds_read_b64_tr_b16 v[182:183], v13 offset:18432
  v_mfma_f32_16x16x32_bf16 v[52:55], v[164:167], a[164:167], v[52:55]
  v_mfma_f32_16x16x32_bf16 v[56:59], v[164:167], a[168:171], v[56:59]
  v_mfma_f32_16x16x32_bf16 v[60:63], v[164:167], a[172:175], v[60:63]
  s_waitcnt lgkmcnt(6)
  v_mfma_f32_16x16x32_bf16 v[64:67], v[168:171], a[160:163], v[64:67]
  ds_read_b64_tr_b16 v[184:185], v12 offset:20480
  ds_read_b64_tr_b16 v[186:187], v12 offset:22528
  v_mfma_f32_16x16x32_bf16 v[68:71], v[168:171], a[164:167], v[68:71]
  v_mfma_f32_16x16x32_bf16 v[72:75], v[168:171], a[168:171], v[72:75]
  v_mfma_f32_16x16x32_bf16 v[76:79], v[168:171], a[172:175], v[76:79]
  s_waitcnt lgkmcnt(6)
  v_mfma_f32_16x16x32_bf16 v[80:83], v[172:175], a[160:163], v[80:83]
  ds_read_b64_tr_b16 v[188:189], v13 offset:20480
  ds_read_b64_tr_b16 v[190:191], v13 offset:22528
  v_mfma_f32_16x16x32_bf16 v[84:87], v[172:175], a[164:167], v[84:87]
  v_mfma_f32_16x16x32_bf16 v[88:91], v[172:175], a[168:171], v[88:91]
  v_mfma_f32_16x16x32_bf16 v[92:95], v[172:175], a[172:175], v[92:95]
  s_waitcnt lgkmcnt(6)
  v_mfma_f32_16x16x32_bf16 v[32:35], v[176:179], a[176:179], v[32:35]
  s_waitcnt vmcnt(20)
  s_barrier
  ds_read_b64_tr_b16 v[160:161], v12 offset:24576
  ds_read_b64_tr_b16 v[162:163], v12 offset:26624
  v_mfma_f32_16x16x32_bf16 v[36:39], v[176:179], a[180:183], v[36:39]
  s_add_u32 m0, s32, 138880
  v_mfma_f32_16x16x32_bf16 v[40:43], v[176:179], a[184:187], v[40:43]
  buffer_load_dwordx4 v3, s[12:15], s65 offen offset:384 lds
  v_mfma_f32_16x16x32_bf16 v[44:47], v[176:179], a[188:191], v[44:47]
  s_waitcnt lgkmcnt(6)
  v_mfma_f32_16x16x32_bf16 v[48:51], v[180:183], a[176:179], v[48:51]
  ds_read_b64_tr_b16 v[164:165], v13 offset:24576
  ds_read_b64_tr_b16 v[166:167], v13 offset:26624
  v_mfma_f32_16x16x32_bf16 v[52:55], v[180:183], a[180:183], v[52:55]
  s_add_u32 m0, s32, 142976
  v_mfma_f32_16x16x32_bf16 v[56:59], v[180:183], a[184:187], v[56:59]
  buffer_load_dwordx4 v3, s[16:19], s65 offen offset:384 lds
  v_mfma_f32_16x16x32_bf16 v[60:63], v[180:183], a[188:191], v[60:63]
  s_waitcnt lgkmcnt(6)
  v_mfma_f32_16x16x32_bf16 v[64:67], v[184:187], a[176:179], v[64:67]
  ds_read_b64_tr_b16 v[168:169], v12 offset:28672
  ds_read_b64_tr_b16 v[170:171], v12 offset:30720
  v_mfma_f32_16x16x32_bf16 v[68:71], v[184:187], a[180:183], v[68:71]
  s_add_u32 m0, s32, 24192
  v_mfma_f32_16x16x32_bf16 v[72:75], v[184:187], a[184:187], v[72:75]
  buffer_load_dwordx4 v3, s[12:15], s66 offen offset:384 lds
  v_mfma_f32_16x16x32_bf16 v[76:79], v[184:187], a[188:191], v[76:79]
  s_waitcnt lgkmcnt(6)
  v_mfma_f32_16x16x32_bf16 v[80:83], v[188:191], a[176:179], v[80:83]
  ds_read_b64_tr_b16 v[172:173], v13 offset:28672
  ds_read_b64_tr_b16 v[174:175], v13 offset:30720
  v_mfma_f32_16x16x32_bf16 v[84:87], v[188:191], a[180:183], v[84:87]
  s_add_u32 m0, s32, 28288
  v_mfma_f32_16x16x32_bf16 v[88:91], v[188:191], a[184:187], v[88:91]
  buffer_load_dwordx4 v3, s[16:19], s66 offen offset:384 lds
  v_mfma_f32_16x16x32_bf16 v[92:95], v[188:191], a[188:191], v[92:95]
  s_waitcnt lgkmcnt(6)
  v_mfma_f32_16x16x32_bf16 v[32:35], v[160:163], a[192:195], v[32:35]
  ds_read_b64_tr_b16 v[176:177], v8 offset:32768
  ds_read_b64_tr_b16 v[178:179], v8 offset:34816
  v_mfma_f32_16x16x32_bf16 v[36:39], v[160:163], a[196:199], v[36:39]
  v_mfma_f32_16x16x32_bf16 v[40:43], v[160:163], a[200:203], v[40:43]
  v_mfma_f32_16x16x32_bf16 v[44:47], v[160:163], a[204:207], v[44:47]
  s_waitcnt lgkmcnt(6)
  v_mfma_f32_16x16x32_bf16 v[48:51], v[164:167], a[192:195], v[48:51]
  ds_read_b64_tr_b16 v[180:181], v9 offset:32768
  ds_read_b64_tr_b16 v[182:183], v9 offset:34816
  v_mfma_f32_16x16x32_bf16 v[52:55], v[164:167], a[196:199], v[52:55]
  v_mfma_f32_16x16x32_bf16 v[56:59], v[164:167], a[200:203], v[56:59]
  v_mfma_f32_16x16x32_bf16 v[60:63], v[164:167], a[204:207], v[60:63]
  s_waitcnt lgkmcnt(6)
  v_mfma_f32_16x16x32_bf16 v[64:67], v[168:171], a[192:195], v[64:67]
  ds_read_b64_tr_b16 v[184:185], v8 offset:36864
  ds_read_b64_tr_b16 v[186:187], v8 offset:38912
  v_mfma_f32_16x16x32_bf16 v[68:71], v[168:171], a[196:199], v[68:71]
  v_mfma_f32_16x16x32_bf16 v[72:75], v[168:171], a[200:203], v[72:75]
  v_mfma_f32_16x16x32_bf16 v[76:79], v[168:171], a[204:207], v[76:79]
  s_waitcnt lgkmcnt(6)
  v_mfma_f32_16x16x32_bf16 v[80:83], v[172:175], a[192:195], v[80:83]
  ds_read_b64_tr_b16 v[188:189], v9 offset:36864
  ds_read_b64_tr_b16 v[190:191], v9 offset:38912
  v_mfma_f32_16x16x32_bf16 v[84:87], v[172:175], a[196:199], v[84:87]
  v_mfma_f32_16x16x32_bf16 v[88:91], v[172:175], a[200:203], v[88:91]
  v_mfma_f32_16x16x32_bf16 v[92:95], v[172:175], a[204:207], v[92:95]
  s_waitcnt lgkmcnt(6)
  v_mfma_f32_16x16x32_bf16 v[32:35], v[176:179], a[208:211], v[32:35]
  ds_read_b64_tr_b16 v[160:161], v8 offset:40960
  ds_read_b64_tr_b16 v[162:163], v8 offset:43008
  v_mfma_f32_16x16x32_bf16 v[36:39], v[176:179], a[212:215], v[36:39]
  v_mfma_f32_16x16x32_bf16 v[40:43], v[176:179], a[216:219], v[40:43]
  v_mfma_f32_16x16x32_bf16 v[44:47], v[176:179], a[220:223], v[44:47]
  s_waitcnt lgkmcnt(6)
  v_mfma_f32_16x16x32_bf16 v[48:51], v[180:183], a[208:211], v[48:51]
  ds_read_b64_tr_b16 v[164:165], v9 offset:40960
  ds_read_b64_tr_b16 v[166:167], v9 offset:43008
  v_mfma_f32_16x16x32_bf16 v[52:55], v[180:183], a[212:215], v[52:55]
  v_mfma_f32_16x16x32_bf16 v[56:59], v[180:183], a[216:219], v[56:59]
  v_mfma_f32_16x16x32_bf16 v[60:63], v[180:183], a[220:223], v[60:63]
  s_waitcnt lgkmcnt(6)
  v_mfma_f32_16x16x32_bf16 v[64:67], v[184:187], a[208:211], v[64:67]
  ds_read_b64_tr_b16 v[168:169], v8 offset:45056
  ds_read_b64_tr_b16 v[170:171], v8 offset:47104
  v_mfma_f32_16x16x32_bf16 v[68:71], v[184:187], a[212:215], v[68:71]
  v_mfma_f32_16x16x32_bf16 v[72:75], v[184:187], a[216:219], v[72:75]
  v_mfma_f32_16x16x32_bf16 v[76:79], v[184:187], a[220:223], v[76:79]
  s_waitcnt lgkmcnt(6)
  v_mfma_f32_16x16x32_bf16 v[80:83], v[188:191], a[208:211], v[80:83]
  ds_read_b64_tr_b16 v[172:173], v9 offset:45056
  ds_read_b64_tr_b16 v[174:175], v9 offset:47104
  v_mfma_f32_16x16x32_bf16 v[84:87], v[188:191], a[212:215], v[84:87]
  v_mfma_f32_16x16x32_bf16 v[88:91], v[188:191], a[216:219], v[88:91]
  v_mfma_f32_16x16x32_bf16 v[92:95], v[188:191], a[220:223], v[92:95]
  s_waitcnt lgkmcnt(6)
  v_mfma_f32_16x16x32_bf16 v[32:35], v[160:163], a[224:227], v[32:35]
  s_waitcnt vmcnt(17)
  s_barrier
  ds_read_b64_tr_b16 v[176:177], v8 offset:0
  ds_read_b64_tr_b16 v[178:179], v8 offset:2048
  v_mfma_f32_16x16x32_bf16 v[36:39], v[160:163], a[228:231], v[36:39]
  s_add_u32 m0, s32, 147072
  v_mfma_f32_16x16x32_bf16 v[40:43], v[160:163], a[232:235], v[40:43]
  buffer_load_dwordx4 v3, s[12:15], s67 offen offset:384 lds
  v_mfma_f32_16x16x32_bf16 v[44:47], v[160:163], a[236:239], v[44:47]
  s_waitcnt lgkmcnt(6)
  v_mfma_f32_16x16x32_bf16 v[48:51], v[164:167], a[224:227], v[48:51]
  ds_read_b64_tr_b16 v[180:181], v9 offset:0
  ds_read_b64_tr_b16 v[182:183], v9 offset:2048
  v_mfma_f32_16x16x32_bf16 v[52:55], v[164:167], a[228:231], v[52:55]
  s_add_u32 m0, s32, 151168
  v_mfma_f32_16x16x32_bf16 v[56:59], v[164:167], a[232:235], v[56:59]
  buffer_load_dwordx4 v3, s[16:19], s67 offen offset:384 lds
  v_mfma_f32_16x16x32_bf16 v[60:63], v[164:167], a[236:239], v[60:63]
  s_waitcnt lgkmcnt(6)
  v_mfma_f32_16x16x32_bf16 v[64:67], v[168:171], a[224:227], v[64:67]
  ds_read_b64_tr_b16 v[184:185], v8 offset:4096
  ds_read_b64_tr_b16 v[186:187], v8 offset:6144
  v_mfma_f32_16x16x32_bf16 v[68:71], v[168:171], a[228:231], v[68:71]
  s_add_u32 m0, s32, 155264
  v_mfma_f32_16x16x32_bf16 v[72:75], v[168:171], a[232:235], v[72:75]
  buffer_load_dwordx4 v3, s[12:15], s68 offen offset:384 lds
  v_mfma_f32_16x16x32_bf16 v[76:79], v[168:171], a[236:239], v[76:79]
  s_waitcnt lgkmcnt(6)
  v_mfma_f32_16x16x32_bf16 v[80:83], v[172:175], a[224:227], v[80:83]
  ds_read_b64_tr_b16 v[188:189], v9 offset:4096
  ds_read_b64_tr_b16 v[190:191], v9 offset:6144
  v_mfma_f32_16x16x32_bf16 v[84:87], v[172:175], a[228:231], v[84:87]
  s_add_u32 m0, s32, 159360
  v_mfma_f32_16x16x32_bf16 v[88:91], v[172:175], a[232:235], v[88:91]
  buffer_load_dwordx4 v3, s[16:19], s68 offen offset:384 lds
  v_mfma_f32_16x16x32_bf16 v[92:95], v[172:175], a[236:239], v[92:95]
  s_waitcnt lgkmcnt(6)
  v_mfma_f32_16x16x32_bf16 v[32:35], v[176:179], a[240:243], v[32:35]
  ds_read_b64_tr_b16 v[160:161], v8 offset:49152
  ds_read_b64_tr_b16 v[162:163], v8 offset:51200
  v_mfma_f32_16x16x32_bf16 v[36:39], v[176:179], a[244:247], v[36:39]
  s_add_u32 m0, s32, 32384
  v_mfma_f32_16x16x32_bf16 v[40:43], v[176:179], a[248:251], v[40:43]
  buffer_load_dwordx4 v3, s[12:15], s69 offen offset:384 lds
  v_mfma_f32_16x16x32_bf16 v[44:47], v[176:179], a[252:255], v[44:47]
  s_waitcnt lgkmcnt(6)
  v_mfma_f32_16x16x32_bf16 v[48:51], v[180:183], a[240:243], v[48:51]
  ds_read_b64_tr_b16 v[164:165], v9 offset:49152
  ds_read_b64_tr_b16 v[166:167], v9 offset:51200
  v_mfma_f32_16x16x32_bf16 v[52:55], v[180:183], a[244:247], v[52:55]
  s_add_u32 m0, s32, 36480
  v_mfma_f32_16x16x32_bf16 v[56:59], v[180:183], a[248:251], v[56:59]
  buffer_load_dwordx4 v3, s[16:19], s69 offen offset:384 lds
  v_mfma_f32_16x16x32_bf16 v[60:63], v[180:183], a[252:255], v[60:63]
  s_waitcnt lgkmcnt(6)
  v_mfma_f32_16x16x32_bf16 v[64:67], v[184:187], a[240:243], v[64:67]
  ds_read_b64_tr_b16 v[168:169], v8 offset:53248
  ds_read_b64_tr_b16 v[170:171], v8 offset:55296
  v_mfma_f32_16x16x32_bf16 v[68:71], v[184:187], a[244:247], v[68:71]
  v_mfma_f32_16x16x32_bf16 v[72:75], v[184:187], a[248:251], v[72:75]
  v_mfma_f32_16x16x32_bf16 v[76:79], v[184:187], a[252:255], v[76:79]
  s_waitcnt lgkmcnt(6)
  v_mfma_f32_16x16x32_bf16 v[80:83], v[188:191], a[240:243], v[80:83]
  ds_read_b64_tr_b16 v[172:173], v9 offset:53248
  ds_read_b64_tr_b16 v[174:175], v9 offset:55296
  v_mfma_f32_16x16x32_bf16 v[84:87], v[188:191], a[244:247], v[84:87]
  v_mfma_f32_16x16x32_bf16 v[88:91], v[188:191], a[248:251], v[88:91]
  v_mfma_f32_16x16x32_bf16 v[92:95], v[188:191], a[252:255], v[92:95]
  s_waitcnt lgkmcnt(6)
  v_mfma_f32_16x16x32_bf16 v[32:35], v[160:163], v[224:227], v[32:35]
  ds_read_b64_tr_b16 v[176:177], v8 offset:57344
  ds_read_b64_tr_b16 v[178:179], v8 offset:59392
  v_mfma_f32_16x16x32_bf16 v[36:39], v[160:163], v[228:231], v[36:39]
  v_mfma_f32_16x16x32_bf16 v[40:43], v[160:163], v[232:235], v[40:43]
  v_mfma_f32_16x16x32_bf16 v[44:47], v[160:163], v[236:239], v[44:47]
  s_waitcnt lgkmcnt(6)
  v_mfma_f32_16x16x32_bf16 v[48:51], v[164:167], v[224:227], v[48:51]
  ds_read_b64_tr_b16 v[180:181], v9 offset:57344
  ds_read_b64_tr_b16 v[182:183], v9 offset:59392
  v_mfma_f32_16x16x32_bf16 v[52:55], v[164:167], v[228:231], v[52:55]
  v_mfma_f32_16x16x32_bf16 v[56:59], v[164:167], v[232:235], v[56:59]
  v_mfma_f32_16x16x32_bf16 v[60:63], v[164:167], v[236:239], v[60:63]
  s_waitcnt lgkmcnt(6)
  v_mfma_f32_16x16x32_bf16 v[64:67], v[168:171], v[224:227], v[64:67]
  ds_read_b64_tr_b16 v[184:185], v8 offset:61440
  ds_read_b64_tr_b16 v[186:187], v8 offset:63488
  v_mfma_f32_16x16x32_bf16 v[68:71], v[168:171], v[228:231], v[68:71]
  v_mfma_f32_16x16x32_bf16 v[72:75], v[168:171], v[232:235], v[72:75]
  v_mfma_f32_16x16x32_bf16 v[76:79], v[168:171], v[236:239], v[76:79]
  s_waitcnt lgkmcnt(6)
  v_mfma_f32_16x16x32_bf16 v[80:83], v[172:175], v[224:227], v[80:83]
  ds_read_b64_tr_b16 v[188:189], v9 offset:61440
  ds_read_b64_tr_b16 v[190:191], v9 offset:63488
  v_mfma_f32_16x16x32_bf16 v[84:87], v[172:175], v[228:231], v[84:87]
  v_mfma_f32_16x16x32_bf16 v[88:91], v[172:175], v[232:235], v[88:91]
  v_mfma_f32_16x16x32_bf16 v[92:95], v[172:175], v[236:239], v[92:95]
  s_waitcnt lgkmcnt(6)
  v_mfma_f32_16x16x32_bf16 v[32:35], v[176:179], v[240:243], v[32:35]
  s_waitcnt vmcnt(16)
  s_barrier
  ds_read_b64_tr_b16 v[160:161], v10 offset:0
  ds_read_b64_tr_b16 v[162:163], v10 offset:2048
  v_mfma_f32_16x16x32_bf16 v[36:39], v[176:179], v[244:247], v[36:39]
  s_add_u32 s47, s70, 384
  s_add_u32 m0, s32, 0
  v_mfma_f32_16x16x32_bf16 v[40:43], v[176:179], v[248:251], v[40:43]
  buffer_load_dwordx4 v3, s[12:15], s47 offen offset:0 lds
  v_mfma_f32_16x16x32_bf16 v[44:47], v[176:179], v[252:255], v[44:47]
  s_waitcnt lgkmcnt(6)
  v_mfma_f32_16x16x32_bf16 v[48:51], v[180:183], v[240:243], v[48:51]
  ds_read_b64_tr_b16 v[164:165], v11 offset:0
  ds_read_b64_tr_b16 v[166:167], v11 offset:2048
  v_mfma_f32_16x16x32_bf16 v[52:55], v[180:183], v[244:247], v[52:55]
  s_add_u32 m0, s32, 3712
  v_mfma_f32_16x16x32_bf16 v[56:59], v[180:183], v[248:251], v[56:59]
  buffer_load_dwordx4 v3, s[16:19], s70 offen offset:384 lds
  v_mfma_f32_16x16x32_bf16 v[60:63], v[180:183], v[252:255], v[60:63]
  v_cvt_pk_bf16_f32 v128, v32, v33
  v_cvt_pk_bf16_f32 v129, v34, v35
  s_waitcnt lgkmcnt(6)
  v_mfma_f32_16x16x32_bf16 v[64:67], v[184:187], v[240:243], v[64:67]
  v_cvt_pk_bf16_f32 v132, v36, v37
  v_cvt_pk_bf16_f32 v133, v38, v39
  ds_read_b64_tr_b16 v[168:169], v10 offset:4096
  ds_read_b64_tr_b16 v[170:171], v10 offset:6144
  v_mfma_f32_16x16x32_bf16 v[68:71], v[184:187], v[244:247], v[68:71]
  v_cvt_pk_bf16_f32 v136, v40, v41
  v_cvt_pk_bf16_f32 v137, v42, v43
  s_add_u32 m0, s32, 40576
  v_mfma_f32_16x16x32_bf16 v[72:75], v[184:187], v[248:251], v[72:75]
  buffer_load_dwordx4 v3, s[12:15], s71 offen offset:384 lds
  v_cvt_pk_bf16_f32 v140, v44, v45
  v_cvt_pk_bf16_f32 v141, v46, v47
  v_mfma_f32_16x16x32_bf16 v[76:79], v[184:187], v[252:255], v[76:79]
  v_cvt_pk_bf16_f32 v130, v48, v49
  v_cvt_pk_bf16_f32 v131, v50, v51
  s_waitcnt lgkmcnt(6)
  v_mfma_f32_16x16x32_bf16 v[80:83], v[188:191], v[240:243], v[80:83]
  v_cvt_pk_bf16_f32 v134, v52, v53
  v_cvt_pk_bf16_f32 v135, v54, v55
  ds_read_b64_tr_b16 v[172:173], v11 offset:4096
  ds_read_b64_tr_b16 v[174:175], v11 offset:6144
  v_mfma_f32_16x16x32_bf16 v[84:87], v[188:191], v[244:247], v[84:87]
  v_cvt_pk_bf16_f32 v138, v56, v57
  v_cvt_pk_bf16_f32 v139, v58, v59
  s_add_u32 m0, s32, 44672
  v_mfma_f32_16x16x32_bf16 v[88:91], v[188:191], v[248:251], v[88:91]
  buffer_load_dwordx4 v3, s[16:19], s71 offen offset:384 lds
  v_cvt_pk_bf16_f32 v142, v60, v61
  v_cvt_pk_bf16_f32 v143, v62, v63
  v_mfma_f32_16x16x32_bf16 v[92:95], v[188:191], v[252:255], v[92:95]
  v_cvt_pk_bf16_f32 v144, v64, v65
  v_cvt_pk_bf16_f32 v145, v66, v67
  s_waitcnt lgkmcnt(6)
  v_mfma_f32_16x16x32_bf16 v[32:35], v[160:163], a[0:3], 0
  v_cvt_pk_bf16_f32 v148, v68, v69
  v_cvt_pk_bf16_f32 v149, v70, v71
  ds_read_b64_tr_b16 v[176:177], v10 offset:8192
  ds_read_b64_tr_b16 v[178:179], v10 offset:10240
  v_mfma_f32_16x16x32_bf16 v[36:39], v[160:163], a[4:7], 0
  v_cvt_pk_bf16_f32 v152, v72, v73
  v_cvt_pk_bf16_f32 v153, v74, v75
  v_mfma_f32_16x16x32_bf16 v[40:43], v[160:163], a[8:11], 0
  v_cvt_pk_bf16_f32 v156, v76, v77
  v_cvt_pk_bf16_f32 v157, v78, v79
  v_mfma_f32_16x16x32_bf16 v[44:47], v[160:163], a[12:15], 0
  v_cvt_pk_bf16_f32 v146, v80, v81
  v_cvt_pk_bf16_f32 v147, v82, v83
  s_waitcnt lgkmcnt(6)
  v_mfma_f32_16x16x32_bf16 v[48:51], v[164:167], a[0:3], 0
  v_cvt_pk_bf16_f32 v150, v84, v85
  v_cvt_pk_bf16_f32 v151, v86, v87
  ds_read_b64_tr_b16 v[180:181], v11 offset:8192
  ds_read_b64_tr_b16 v[182:183], v11 offset:10240
  v_mfma_f32_16x16x32_bf16 v[52:55], v[164:167], a[4:7], 0
  v_cvt_pk_bf16_f32 v154, v88, v89
  v_cvt_pk_bf16_f32 v155, v90, v91
  v_mfma_f32_16x16x32_bf16 v[56:59], v[164:167], a[8:11], 0
  v_cvt_pk_bf16_f32 v158, v92, v93
  v_cvt_pk_bf16_f32 v159, v94, v95
  v_mfma_f32_16x16x32_bf16 v[60:63], v[164:167], a[12:15], 0
  v_pk_max_i16 v128, v128, 0
  s_waitcnt lgkmcnt(6)
  v_mfma_f32_16x16x32_bf16 v[64:67], v[168:171], a[0:3], 0
  ds_read_b64_tr_b16 v[184:185], v10 offset:12288
  ds_read_b64_tr_b16 v[186:187], v10 offset:14336
  v_mfma_f32_16x16x32_bf16 v[68:71], v[168:171], a[4:7], 0
  v_lshlrev_b32 v25, 16, v144
  v_and_b32 v27, s33, v144
  v_mfma_f32_16x16x32_bf16 v[72:75], v[168:171], a[8:11], 0
  v_lshlrev_b32 v24, 16, v128
  v_and_b32 v26, s33, v128
  v_mfma_f32_16x16x32_bf16 v[76:79], v[168:171], a[12:15], 0
  v_mul_f32 v24, v24, v25
  s_waitcnt lgkmcnt(6)
  v_mfma_f32_16x16x32_bf16 v[80:83], v[172:175], a[0:3], 0
  ds_read_b64_tr_b16 v[188:189], v11 offset:12288
  ds_read_b64_tr_b16 v[190:191], v11 offset:14336
  v_mfma_f32_16x16x32_bf16 v[84:87], v[172:175], a[4:7], 0
  v_mul_f32 v26, v26, v27
  v_cvt_pk_bf16_f32 v128, v24, v26
  v_mfma_f32_16x16x32_bf16 v[88:91], v[172:175], a[8:11], 0
  v_pk_max_i16 v129, v129, 0
  v_lshlrev_b32 v29, 16, v145
  v_mfma_f32_16x16x32_bf16 v[92:95], v[172:175], a[12:15], 0
  v_and_b32 v31, s33, v145
  s_waitcnt lgkmcnt(6)
  v_mfma_f32_16x16x32_bf16 v[32:35], v[176:179], a[16:19], v[32:35]
  ds_read_b64_tr_b16 v[160:161], v10 offset:16384
  ds_read_b64_tr_b16 v[162:163], v10 offset:18432
  v_mfma_f32_16x16x32_bf16 v[36:39], v[176:179], a[20:23], v[36:39]
  v_lshlrev_b32 v28, 16, v129
  v_and_b32 v30, s33, v129
  v_mfma_f32_16x16x32_bf16 v[40:43], v[176:179], a[24:27], v[40:43]
  v_mul_f32 v28, v28, v29
  v_mul_f32 v30, v30, v31
  v_mfma_f32_16x16x32_bf16 v[44:47], v[176:179], a[28:31], v[44:47]
  v_cvt_pk_bf16_f32 v129, v28, v30
  s_waitcnt lgkmcnt(6)
  v_mfma_f32_16x16x32_bf16 v[48:51], v[180:183], a[16:19], v[48:51]
  ds_read_b64_tr_b16 v[164:165], v11 offset:16384
  ds_read_b64_tr_b16 v[166:167], v11 offset:18432
  v_mfma_f32_16x16x32_bf16 v[52:55], v[180:183], a[20:23], v[52:55]
  v_pk_max_i16 v130, v130, 0
  v_lshlrev_b32 v25, 16, v146
  v_mfma_f32_16x16x32_bf16 v[56:59], v[180:183], a[24:27], v[56:59]
  v_and_b32 v27, s33, v146
  v_lshlrev_b32 v24, 16, v130
  v_mfma_f32_16x16x32_bf16 v[60:63], v[180:183], a[28:31], v[60:63]
  v_and_b32 v26, s33, v130
  s_waitcnt lgkmcnt(6)
  v_mfma_f32_16x16x32_bf16 v[64:67], v[184:187], a[16:19], v[64:67]
  ds_read_b64_tr_b16 v[168:169], v10 offset:20480
  ds_read_b64_tr_b16 v[170:171], v10 offset:22528
  v_mfma_f32_16x16x32_bf16 v[68:71], v[184:187], a[20:23], v[68:71]
  v_mul_f32 v24, v24, v25
  v_mul_f32 v26, v26, v27
  v_mfma_f32_16x16x32_bf16 v[72:75], v[184:187], a[24:27], v[72:75]
  v_cvt_pk_bf16_f32 v130, v24, v26
  v_pk_max_i16 v131, v131, 0
  v_mfma_f32_16x16x32_bf16 v[76:79], v[184:187], a[28:31], v[76:79]
  v_lshlrev_b32 v29, 16, v147
  s_waitcnt lgkmcnt(6)
  v_mfma_f32_16x16x32_bf16 v[80:83], v[188:191], a[16:19], v[80:83]
  ds_read_b64_tr_b16 v[172:173], v11 offset:20480
  ds_read_b64_tr_b16 v[174:175], v11 offset:22528
  v_mfma_f32_16x16x32_bf16 v[84:87], v[188:191], a[20:23], v[84:87]
  v_and_b32 v31, s33, v147
  v_lshlrev_b32 v28, 16, v131
  v_mfma_f32_16x16x32_bf16 v[88:91], v[188:191], a[24:27], v[88:91]
  v_and_b32 v30, s33, v131
  v_mul_f32 v28, v28, v29
  v_mfma_f32_16x16x32_bf16 v[92:95], v[188:191], a[28:31], v[92:95]
  v_mul_f32 v30, v30, v31
  s_waitcnt lgkmcnt(6)
  v_mfma_f32_16x16x32_bf16 v[32:35], v[160:163], a[32:35], v[32:35]
  s_waitcnt vmcnt(12)
  s_barrier
  ds_read_b64_tr_b16 v[176:177], v8 offset:8192
  ds_read_b64_tr_b16 v[178:179], v8 offset:10240
  v_mfma_f32_16x16x32_bf16 v[36:39], v[160:163], a[36:39], v[36:39]
  s_add_u32 m0, s32, 48768
  v_cvt_pk_bf16_f32 v131, v28, v30
  v_mfma_f32_16x16x32_bf16 v[40:43], v[160:163], a[40:43], v[40:43]
  buffer_load_dwordx4 v3, s[12:15], s72 offen offset:384 lds
  ds_write_b128 v20, v[128:131] offset:57344
  v_mfma_f32_16x16x32_bf16 v[44:47], v[160:163], a[44:47], v[44:47]
  buffer_store_dwordx4 v[128:131], v5, s[8:11], s57 offen offset:0 sc1
  s_waitcnt lgkmcnt(7)
  v_mfma_f32_16x16x32_bf16 v[48:51], v[164:167], a[32:35], v[48:51]
  ds_read_b64_tr_b16 v[180:181], v9 offset:8192
  ds_read_b64_tr_b16 v[182:183], v9 offset:10240
  v_mfma_f32_16x16x32_bf16 v[52:55], v[164:167], a[36:39], v[52:55]
  s_add_u32 m0, s32, 52864
  v_pk_max_i16 v132, v132, 0
  v_mfma_f32_16x16x32_bf16 v[56:59], v[164:167], a[40:43], v[56:59]
  buffer_load_dwordx4 v3, s[16:19], s72 offen offset:384 lds
  v_lshlrev_b32 v25, 16, v148
  v_mfma_f32_16x16x32_bf16 v[60:63], v[164:167], a[44:47], v[60:63]
  v_and_b32 v27, s33, v148
  s_waitcnt lgkmcnt(7)
  v_mfma_f32_16x16x32_bf16 v[64:67], v[168:171], a[32:35], v[64:67]
  ds_read_b64_tr_b16 v[184:185], v8 offset:12288
  ds_read_b64_tr_b16 v[186:187], v8 offset:14336
  v_mfma_f32_16x16x32_bf16 v[68:71], v[168:171], a[36:39], v[68:71]
  s_add_u32 m0, s32, 56960
  v_lshlrev_b32 v24, 16, v132
  v_mfma_f32_16x16x32_bf16 v[72:75], v[168:171], a[40:43], v[72:75]
  buffer_load_dwordx4 v3, s[12:15], s73 offen offset:384 lds
  v_and_b32 v26, s33, v132
  v_mfma_f32_16x16x32_bf16 v[76:79], v[168:171], a[44:47], v[76:79]
  v_mul_f32 v24, v24, v25
  s_waitcnt lgkmcnt(7)
  v_mfma_f32_16x16x32_bf16 v[80:83], v[172:175], a[32:35], v[80:83]
  ds_read_b64_tr_b16 v[188:189], v9 offset:12288
  ds_read_b64_tr_b16 v[190:191], v9 offset:14336
  v_mfma_f32_16x16x32_bf16 v[84:87], v[172:175], a[36:39], v[84:87]
  s_add_u32 m0, s32, 61056
  v_mul_f32 v26, v26, v27
  v_mfma_f32_16x16x32_bf16 v[88:91], v[172:175], a[40:43], v[88:91]
  buffer_load_dwordx4 v3, s[16:19], s73 offen offset:384 lds
  v_cvt_pk_bf16_f32 v132, v24, v26
  v_mfma_f32_16x16x32_bf16 v[92:95], v[172:175], a[44:47], v[92:95]
  v_pk_max_i16 v133, v133, 0
  s_waitcnt lgkmcnt(7)
  v_mfma_f32_16x16x32_bf16 v[32:35], v[176:179], a[48:51], v[32:35]
  ds_read_b64_tr_b16 v[160:161], v8 offset:16384
  ds_read_b64_tr_b16 v[162:163], v8 offset:18432
  v_mfma_f32_16x16x32_bf16 v[36:39], v[176:179], a[52:55], v[36:39]
  s_add_u32 m0, s32, 65152
  v_lshlrev_b32 v29, 16, v149
  v_mfma_f32_16x16x32_bf16 v[40:43], v[176:179], a[56:59], v[40:43]
  buffer_load_dwordx4 v3, s[12:15], s74 offen offset:384 lds
  v_and_b32 v31, s33, v149
  v_mfma_f32_16x16x32_bf16 v[44:47], v[176:179], a[60:63], v[44:47]
  v_lshlrev_b32 v28, 16, v133
  s_waitcnt lgkmcnt(6)
  v_mfma_f32_16x16x32_bf16 v[48:51], v[180:183], a[48:51], v[48:51]
  ds_read_b64_tr_b16 v[164:165], v9 offset:16384
  ds_read_b64_tr_b16 v[166:167], v9 offset:18432
  v_mfma_f32_16x16x32_bf16 v[52:55], v[180:183], a[52:55], v[52:55]
  s_add_u32 m0, s32, 69248
  v_and_b32 v30, s33, v133
  v_mfma_f32_16x16x32_bf16 v[56:59], v[180:183], a[56:59], v[56:59]
  buffer_load_dwordx4 v3, s[16:19], s74 offen offset:384 lds
  v_mul_f32 v28, v28, v29
  v_mfma_f32_16x16x32_bf16 v[60:63], v[180:183], a[60:63], v[60:63]
  v_mul_f32 v30, v30, v31
  s_waitcnt lgkmcnt(6)
  v_mfma_f32_16x16x32_bf16 v[64:67], v[184:187], a[48:51], v[64:67]
  ds_read_b64_tr_b16 v[168:169], v8 offset:20480
  ds_read_b64_tr_b16 v[170:171], v8 offset:22528
  v_mfma_f32_16x16x32_bf16 v[68:71], v[184:187], a[52:55], v[68:71]
  v_cvt_pk_bf16_f32 v133, v28, v30
  v_pk_max_i16 v134, v134, 0
  v_mfma_f32_16x16x32_bf16 v[72:75], v[184:187], a[56:59], v[72:75]
  v_lshlrev_b32 v25, 16, v150
  v_and_b32 v27, s33, v150
  v_mfma_f32_16x16x32_bf16 v[76:79], v[184:187], a[60:63], v[76:79]
  v_lshlrev_b32 v24, 16, v134
  s_waitcnt lgkmcnt(6)
  v_mfma_f32_16x16x32_bf16 v[80:83], v[188:191], a[48:51], v[80:83]
  ds_read_b64_tr_b16 v[172:173], v9 offset:20480
  ds_read_b64_tr_b16 v[174:175], v9 offset:22528
  v_mfma_f32_16x16x32_bf16 v[84:87], v[188:191], a[52:55], v[84:87]
  v_and_b32 v26, s33, v134
  v_mul_f32 v24, v24, v25
  v_mfma_f32_16x16x32_bf16 v[88:91], v[188:191], a[56:59], v[88:91]
  v_mul_f32 v26, v26, v27
  v_cvt_pk_bf16_f32 v134, v24, v26
  v_mfma_f32_16x16x32_bf16 v[92:95], v[188:191], a[60:63], v[92:95]
  v_pk_max_i16 v135, v135, 0
  s_waitcnt lgkmcnt(6)
  v_mfma_f32_16x16x32_bf16 v[32:35], v[160:163], a[64:67], v[32:35]
  ds_read_b64_tr_b16 v[176:177], v12 offset:8192
  ds_read_b64_tr_b16 v[178:179], v12 offset:10240
  v_mfma_f32_16x16x32_bf16 v[36:39], v[160:163], a[68:71], v[36:39]
  v_lshlrev_b32 v29, 16, v151
  v_and_b32 v31, s33, v151
  v_mfma_f32_16x16x32_bf16 v[40:43], v[160:163], a[72:75], v[40:43]
  v_lshlrev_b32 v28, 16, v135
  v_and_b32 v30, s33, v135
  v_mfma_f32_16x16x32_bf16 v[44:47], v[160:163], a[76:79], v[44:47]
  v_mul_f32 v28, v28, v29
  s_waitcnt lgkmcnt(6)
  v_mfma_f32_16x16x32_bf16 v[48:51], v[164:167], a[64:67], v[48:51]
  ds_read_b64_tr_b16 v[180:181], v13 offset:8192
  ds_read_b64_tr_b16 v[182:183], v13 offset:10240
  v_mfma_f32_16x16x32_bf16 v[52:55], v[164:167], a[68:71], v[52:55]
  v_mul_f32 v30, v30, v31
  v_cvt_pk_bf16_f32 v135, v28, v30
  v_mfma_f32_16x16x32_bf16 v[56:59], v[164:167], a[72:75], v[56:59]
  ds_write_b128 v20, v[132:135] offset:58368
  buffer_store_dwordx4 v[132:135], v5, s[8:11], s57 offen offset:1024 sc1
  v_mfma_f32_16x16x32_bf16 v[60:63], v[164:167], a[76:79], v[60:63]
  v_pk_max_i16 v136, v136, 0
  s_waitcnt lgkmcnt(7)
  v_mfma_f32_16x16x32_bf16 v[64:67], v[168:171], a[64:67], v[64:67]
  ds_read_b64_tr_b16 v[184:185], v12 offset:12288
  ds_read_b64_tr_b16 v[186:187], v12 offset:14336
  v_mfma_f32_16x16x32_bf16 v[68:71], v[168:171], a[68:71], v[68:71]
  v_lshlrev_b32 v25, 16, v152
  v_and_b32 v27, s33, v152
  v_mfma_f32_16x16x32_bf16 v[72:75], v[168:171], a[72:75], v[72:75]
  v_lshlrev_b32 v24, 16, v136
  v_and_b32 v26, s33, v136
  v_mfma_f32_16x16x32_bf16 v[76:79], v[168:171], a[76:79], v[76:79]
  v_mul_f32 v24, v24, v25
  s_waitcnt lgkmcnt(7)
  v_mfma_f32_16x16x32_bf16 v[80:83], v[172:175], a[64:67], v[80:83]
  ds_read_b64_tr_b16 v[188:189], v13 offset:12288
  ds_read_b64_tr_b16 v[190:191], v13 offset:14336
  v_mfma_f32_16x16x32_bf16 v[84:87], v[172:175], a[68:71], v[84:87]
  v_mul_f32 v26, v26, v27
  v_cvt_pk_bf16_f32 v136, v24, v26
  v_mfma_f32_16x16x32_bf16 v[88:91], v[172:175], a[72:75], v[88:91]
  v_pk_max_i16 v137, v137, 0
  v_lshlrev_b32 v29, 16, v153
  v_mfma_f32_16x16x32_bf16 v[92:95], v[172:175], a[76:79], v[92:95]
  v_and_b32 v31, s33, v153
  s_waitcnt lgkmcnt(7)
  v_mfma_f32_16x16x32_bf16 v[32:35], v[176:179], a[80:83], v[32:35]
  s_waitcnt vmcnt(14)
  s_waitcnt lgkmcnt(4)
  s_barrier
  ds_read_b64_tr_b16 v[160:161], v8 offset:24576
  ds_read_b64_tr_b16 v[162:163], v8 offset:26624
  v_mfma_f32_16x16x32_bf16 v[36:39], v[176:179], a[84:87], v[36:39]
  s_add_u32 m0, s32, 73344
  v_lshlrev_b32 v28, 16, v137
  v_mfma_f32_16x16x32_bf16 v[40:43], v[176:179], a[88:91], v[40:43]
  buffer_load_dwordx4 v3, s[12:15], s75 offen offset:384 lds
  v_and_b32 v30, s33, v137
  v_mfma_f32_16x16x32_bf16 v[44:47], v[176:179], a[92:95], v[44:47]
  v_mul_f32 v28, v28, v29
  v_mfma_f32_16x16x32_bf16 v[48:51], v[180:183], a[80:83], v[48:51]
  ds_read_b64_tr_b16 v[164:165], v9 offset:24576
  ds_read_b64_tr_b16 v[166:167], v9 offset:26624
  v_mfma_f32_16x16x32_bf16 v[52:55], v[180:183], a[84:87], v[52:55]
  s_add_u32 m0, s32, 77440
  v_mul_f32 v30, v30, v31
  v_mfma_f32_16x16x32_bf16 v[56:59], v[180:183], a[88:91], v[56:59]
  buffer_load_dwordx4 v3, s[16:19], s75 offen offset:384 lds
  v_cvt_pk_bf16_f32 v137, v28, v30
  v_mfma_f32_16x16x32_bf16 v[60:63], v[180:183], a[92:95], v[60:63]
  v_pk_max_i16 v138, v138, 0
  s_waitcnt lgkmcnt(6)
  v_mfma_f32_16x16x32_bf16 v[64:67], v[184:187], a[80:83], v[64:67]
  ds_read_b64_tr_b16 v[168:169], v8 offset:28672
  ds_read_b64_tr_b16 v[170:171], v8 offset:30720
  v_mfma_f32_16x16x32_bf16 v[68:71], v[184:187], a[84:87], v[68:71]
  s_add_u32 m0, s32, 7808
  v_lshlrev_b32 v25, 16, v154
  v_mfma_f32_16x16x32_bf16 v[72:75], v[184:187], a[88:91], v[72:75]
  buffer_load_dwordx4 v3, s[12:15], s76 offen offset:384 lds
  v_and_b32 v27, s33, v154
  v_mfma_f32_16x16x32_bf16 v[76:79], v[184:187], a[92:95], v[76:79]
  v_lshlrev_b32 v24, 16, v138
  s_waitcnt lgkmcnt(6)
  v_mfma_f32_16x16x32_bf16 v[80:83], v[188:191], a[80:83], v[80:83]
  ds_read_b64_tr_b16 v[172:173], v9 offset:28672
  ds_read_b64_tr_b16 v[174:175], v9 offset:30720
  v_mfma_f32_16x16x32_bf16 v[84:87], v[188:191], a[84:87], v[84:87]
  s_add_u32 m0, s32, 11904
  v_and_b32 v26, s33, v138
  v_mfma_f32_16x16x32_bf16 v[88:91], v[188:191], a[88:91], v[88:91]
  buffer_load_dwordx4 v3, s[16:19], s76 offen offset:384 lds
  v_mul_f32 v24, v24, v25
  v_mfma_f32_16x16x32_bf16 v[92:95], v[188:191], a[92:95], v[92:95]
  v_mul_f32 v26, v26, v27
  s_waitcnt lgkmcnt(6)
  v_mfma_f32_16x16x32_bf16 v[32:35], v[160:163], a[96:99], v[32:35]
  ds_read_b64_tr_b16 v[176:177], v12 offset:16384
  ds_read_b64_tr_b16 v[178:179], v12 offset:18432
  v_mfma_f32_16x16x32_bf16 v[36:39], v[160:163], a[100:103], v[36:39]
  s_add_u32 m0, s32, 16000
  v_cvt_pk_bf16_f32 v138, v24, v26
  v_mfma_f32_16x16x32_bf16 v[40:43], v[160:163], a[104:107], v[40:43]
  buffer_load_dwordx4 v3, s[12:15], s77 offen offset:384 lds
  v_pk_max_i16 v139, v139, 0
  v_mfma_f32_16x16x32_bf16 v[44:47], v[160:163], a[108:111], v[44:47]
  v_lshlrev_b32 v29, 16, v155
  s_waitcnt lgkmcnt(6)
  v_mfma_f32_16x16x32_bf16 v[48:51], v[164:167], a[96:99], v[48:51]
  ds_read_b64_tr_b16 v[180:181], v13 offset:16384
  ds_read_b64_tr_b16 v[182:183], v13 offset:18432
  v_mfma_f32_16x16x32_bf16 v[52:55], v[164:167], a[100:103], v[52:55]
  s_add_u32 m0, s32, 20096
  v_and_b32 v31, s33, v155
  v_mfma_f32_16x16x32_bf16 v[56:59], v[164:167], a[104:107], v[56:59]
  buffer_load_dwordx4 v3, s[16:19], s77 offen offset:384 lds
  v_lshlrev_b32 v28, 16, v139
  v_mfma_f32_16x16x32_bf16 v[60:63], v[164:167], a[108:111], v[60:63]
  v_and_b32 v30, s33, v139
  s_waitcnt lgkmcnt(6)
  v_mfma_f32_16x16x32_bf16 v[64:67], v[168:171], a[96:99], v[64:67]
  ds_read_b64_tr_b16 v[184:185], v12 offset:20480
  ds_read_b64_tr_b16 v[186:187], v12 offset:22528
  v_mfma_f32_16x16x32_bf16 v[68:71], v[168:171], a[100:103], v[68:71]
  v_mul_f32 v28, v28, v29
  v_mul_f32 v30, v30, v31
  v_mfma_f32_16x16x32_bf16 v[72:75], v[168:171], a[104:107], v[72:75]
  v_cvt_pk_bf16_f32 v139, v28, v30
  ds_write_b128 v20, v[136:139] offset:59392
  v_mfma_f32_16x16x32_bf16 v[76:79], v[168:171], a[108:111], v[76:79]
  buffer_store_dwordx4 v[136:139], v5, s[8:11], s57 offen offset:2048 sc1
  s_waitcnt lgkmcnt(7)
  v_mfma_f32_16x16x32_bf16 v[80:83], v[172:175], a[96:99], v[80:83]
  ds_read_b64_tr_b16 v[188:189], v13 offset:20480
  ds_read_b64_tr_b16 v[190:191], v13 offset:22528
  v_mfma_f32_16x16x32_bf16 v[84:87], v[172:175], a[100:103], v[84:87]
  v_pk_max_i16 v140, v140, 0
  v_lshlrev_b32 v25, 16, v156
  v_mfma_f32_16x16x32_bf16 v[88:91], v[172:175], a[104:107], v[88:91]
  v_and_b32 v27, s33, v156
  v_lshlrev_b32 v24, 16, v140
  v_mfma_f32_16x16x32_bf16 v[92:95], v[172:175], a[108:111], v[92:95]
  v_and_b32 v26, s33, v140
  s_waitcnt lgkmcnt(7)
  v_mfma_f32_16x16x32_bf16 v[32:35], v[176:179], a[112:115], v[32:35]
  ds_read_b64_tr_b16 v[160:161], v12 offset:24576
  ds_read_b64_tr_b16 v[162:163], v12 offset:26624
  v_mfma_f32_16x16x32_bf16 v[36:39], v[176:179], a[116:119], v[36:39]
  v_mul_f32 v24, v24, v25
  v_mul_f32 v26, v26, v27
  v_mfma_f32_16x16x32_bf16 v[40:43], v[176:179], a[120:123], v[40:43]
  v_cvt_pk_bf16_f32 v140, v24, v26
  v_pk_max_i16 v141, v141, 0
  v_mfma_f32_16x16x32_bf16 v[44:47], v[176:179], a[124:127], v[44:47]
  v_lshlrev_b32 v29, 16, v157
  s_waitcnt lgkmcnt(7)
  v_mfma_f32_16x16x32_bf16 v[48:51], v[180:183], a[112:115], v[48:51]
  ds_read_b64_tr_b16 v[164:165], v13 offset:24576
  ds_read_b64_tr_b16 v[166:167], v13 offset:26624
  v_mfma_f32_16x16x32_bf16 v[52:55], v[180:183], a[116:119], v[52:55]
  v_and_b32 v31, s33, v157
  v_lshlrev_b32 v28, 16, v141
  v_mfma_f32_16x16x32_bf16 v[56:59], v[180:183], a[120:123], v[56:59]
  v_and_b32 v30, s33, v141
  v_mul_f32 v28, v28, v29
  v_mfma_f32_16x16x32_bf16 v[60:63], v[180:183], a[124:127], v[60:63]
  v_mul_f32 v30, v30, v31
  s_waitcnt lgkmcnt(7)
  v_mfma_f32_16x16x32_bf16 v[64:67], v[184:187], a[112:115], v[64:67]
  ds_read_b64_tr_b16 v[168:169], v12 offset:28672
  ds_read_b64_tr_b16 v[170:171], v12 offset:30720
  v_mfma_f32_16x16x32_bf16 v[68:71], v[184:187], a[116:119], v[68:71]
  v_cvt_pk_bf16_f32 v141, v28, v30
  v_pk_max_i16 v142, v142, 0
  v_mfma_f32_16x16x32_bf16 v[72:75], v[184:187], a[120:123], v[72:75]
  v_lshlrev_b32 v25, 16, v158
  v_and_b32 v27, s33, v158
  v_mfma_f32_16x16x32_bf16 v[76:79], v[184:187], a[124:127], v[76:79]
  v_lshlrev_b32 v24, 16, v142
  s_waitcnt lgkmcnt(6)
  v_mfma_f32_16x16x32_bf16 v[80:83], v[188:191], a[112:115], v[80:83]
  ds_read_b64_tr_b16 v[172:173], v13 offset:28672
  ds_read_b64_tr_b16 v[174:175], v13 offset:30720
  v_mfma_f32_16x16x32_bf16 v[84:87], v[188:191], a[116:119], v[84:87]
  v_and_b32 v26, s33, v142
  v_mul_f32 v24, v24, v25
  v_mfma_f32_16x16x32_bf16 v[88:91], v[188:191], a[120:123], v[88:91]
  v_mul_f32 v26, v26, v27
  v_cvt_pk_bf16_f32 v142, v24, v26
  v_mfma_f32_16x16x32_bf16 v[92:95], v[188:191], a[124:127], v[92:95]
  v_pk_max_i16 v143, v143, 0
  s_waitcnt lgkmcnt(6)
  v_mfma_f32_16x16x32_bf16 v[32:35], v[160:163], a[128:131], v[32:35]
  s_waitcnt vmcnt(15)
  s_barrier
  ds_read_b64_tr_b16 v[176:177], v8 offset:32768
  ds_read_b64_tr_b16 v[178:179], v8 offset:34816
  v_mfma_f32_16x16x32_bf16 v[36:39], v[160:163], a[132:135], v[36:39]
  s_add_u32 m0, s32, 81920
  v_lshlrev_b32 v29, 16, v159
  v_mfma_f32_16x16x32_bf16 v[40:43], v[160:163], a[136:139], v[40:43]
  buffer_load_dwordx4 v6, s[52:55], s60 offen offset:0 lds
  v_and_b32 v31, s33, v159
  v_mfma_f32_16x16x32_bf16 v[44:47], v[160:163], a[140:143], v[44:47]
  v_lshlrev_b32 v28, 16, v143
  s_waitcnt lgkmcnt(6)
  v_mfma_f32_16x16x32_bf16 v[48:51], v[164:167], a[128:131], v[48:51]
  ds_read_b64_tr_b16 v[180:181], v9 offset:32768
  ds_read_b64_tr_b16 v[182:183], v9 offset:34816
  v_mfma_f32_16x16x32_bf16 v[52:55], v[164:167], a[132:135], v[52:55]
  s_add_u32 m0, s32, 86016
  v_and_b32 v30, s33, v143
  v_mfma_f32_16x16x32_bf16 v[56:59], v[164:167], a[136:139], v[56:59]
  buffer_load_dwordx4 v6, s[52:55], s61 offen offset:0 lds
  v_mul_f32 v28, v28, v29
  v_mfma_f32_16x16x32_bf16 v[60:63], v[164:167], a[140:143], v[60:63]
  v_mul_f32 v30, v30, v31
  s_waitcnt lgkmcnt(6)
  v_mfma_f32_16x16x32_bf16 v[64:67], v[168:171], a[128:131], v[64:67]
  ds_read_b64_tr_b16 v[184:185], v8 offset:36864
  ds_read_b64_tr_b16 v[186:187], v8 offset:38912
  v_mfma_f32_16x16x32_bf16 v[68:71], v[168:171], a[132:135], v[68:71]
  s_add_u32 m0, s32, 24576
  v_cvt_pk_bf16_f32 v143, v28, v30
  v_mfma_f32_16x16x32_bf16 v[72:75], v[168:171], a[136:139], v[72:75]
  buffer_load_dwordx4 v6, s[52:55], s62 offen offset:0 lds
  ds_write_b128 v20, v[140:143] offset:60416
  v_mfma_f32_16x16x32_bf16 v[76:79], v[168:171], a[140:143], v[76:79]
  buffer_store_dwordx4 v[140:143], v5, s[8:11], s57 offen offset:3072 sc1
  s_waitcnt lgkmcnt(7)
  v_mfma_f32_16x16x32_bf16 v[80:83], v[172:175], a[128:131], v[80:83]
  ds_read_b64_tr_b16 v[188:189], v9 offset:36864
  ds_read_b64_tr_b16 v[190:191], v9 offset:38912
  v_mfma_f32_16x16x32_bf16 v[84:87], v[172:175], a[132:135], v[84:87]
  s_add_u32 m0, s32, 28672
  s_add_u32 s57, s57, 16384
  v_mfma_f32_16x16x32_bf16 v[88:91], v[172:175], a[136:139], v[88:91]
  buffer_load_dwordx4 v6, s[52:55], s63 offen offset:0 lds
  v_mfma_f32_16x16x32_bf16 v[92:95], v[172:175], a[140:143], v[92:95]
  s_waitcnt lgkmcnt(7)
  v_mfma_f32_16x16x32_bf16 v[32:35], v[176:179], a[144:147], v[32:35]
  ds_read_b64_tr_b16 v[160:161], v8 offset:0
  ds_read_b64_tr_b16 v[162:163], v8 offset:2048
  v_mfma_f32_16x16x32_bf16 v[36:39], v[176:179], a[148:151], v[36:39]
  v_mfma_f32_16x16x32_bf16 v[40:43], v[176:179], a[152:155], v[40:43]
  v_mfma_f32_16x16x32_bf16 v[44:47], v[176:179], a[156:159], v[44:47]
  s_waitcnt lgkmcnt(7)
  v_mfma_f32_16x16x32_bf16 v[48:51], v[180:183], a[144:147], v[48:51]
  ds_read_b64_tr_b16 v[164:165], v9 offset:0
  ds_read_b64_tr_b16 v[166:167], v9 offset:2048
  v_mfma_f32_16x16x32_bf16 v[52:55], v[180:183], a[148:151], v[52:55]
  v_mfma_f32_16x16x32_bf16 v[56:59], v[180:183], a[152:155], v[56:59]
  v_mfma_f32_16x16x32_bf16 v[60:63], v[180:183], a[156:159], v[60:63]
  s_waitcnt lgkmcnt(7)
  v_mfma_f32_16x16x32_bf16 v[64:67], v[184:187], a[144:147], v[64:67]
  ds_read_b64_tr_b16 v[168:169], v8 offset:4096
  ds_read_b64_tr_b16 v[170:171], v8 offset:6144
  v_mfma_f32_16x16x32_bf16 v[68:71], v[184:187], a[148:151], v[68:71]
  v_mfma_f32_16x16x32_bf16 v[72:75], v[184:187], a[152:155], v[72:75]
  v_mfma_f32_16x16x32_bf16 v[76:79], v[184:187], a[156:159], v[76:79]
  s_waitcnt lgkmcnt(6)
  v_mfma_f32_16x16x32_bf16 v[80:83], v[188:191], a[144:147], v[80:83]
  ds_read_b64_tr_b16 v[172:173], v9 offset:4096
  ds_read_b64_tr_b16 v[174:175], v9 offset:6144
  v_mfma_f32_16x16x32_bf16 v[84:87], v[188:191], a[148:151], v[84:87]
  v_mfma_f32_16x16x32_bf16 v[88:91], v[188:191], a[152:155], v[88:91]
  v_mfma_f32_16x16x32_bf16 v[92:95], v[188:191], a[156:159], v[92:95]
  s_waitcnt lgkmcnt(6)
  v_mfma_f32_16x16x32_bf16 v[32:35], v[160:163], a[160:163], v[32:35]
  ds_read_b64_tr_b16 v[176:177], v8 offset:40960
  ds_read_b64_tr_b16 v[178:179], v8 offset:43008
  v_mfma_f32_16x16x32_bf16 v[36:39], v[160:163], a[164:167], v[36:39]
  v_mfma_f32_16x16x32_bf16 v[40:43], v[160:163], a[168:171], v[40:43]
  v_mfma_f32_16x16x32_bf16 v[44:47], v[160:163], a[172:175], v[44:47]
  s_waitcnt lgkmcnt(6)
  v_mfma_f32_16x16x32_bf16 v[48:51], v[164:167], a[160:163], v[48:51]
  ds_read_b64_tr_b16 v[180:181], v9 offset:40960
  ds_read_b64_tr_b16 v[182:183], v9 offset:43008
  v_mfma_f32_16x16x32_bf16 v[52:55], v[164:167], a[164:167], v[52:55]
  v_mfma_f32_16x16x32_bf16 v[56:59], v[164:167], a[168:171], v[56:59]
  v_mfma_f32_16x16x32_bf16 v[60:63], v[164:167], a[172:175], v[60:63]
  s_waitcnt lgkmcnt(6)
  v_mfma_f32_16x16x32_bf16 v[64:67], v[168:171], a[160:163], v[64:67]
  ds_read_b64_tr_b16 v[184:185], v8 offset:45056
  ds_read_b64_tr_b16 v[186:187], v8 offset:47104
  v_mfma_f32_16x16x32_bf16 v[68:71], v[168:171], a[164:167], v[68:71]
  v_mfma_f32_16x16x32_bf16 v[72:75], v[168:171], a[168:171], v[72:75]
  v_mfma_f32_16x16x32_bf16 v[76:79], v[168:171], a[172:175], v[76:79]
  s_waitcnt lgkmcnt(6)
  v_mfma_f32_16x16x32_bf16 v[80:83], v[172:175], a[160:163], v[80:83]
  ds_read_b64_tr_b16 v[188:189], v9 offset:45056
  ds_read_b64_tr_b16 v[190:191], v9 offset:47104
  v_mfma_f32_16x16x32_bf16 v[84:87], v[172:175], a[164:167], v[84:87]
  v_mfma_f32_16x16x32_bf16 v[88:91], v[172:175], a[168:171], v[88:91]
  v_mfma_f32_16x16x32_bf16 v[92:95], v[172:175], a[172:175], v[92:95]
  s_waitcnt lgkmcnt(6)
  v_mfma_f32_16x16x32_bf16 v[32:35], v[176:179], a[176:179], v[32:35]
  s_waitcnt vmcnt(13)
  s_barrier
  ds_read_b64_tr_b16 v[160:161], v8 offset:49152
  ds_read_b64_tr_b16 v[162:163], v8 offset:51200
  v_mfma_f32_16x16x32_bf16 v[36:39], v[176:179], a[180:183], v[36:39]
  s_add_u32 m0, s32, 155648
  v_mfma_f32_16x16x32_bf16 v[40:43], v[176:179], a[184:187], v[40:43]
  buffer_load_dwordx4 v6, s[52:55], s64 offen offset:0 lds
  v_mfma_f32_16x16x32_bf16 v[44:47], v[176:179], a[188:191], v[44:47]
  s_waitcnt lgkmcnt(6)
  v_mfma_f32_16x16x32_bf16 v[48:51], v[180:183], a[176:179], v[48:51]
  ds_read_b64_tr_b16 v[164:165], v9 offset:49152
  ds_read_b64_tr_b16 v[166:167], v9 offset:51200
  v_mfma_f32_16x16x32_bf16 v[52:55], v[180:183], a[180:183], v[52:55]
  s_add_u32 m0, s32, 159744
  v_mfma_f32_16x16x32_bf16 v[56:59], v[180:183], a[184:187], v[56:59]
  buffer_load_dwordx4 v6, s[52:55], s65 offen offset:0 lds
  v_mfma_f32_16x16x32_bf16 v[60:63], v[180:183], a[188:191], v[60:63]
  s_waitcnt lgkmcnt(6)
  v_mfma_f32_16x16x32_bf16 v[64:67], v[184:187], a[176:179], v[64:67]
  ds_read_b64_tr_b16 v[168:169], v8 offset:53248
  ds_read_b64_tr_b16 v[170:171], v8 offset:55296
  v_mfma_f32_16x16x32_bf16 v[68:71], v[184:187], a[180:183], v[68:71]
  s_add_u32 m0, s32, 0
  v_mfma_f32_16x16x32_bf16 v[72:75], v[184:187], a[184:187], v[72:75]
  buffer_load_dwordx4 v6, s[52:55], s66 offen offset:0 lds
  v_mfma_f32_16x16x32_bf16 v[76:79], v[184:187], a[188:191], v[76:79]
  s_waitcnt lgkmcnt(6)
  v_mfma_f32_16x16x32_bf16 v[80:83], v[188:191], a[176:179], v[80:83]
  ds_read_b64_tr_b16 v[172:173], v9 offset:53248
  ds_read_b64_tr_b16 v[174:175], v9 offset:55296
  v_mfma_f32_16x16x32_bf16 v[84:87], v[188:191], a[180:183], v[84:87]
  s_add_u32 m0, s32, 4096
  v_mfma_f32_16x16x32_bf16 v[88:91], v[188:191], a[184:187], v[88:91]
  buffer_load_dwordx4 v6, s[52:55], s67 offen offset:0 lds
  v_mfma_f32_16x16x32_bf16 v[92:95], v[188:191], a[188:191], v[92:95]
  s_waitcnt lgkmcnt(6)
  v_mfma_f32_16x16x32_bf16 v[32:35], v[160:163], a[192:195], v[32:35]
  ds_read_b64_tr_b16 v[176:177], v8 offset:57344
  ds_read_b64_tr_b16 v[178:179], v8 offset:59392
  v_mfma_f32_16x16x32_bf16 v[36:39], v[160:163], a[196:199], v[36:39]
  s_add_u32 m0, s32, 32768
  v_mfma_f32_16x16x32_bf16 v[40:43], v[160:163], a[200:203], v[40:43]
  buffer_load_dwordx4 v6, s[52:55], s68 offen offset:0 lds
  v_mfma_f32_16x16x32_bf16 v[44:47], v[160:163], a[204:207], v[44:47]
  s_waitcnt lgkmcnt(6)
  v_mfma_f32_16x16x32_bf16 v[48:51], v[164:167], a[192:195], v[48:51]
  ds_read_b64_tr_b16 v[180:181], v9 offset:57344
  ds_read_b64_tr_b16 v[182:183], v9 offset:59392
  v_mfma_f32_16x16x32_bf16 v[52:55], v[164:167], a[196:199], v[52:55]
  s_add_u32 m0, s32, 36864
  v_mfma_f32_16x16x32_bf16 v[56:59], v[164:167], a[200:203], v[56:59]
  buffer_load_dwordx4 v6, s[52:55], s69 offen offset:0 lds
  v_mfma_f32_16x16x32_bf16 v[60:63], v[164:167], a[204:207], v[60:63]
  s_waitcnt lgkmcnt(6)
  v_mfma_f32_16x16x32_bf16 v[64:67], v[168:171], a[192:195], v[64:67]
  ds_read_b64_tr_b16 v[184:185], v8 offset:61440
  ds_read_b64_tr_b16 v[186:187], v8 offset:63488
  v_mfma_f32_16x16x32_bf16 v[68:71], v[168:171], a[196:199], v[68:71]
  v_mfma_f32_16x16x32_bf16 v[72:75], v[168:171], a[200:203], v[72:75]
  v_mfma_f32_16x16x32_bf16 v[76:79], v[168:171], a[204:207], v[76:79]
  s_waitcnt lgkmcnt(6)
  v_mfma_f32_16x16x32_bf16 v[80:83], v[172:175], a[192:195], v[80:83]
  ds_read_b64_tr_b16 v[188:189], v9 offset:61440
  ds_read_b64_tr_b16 v[190:191], v9 offset:63488
  v_mfma_f32_16x16x32_bf16 v[84:87], v[172:175], a[196:199], v[84:87]
  v_mfma_f32_16x16x32_bf16 v[88:91], v[172:175], a[200:203], v[88:91]
  v_mfma_f32_16x16x32_bf16 v[92:95], v[172:175], a[204:207], v[92:95]
  s_waitcnt lgkmcnt(6)
  v_mfma_f32_16x16x32_bf16 v[32:35], v[176:179], a[208:211], v[32:35]
  ds_read_b64_tr_b16 v[160:161], v10 offset:0
  ds_read_b64_tr_b16 v[162:163], v10 offset:2048
  v_mfma_f32_16x16x32_bf16 v[36:39], v[176:179], a[212:215], v[36:39]
  v_mfma_f32_16x16x32_bf16 v[40:43], v[176:179], a[216:219], v[40:43]
  v_mfma_f32_16x16x32_bf16 v[44:47], v[176:179], a[220:223], v[44:47]
  s_waitcnt lgkmcnt(6)
  v_mfma_f32_16x16x32_bf16 v[48:51], v[180:183], a[208:211], v[48:51]
  ds_read_b64_tr_b16 v[164:165], v11 offset:0
  ds_read_b64_tr_b16 v[166:167], v11 offset:2048
  v_mfma_f32_16x16x32_bf16 v[52:55], v[180:183], a[212:215], v[52:55]
  v_mfma_f32_16x16x32_bf16 v[56:59], v[180:183], a[216:219], v[56:59]
  v_mfma_f32_16x16x32_bf16 v[60:63], v[180:183], a[220:223], v[60:63]
  s_waitcnt lgkmcnt(6)
  v_mfma_f32_16x16x32_bf16 v[64:67], v[184:187], a[208:211], v[64:67]
  ds_read_b64_tr_b16 v[168:169], v10 offset:4096
  ds_read_b64_tr_b16 v[170:171], v10 offset:6144
  v_mfma_f32_16x16x32_bf16 v[68:71], v[184:187], a[212:215], v[68:71]
  v_mfma_f32_16x16x32_bf16 v[72:75], v[184:187], a[216:219], v[72:75]
  v_mfma_f32_16x16x32_bf16 v[76:79], v[184:187], a[220:223], v[76:79]
  s_waitcnt lgkmcnt(6)
  v_mfma_f32_16x16x32_bf16 v[80:83], v[188:191], a[208:211], v[80:83]
  ds_read_b64_tr_b16 v[172:173], v11 offset:4096
  ds_read_b64_tr_b16 v[174:175], v11 offset:6144
  v_mfma_f32_16x16x32_bf16 v[84:87], v[188:191], a[212:215], v[84:87]
  v_mfma_f32_16x16x32_bf16 v[88:91], v[188:191], a[216:219], v[88:91]
  v_mfma_f32_16x16x32_bf16 v[92:95], v[188:191], a[220:223], v[92:95]
  s_waitcnt lgkmcnt(6)
  v_mfma_f32_16x16x32_bf16 v[32:35], v[160:163], a[224:227], v[32:35]
  s_waitcnt vmcnt(12)
  s_waitcnt vmcnt(7)
  v_mov_b32 v1, 0
  s_barrier
  buffer_store_dword v1, v7, s[8:11], 0 offen sc1
  ds_read_b64_tr_b16 v[176:177], v10 offset:8192
  ds_read_b64_tr_b16 v[178:179], v10 offset:10240
  v_mfma_f32_16x16x32_bf16 v[36:39], v[160:163], a[228:231], v[36:39]
  s_add_u32 m0, s32, 40960
  v_mfma_f32_16x16x32_bf16 v[40:43], v[160:163], a[232:235], v[40:43]
  buffer_load_dwordx4 v6, s[52:55], s70 offen offset:0 lds
  v_mfma_f32_16x16x32_bf16 v[44:47], v[160:163], a[236:239], v[44:47]
  s_waitcnt lgkmcnt(6)
  v_mfma_f32_16x16x32_bf16 v[48:51], v[164:167], a[224:227], v[48:51]
  ds_read_b64_tr_b16 v[180:181], v11 offset:8192
  ds_read_b64_tr_b16 v[182:183], v11 offset:10240
  v_mfma_f32_16x16x32_bf16 v[52:55], v[164:167], a[228:231], v[52:55]
  s_add_u32 m0, s32, 45056
  v_mfma_f32_16x16x32_bf16 v[56:59], v[164:167], a[232:235], v[56:59]
  buffer_load_dwordx4 v6, s[52:55], s71 offen offset:0 lds
  v_mfma_f32_16x16x32_bf16 v[60:63], v[164:167], a[236:239], v[60:63]
  s_waitcnt lgkmcnt(6)
  v_mfma_f32_16x16x32_bf16 v[64:67], v[168:171], a[224:227], v[64:67]
  ds_read_b64_tr_b16 v[184:185], v10 offset:12288
  ds_read_b64_tr_b16 v[186:187], v10 offset:14336
  v_mfma_f32_16x16x32_bf16 v[68:71], v[168:171], a[228:231], v[68:71]
  s_add_u32 m0, s32, 49152
  v_mfma_f32_16x16x32_bf16 v[72:75], v[168:171], a[232:235], v[72:75]
  buffer_load_dwordx4 v6, s[52:55], s72 offen offset:0 lds
  v_mfma_f32_16x16x32_bf16 v[76:79], v[168:171], a[236:239], v[76:79]
  s_waitcnt lgkmcnt(6)
  v_mfma_f32_16x16x32_bf16 v[80:83], v[172:175], a[224:227], v[80:83]
  ds_read_b64_tr_b16 v[188:189], v11 offset:12288
  ds_read_b64_tr_b16 v[190:191], v11 offset:14336
  v_mfma_f32_16x16x32_bf16 v[84:87], v[172:175], a[228:231], v[84:87]
  s_add_u32 m0, s32, 53248
  v_mfma_f32_16x16x32_bf16 v[88:91], v[172:175], a[232:235], v[88:91]
  buffer_load_dwordx4 v6, s[52:55], s73 offen offset:0 lds
  v_mfma_f32_16x16x32_bf16 v[92:95], v[172:175], a[236:239], v[92:95]
  s_waitcnt lgkmcnt(6)
  v_mfma_f32_16x16x32_bf16 v[32:35], v[176:179], a[240:243], v[32:35]
  ds_read_b64_tr_b16 v[160:161], v8 offset:8192
  ds_read_b64_tr_b16 v[162:163], v8 offset:10240
  v_mfma_f32_16x16x32_bf16 v[36:39], v[176:179], a[244:247], v[36:39]
  s_add_u32 m0, s32, 57344
  v_mfma_f32_16x16x32_bf16 v[40:43], v[176:179], a[248:251], v[40:43]
  buffer_load_dwordx4 v6, s[52:55], s74 offen offset:0 lds
  v_mfma_f32_16x16x32_bf16 v[44:47], v[176:179], a[252:255], v[44:47]
  s_waitcnt lgkmcnt(6)
  v_mfma_f32_16x16x32_bf16 v[48:51], v[180:183], a[240:243], v[48:51]
  ds_read_b64_tr_b16 v[164:165], v9 offset:8192
  ds_read_b64_tr_b16 v[166:167], v9 offset:10240
  v_mfma_f32_16x16x32_bf16 v[52:55], v[180:183], a[244:247], v[52:55]
  s_add_u32 m0, s32, 61440
  v_mfma_f32_16x16x32_bf16 v[56:59], v[180:183], a[248:251], v[56:59]
  buffer_load_dwordx4 v6, s[52:55], s75 offen offset:0 lds
  v_mfma_f32_16x16x32_bf16 v[60:63], v[180:183], a[252:255], v[60:63]
  s_waitcnt lgkmcnt(6)
  v_mfma_f32_16x16x32_bf16 v[64:67], v[184:187], a[240:243], v[64:67]
  ds_read_b64_tr_b16 v[168:169], v8 offset:12288
  ds_read_b64_tr_b16 v[170:171], v8 offset:14336
  v_mfma_f32_16x16x32_bf16 v[68:71], v[184:187], a[244:247], v[68:71]
  v_mfma_f32_16x16x32_bf16 v[72:75], v[184:187], a[248:251], v[72:75]
  v_mfma_f32_16x16x32_bf16 v[76:79], v[184:187], a[252:255], v[76:79]
  s_waitcnt lgkmcnt(6)
  v_mfma_f32_16x16x32_bf16 v[80:83], v[188:191], a[240:243], v[80:83]
  ds_read_b64_tr_b16 v[172:173], v9 offset:12288
  ds_read_b64_tr_b16 v[174:175], v9 offset:14336
  v_mfma_f32_16x16x32_bf16 v[84:87], v[188:191], a[244:247], v[84:87]
  v_mfma_f32_16x16x32_bf16 v[88:91], v[188:191], a[248:251], v[88:91]
  v_mfma_f32_16x16x32_bf16 v[92:95], v[188:191], a[252:255], v[92:95]
  s_waitcnt lgkmcnt(6)
  v_mfma_f32_16x16x32_bf16 v[32:35], v[160:163], v[224:227], v[32:35]
  ds_read_b64_tr_b16 v[176:177], v8 offset:16384
  ds_read_b64_tr_b16 v[178:179], v8 offset:18432
  v_mfma_f32_16x16x32_bf16 v[36:39], v[160:163], v[228:231], v[36:39]
  v_mfma_f32_16x16x32_bf16 v[40:43], v[160:163], v[232:235], v[40:43]
  v_mfma_f32_16x16x32_bf16 v[44:47], v[160:163], v[236:239], v[44:47]
  s_waitcnt lgkmcnt(6)
  v_mfma_f32_16x16x32_bf16 v[48:51], v[164:167], v[224:227], v[48:51]
  ds_read_b64_tr_b16 v[180:181], v9 offset:16384
  ds_read_b64_tr_b16 v[182:183], v9 offset:18432
  v_mfma_f32_16x16x32_bf16 v[52:55], v[164:167], v[228:231], v[52:55]
  v_mfma_f32_16x16x32_bf16 v[56:59], v[164:167], v[232:235], v[56:59]
  v_mfma_f32_16x16x32_bf16 v[60:63], v[164:167], v[236:239], v[60:63]
  s_waitcnt lgkmcnt(6)
  v_mfma_f32_16x16x32_bf16 v[64:67], v[168:171], v[224:227], v[64:67]
  ds_read_b64_tr_b16 v[184:185], v8 offset:20480
  ds_read_b64_tr_b16 v[186:187], v8 offset:22528
  v_mfma_f32_16x16x32_bf16 v[68:71], v[168:171], v[228:231], v[68:71]
  v_mfma_f32_16x16x32_bf16 v[72:75], v[168:171], v[232:235], v[72:75]
  v_mfma_f32_16x16x32_bf16 v[76:79], v[168:171], v[236:239], v[76:79]
  s_waitcnt lgkmcnt(6)
  v_mfma_f32_16x16x32_bf16 v[80:83], v[172:175], v[224:227], v[80:83]
  ds_read_b64_tr_b16 v[188:189], v9 offset:20480
  ds_read_b64_tr_b16 v[190:191], v9 offset:22528
  v_mfma_f32_16x16x32_bf16 v[84:87], v[172:175], v[228:231], v[84:87]
  v_mfma_f32_16x16x32_bf16 v[88:91], v[172:175], v[232:235], v[88:91]
  v_mfma_f32_16x16x32_bf16 v[92:95], v[172:175], v[236:239], v[92:95]
  s_waitcnt lgkmcnt(6)
  v_mfma_f32_16x16x32_bf16 v[32:35], v[176:179], v[240:243], v[32:35]
  s_waitcnt vmcnt(11)
  s_barrier
  ds_read_b64_tr_b16 v[160:161], v15 offset:16384
  ds_read_b64_tr_b16 v[162:163], v15 offset:17408
  v_mfma_f32_16x16x32_bf16 v[36:39], v[176:179], v[244:247], v[36:39]
  s_add_u32 m0, s32, 8192
  v_mfma_f32_16x16x32_bf16 v[40:43], v[176:179], v[248:251], v[40:43]
  buffer_load_dwordx4 v6, s[52:55], s76 offen offset:0 lds
  v_mfma_f32_16x16x32_bf16 v[44:47], v[176:179], v[252:255], v[44:47]
  s_waitcnt lgkmcnt(6)
  v_mfma_f32_16x16x32_bf16 v[48:51], v[180:183], v[240:243], v[48:51]
  ds_read_b64_tr_b16 v[164:165], v15 offset:18432
  ds_read_b64_tr_b16 v[166:167], v15 offset:19456
  v_mfma_f32_16x16x32_bf16 v[52:55], v[180:183], v[244:247], v[52:55]
  s_add_u32 m0, s32, 12288
  v_mfma_f32_16x16x32_bf16 v[56:59], v[180:183], v[248:251], v[56:59]
  buffer_load_dwordx4 v6, s[52:55], s77 offen offset:0 lds
  v_mfma_f32_16x16x32_bf16 v[60:63], v[180:183], v[252:255], v[60:63]
  v_cvt_pk_bf16_f32 v128, v32, v33
  v_cvt_pk_bf16_f32 v129, v34, v35
  s_waitcnt lgkmcnt(6)
  v_mfma_f32_16x16x32_bf16 v[64:67], v[184:187], v[240:243], v[64:67]
  v_cvt_pk_bf16_f32 v132, v36, v37
  v_cvt_pk_bf16_f32 v133, v38, v39
  ds_read_b64_tr_b16 v[168:169], v15 offset:20480
  ds_read_b64_tr_b16 v[170:171], v15 offset:21504
  v_mfma_f32_16x16x32_bf16 v[68:71], v[184:187], v[244:247], v[68:71]
  v_cvt_pk_bf16_f32 v136, v40, v41
  v_cvt_pk_bf16_f32 v137, v42, v43
  s_add_u32 m0, s32, 65536
  v_mfma_f32_16x16x32_bf16 v[72:75], v[184:187], v[248:251], v[72:75]
  buffer_load_dwordx4 v4, s[20:23], s78 offen offset:0 lds
  v_cvt_pk_bf16_f32 v140, v44, v45
  v_cvt_pk_bf16_f32 v141, v46, v47
  v_mfma_f32_16x16x32_bf16 v[76:79], v[184:187], v[252:255], v[76:79]
  v_cvt_pk_bf16_f32 v130, v48, v49
  v_cvt_pk_bf16_f32 v131, v50, v51
  s_waitcnt lgkmcnt(6)
  v_mfma_f32_16x16x32_bf16 v[80:83], v[188:191], v[240:243], v[80:83]
  v_cvt_pk_bf16_f32 v134, v52, v53
  v_cvt_pk_bf16_f32 v135, v54, v55
  ds_read_b64_tr_b16 v[172:173], v15 offset:22528
  ds_read_b64_tr_b16 v[174:175], v15 offset:23552
  v_mfma_f32_16x16x32_bf16 v[84:87], v[188:191], v[244:247], v[84:87]
  v_cvt_pk_bf16_f32 v138, v56, v57
  v_cvt_pk_bf16_f32 v139, v58, v59
  s_add_u32 m0, s32, 69632
  v_mfma_f32_16x16x32_bf16 v[88:91], v[188:191], v[248:251], v[88:91]
  buffer_load_dwordx4 v4, s[20:23], s79 offen offset:0 lds
  v_cvt_pk_bf16_f32 v142, v60, v61
  v_cvt_pk_bf16_f32 v143, v62, v63
  v_mfma_f32_16x16x32_bf16 v[92:95], v[188:191], v[252:255], v[92:95]
  v_cvt_pk_bf16_f32 v144, v64, v65
  v_cvt_pk_bf16_f32 v145, v66, v67
  s_waitcnt lgkmcnt(6)
  v_mfma_f32_16x16x32_bf16 v[32:35], v[160:163], a[0:3], 0
  v_cvt_pk_bf16_f32 v148, v68, v69
  v_cvt_pk_bf16_f32 v149, v70, v71
  ds_read_b64_tr_b16 v[176:177], v14 offset:24576
  ds_read_b64_tr_b16 v[178:179], v14 offset:25600
  v_mfma_f32_16x16x32_bf16 v[36:39], v[160:163], a[4:7], 0
  v_cvt_pk_bf16_f32 v152, v72, v73
  v_cvt_pk_bf16_f32 v153, v74, v75
  s_add_u32 m0, s32, 73728
  v_mfma_f32_16x16x32_bf16 v[40:43], v[160:163], a[8:11], 0
  buffer_load_dwordx4 v4, s[20:23], s80 offen offset:0 lds
  v_cvt_pk_bf16_f32 v156, v76, v77
  v_cvt_pk_bf16_f32 v157, v78, v79
  v_mfma_f32_16x16x32_bf16 v[44:47], v[160:163], a[12:15], 0
  v_cvt_pk_bf16_f32 v146, v80, v81
  v_cvt_pk_bf16_f32 v147, v82, v83
  s_waitcnt lgkmcnt(6)
  v_mfma_f32_16x16x32_bf16 v[48:51], v[164:167], a[0:3], 0
  v_cvt_pk_bf16_f32 v150, v84, v85
  v_cvt_pk_bf16_f32 v151, v86, v87
  ds_read_b64_tr_b16 v[180:181], v14 offset:26624
  ds_read_b64_tr_b16 v[182:183], v14 offset:27648
  v_mfma_f32_16x16x32_bf16 v[52:55], v[164:167], a[4:7], 0
  v_cvt_pk_bf16_f32 v154, v88, v89
  v_cvt_pk_bf16_f32 v155, v90, v91
  s_add_u32 m0, s32, 77824
  v_mfma_f32_16x16x32_bf16 v[56:59], v[164:167], a[8:11], 0
  buffer_load_dwordx4 v4, s[20:23], s81 offen offset:0 lds
  v_cvt_pk_bf16_f32 v158, v92, v93
  v_cvt_pk_bf16_f32 v159, v94, v95
  v_mfma_f32_16x16x32_bf16 v[60:63], v[164:167], a[12:15], 0
  v_pk_max_i16 v128, v128, 0
  buffer_load_dword v23, off, s[8:11], s59 sc1
  s_waitcnt lgkmcnt(6)
  v_mfma_f32_16x16x32_bf16 v[32:35], v[168:171], a[16:19], v[32:35]
  ds_read_b64_tr_b16 v[184:185], v14 offset:28672
  ds_read_b64_tr_b16 v[186:187], v14 offset:29696
  v_mfma_f32_16x16x32_bf16 v[36:39], v[168:171], a[20:23], v[36:39]
  ds_read_b128 a[0:3], v18 offset:24576
  ds_read_b128 a[4:7], v18 offset:25600
  v_mfma_f32_16x16x32_bf16 v[40:43], v[168:171], a[24:27], v[40:43]
  ds_read_b128 a[8:11], v18 offset:26624
  ds_read_b128 a[12:15], v18 offset:27648
  v_mfma_f32_16x16x32_bf16 v[44:47], v[168:171], a[28:31], v[44:47]
  v_lshlrev_b32 v25, 16, v144
  s_waitcnt lgkmcnt(10)
  v_mfma_f32_16x16x32_bf16 v[48:51], v[172:175], a[16:19], v[48:51]
  ds_read_b64_tr_b16 v[188:189], v14 offset:30720
  ds_read_b64_tr_b16 v[190:191], v14 offset:31744
  v_mfma_f32_16x16x32_bf16 v[52:55], v[172:175], a[20:23], v[52:55]
  v_and_b32 v27, s33, v144
  v_lshlrev_b32 v24, 16, v128
  v_mfma_f32_16x16x32_bf16 v[56:59], v[172:175], a[24:27], v[56:59]
  v_and_b32 v26, s33, v128
  v_mul_f32 v24, v24, v25
  v_mfma_f32_16x16x32_bf16 v[60:63], v[172:175], a[28:31], v[60:63]
  v_mul_f32 v26, v26, v27
  s_waitcnt lgkmcnt(10)
  v_mfma_f32_16x16x32_bf16 v[32:35], v[176:179], a[32:35], v[32:35]
  ds_read_b64_tr_b16 v[160:161], v16 offset:24576
  ds_read_b64_tr_b16 v[162:163], v16 offset:25600
  v_mfma_f32_16x16x32_bf16 v[36:39], v[176:179], a[36:39], v[36:39]
  ds_read_b128 a[16:19], v18 offset:32768
  ds_read_b128 a[20:23], v18 offset:33792
  v_mfma_f32_16x16x32_bf16 v[40:43], v[176:179], a[40:43], v[40:43]
  ds_read_b128 a[24:27], v18 offset:34816
  ds_read_b128 a[28:31], v18 offset:35840
  v_mfma_f32_16x16x32_bf16 v[44:47], v[176:179], a[44:47], v[44:47]
  v_cvt_pk_bf16_f32 v128, v24, v26
  s_waitcnt lgkmcnt(14)
  v_mfma_f32_16x16x32_bf16 v[48:51], v[180:183], a[32:35], v[48:51]
  ds_read_b64_tr_b16 v[164:165], v16 offset:26624
  ds_read_b64_tr_b16 v[166:167], v16 offset:27648
  v_mfma_f32_16x16x32_bf16 v[52:55], v[180:183], a[36:39], v[52:55]
  v_pk_max_i16 v129, v129, 0
  v_lshlrev_b32 v29, 16, v145
  v_mfma_f32_16x16x32_bf16 v[56:59], v[180:183], a[40:43], v[56:59]
  v_and_b32 v31, s33, v145
  v_lshlrev_b32 v28, 16, v129
  v_mfma_f32_16x16x32_bf16 v[60:63], v[180:183], a[44:47], v[60:63]
  v_and_b32 v30, s33, v129
  s_waitcnt lgkmcnt(14)
  v_mfma_f32_16x16x32_bf16 v[32:35], v[184:187], a[48:51], v[32:35]
  ds_read_b64_tr_b16 v[168:169], v16 offset:28672
  ds_read_b64_tr_b16 v[170:171], v16 offset:29696
  v_mfma_f32_16x16x32_bf16 v[36:39], v[184:187], a[52:55], v[36:39]
  ds_read_b128 a[32:35], v18 offset:40960
  ds_read_b128 a[36:39], v18 offset:41984
  v_mfma_f32_16x16x32_bf16 v[40:43], v[184:187], a[56:59], v[40:43]
  ds_read_b128 a[40:43], v18 offset:43008
  ds_read_b128 a[44:47], v18 offset:44032
  v_mfma_f32_16x16x32_bf16 v[44:47], v[184:187], a[60:63], v[44:47]
  v_mul_f32 v28, v28, v29
  s_waitcnt lgkmcnt(14)
  v_mfma_f32_16x16x32_bf16 v[48:51], v[188:191], a[48:51], v[48:51]
  ds_read_b64_tr_b16 v[172:173], v16 offset:30720
  ds_read_b64_tr_b16 v[174:175], v16 offset:31744
  v_mfma_f32_16x16x32_bf16 v[52:55], v[188:191], a[52:55], v[52:55]
  v_mul_f32 v30, v30, v31
  v_cvt_pk_bf16_f32 v129, v28, v30
  v_mfma_f32_16x16x32_bf16 v[56:59], v[188:191], a[56:59], v[56:59]
  v_pk_max_i16 v130, v130, 0
  v_lshlrev_b32 v25, 16, v146
  v_mfma_f32_16x16x32_bf16 v[60:63], v[188:191], a[60:63], v[60:63]
  v_and_b32 v27, s33, v146
  s_waitcnt lgkmcnt(14)
  v_mfma_f32_16x16x32_bf16 v[32:35], v[160:163], a[64:67], v[32:35]
  s_waitcnt vmcnt(11)
  s_waitcnt lgkmcnt(10)
  s_barrier
  ds_read_b64_tr_b16 v[176:177], v14 offset:0
  ds_read_b64_tr_b16 v[178:179], v14 offset:1024
  v_mfma_f32_16x16x32_bf16 v[36:39], v[160:163], a[68:71], v[36:39]
  s_add_u32 m0, s32, 90112
  ds_read_b128 a[48:51], v18 offset:49152
  v_mfma_f32_16x16x32_bf16 v[40:43], v[160:163], a[72:75], v[40:43]
  buffer_load_dwordx4 v4, s[20:23], s82 offen offset:0 lds
  ds_read_b128 a[52:55], v18 offset:50176
  v_mfma_f32_16x16x32_bf16 v[44:47], v[160:163], a[76:79], v[44:47]
  ds_read_b128 a[56:59], v18 offset:51200
  s_waitcnt lgkmcnt(13)
  v_mfma_f32_16x16x32_bf16 v[48:51], v[164:167], a[64:67], v[48:51]
  ds_read_b64_tr_b16 v[180:181], v14 offset:2048
  ds_read_b64_tr_b16 v[182:183], v14 offset:3072
  v_mfma_f32_16x16x32_bf16 v[52:55], v[164:167], a[68:71], v[52:55]
  s_add_u32 m0, s32, 94208
  ds_read_b128 a[60:63], v18 offset:52224
  v_mfma_f32_16x16x32_bf16 v[56:59], v[164:167], a[72:75], v[56:59]
  buffer_load_dwordx4 v4, s[20:23], s83 offen offset:0 lds
  v_lshlrev_b32 v24, 16, v130
  v_mfma_f32_16x16x32_bf16 v[60:63], v[164:167], a[76:79], v[60:63]
  v_and_b32 v26, s33, v130
  s_waitcnt lgkmcnt(14)
  v_mfma_f32_16x16x32_bf16 v[32:35], v[168:171], a[80:83], v[32:35]
  ds_read_b64_tr_b16 v[184:185], v14 offset:4096
  ds_read_b64_tr_b16 v[186:187], v14 offset:5120
  v_mfma_f32_16x16x32_bf16 v[36:39], v[168:171], a[84:87], v[36:39]
  s_add_u32 m0, s32, 98176
  ds_read_b128 a[64:67], v18 offset:57344
  v_mfma_f32_16x16x32_bf16 v[40:43], v[168:171], a[88:91], v[40:43]
  buffer_load_dwordx4 v4, s[20:23], s78 offen offset:128 lds
  ds_read_b128 a[68:71], v18 offset:58368
  v_mfma_f32_16x16x32_bf16 v[44:47], v[168:171], a[92:95], v[44:47]
  ds_read_b128 a[72:75], v18 offset:59392
  s_waitcnt lgkmcnt(13)
  v_mfma_f32_16x16x32_bf16 v[48:51], v[172:175], a[80:83], v[48:51]
  ds_read_b64_tr_b16 v[188:189], v14 offset:6144
  ds_read_b64_tr_b16 v[190:191], v14 offset:7168
  v_mfma_f32_16x16x32_bf16 v[52:55], v[172:175], a[84:87], v[52:55]
  s_add_u32 m0, s32, 102272
  ds_read_b128 a[76:79], v18 offset:60416
  v_mfma_f32_16x16x32_bf16 v[56:59], v[172:175], a[88:91], v[56:59]
  buffer_load_dwordx4 v4, s[20:23], s79 offen offset:128 lds
  v_mul_f32 v24, v24, v25
  v_mfma_f32_16x16x32_bf16 v[60:63], v[172:175], a[92:95], v[60:63]
  v_mul_f32 v26, v26, v27
  s_waitcnt lgkmcnt(14)
  v_mfma_f32_16x16x32_bf16 v[32:35], v[176:179], a[96:99], v[32:35]
  ds_read_b64_tr_b16 v[160:161], v14 offset:32768
  ds_read_b64_tr_b16 v[162:163], v14 offset:33792
  v_mfma_f32_16x16x32_bf16 v[36:39], v[176:179], a[100:103], v[36:39]
  s_add_u32 m0, s32, 16256
  ds_read_b128 a[80:83], v19 offset:0
  v_mfma_f32_16x16x32_bf16 v[40:43], v[176:179], a[104:107], v[40:43]
  buffer_load_dwordx4 v4, s[20:23], s80 offen offset:128 lds
  ds_read_b128 a[84:87], v19 offset:1024
  v_mfma_f32_16x16x32_bf16 v[44:47], v[176:179], a[108:111], v[44:47]
  ds_read_b128 a[88:91], v19 offset:2048
  s_waitcnt lgkmcnt(14)
  v_mfma_f32_16x16x32_bf16 v[48:51], v[180:183], a[96:99], v[48:51]
  ds_read_b64_tr_b16 v[164:165], v14 offset:34816
  ds_read_b64_tr_b16 v[166:167], v14 offset:35840
  v_mfma_f32_16x16x32_bf16 v[52:55], v[180:183], a[100:103], v[52:55]
  s_add_u32 m0, s32, 20352
  ds_read_b128 a[92:95], v19 offset:3072
  v_mfma_f32_16x16x32_bf16 v[56:59], v[180:183], a[104:107], v[56:59]
  buffer_load_dwordx4 v4, s[20:23], s81 offen offset:128 lds
  v_cvt_pk_bf16_f32 v130, v24, v26
  v_mfma_f32_16x16x32_bf16 v[60:63], v[180:183], a[108:111], v[60:63]
  v_pk_max_i16 v131, v131, 0
  s_waitcnt lgkmcnt(14)
  v_mfma_f32_16x16x32_bf16 v[32:35], v[184:187], a[112:115], v[32:35]
  ds_read_b64_tr_b16 v[168:169], v14 offset:36864
  ds_read_b64_tr_b16 v[170:171], v14 offset:37888
  v_mfma_f32_16x16x32_bf16 v[36:39], v[184:187], a[116:119], v[36:39]
  s_add_u32 m0, s32, 24448
  v_lshlrev_b32 v29, 16, v147
  v_mfma_f32_16x16x32_bf16 v[40:43], v[184:187], a[120:123], v[40:43]
  buffer_load_dwordx4 v4, s[20:23], s82 offen offset:128 lds
  v_and_b32 v31, s33, v147
  v_mfma_f32_16x16x32_bf16 v[44:47], v[184:187], a[124:127], v[44:47]
  v_lshlrev_b32 v28, 16, v131
  s_waitcnt lgkmcnt(11)
  v_mfma_f32_16x16x32_bf16 v[48:51], v[188:191], a[112:115], v[48:51]
  ds_read_b64_tr_b16 v[172:173], v14 offset:38912
  ds_read_b64_tr_b16 v[174:175], v14 offset:39936
  v_mfma_f32_16x16x32_bf16 v[52:55], v[188:191], a[116:119], v[52:55]
  s_add_u32 m0, s32, 28544
  v_and_b32 v30, s33, v131
  v_mfma_f32_16x16x32_bf16 v[56:59], v[188:191], a[120:123], v[56:59]
  buffer_load_dwordx4 v4, s[20:23], s83 offen offset:128 lds
  v_mul_f32 v28, v28, v29
  v_mfma_f32_16x16x32_bf16 v[60:63], v[188:191], a[124:127], v[60:63]
  v_mul_f32 v30, v30, v31
  s_waitcnt vmcnt(8)
  v_readfirstlane_b32 s30, v23
  s_nop 0
  s_cmp_ge_i32 s30, 0
  s_cbranch_scc0 slow_29
back_30:
  s_waitcnt lgkmcnt(10)
  v_mfma_f32_16x16x32_bf16 v[32:35], v[160:163], a[128:131], v[32:35]
  ds_read_b64_tr_b16 v[176:177], v14 offset:40960
  ds_read_b64_tr_b16 v[178:179], v14 offset:41984
  v_mfma_f32_16x16x32_bf16 v[36:39], v[160:163], a[132:135], v[36:39]
  v_cvt_pk_bf16_f32 v131, v28, v30
  v_add_u32 v20, 65536, v20
  v_add_u32 v21, 65536, v21
  ds_write_b128 v20, v[128:131] offset:8192
  v_mfma_f32_16x16x32_bf16 v[40:43], v[160:163], a[136:139], v[40:43]
  buffer_store_dwordx4 v[128:131], v5, s[8:11], s57 offen offset:0 sc1
  v_pk_max_i16 v132, v132, 0
  v_mfma_f32_16x16x32_bf16 v[44:47], v[160:163], a[140:143], v[44:47]
  v_lshlrev_b32 v25, 16, v148
  s_waitcnt lgkmcnt(8)
  v_mfma_f32_16x16x32_bf16 v[48:51], v[164:167], a[128:131], v[48:51]
  ds_read_b64_tr_b16 v[180:181], v14 offset:43008
  ds_read_b64_tr_b16 v[182:183], v14 offset:44032
  v_mfma_f32_16x16x32_bf16 v[52:55], v[164:167], a[132:135], v[52:55]
  v_and_b32 v27, s33, v148
  v_lshlrev_b32 v24, 16, v132
  v_mfma_f32_16x16x32_bf16 v[56:59], v[164:167], a[136:139], v[56:59]
  v_and_b32 v26, s33, v132
  v_mul_f32 v24, v24, v25
  v_mfma_f32_16x16x32_bf16 v[60:63], v[164:167], a[140:143], v[60:63]
  v_mul_f32 v26, v26, v27
  s_waitcnt lgkmcnt(7)
  v_mfma_f32_16x16x32_bf16 v[32:35], v[168:171], a[144:147], v[32:35]
  ds_read_b64_tr_b16 v[184:185], v14 offset:45056
  ds_read_b64_tr_b16 v[186:187], v14 offset:46080
  v_mfma_f32_16x16x32_bf16 v[36:39], v[168:171], a[148:151], v[36:39]
  v_cvt_pk_bf16_f32 v132, v24, v26
  v_pk_max_i16 v133, v133, 0
  v_mfma_f32_16x16x32_bf16 v[40:43], v[168:171], a[152:155], v[40:43]
  v_lshlrev_b32 v29, 16, v149
  v_and_b32 v31, s33, v149
  v_mfma_f32_16x16x32_bf16 v[44:47], v[168:171], a[156:159], v[44:47]
  v_lshlrev_b32 v28, 16, v133
  s_waitcnt lgkmcnt(7)
  v_mfma_f32_16x16x32_bf16 v[48:51], v[172:175], a[144:147], v[48:51]
  ds_read_b64_tr_b16 v[188:189], v14 offset:47104
  ds_read_b64_tr_b16 v[190:191], v14 offset:48128
  v_mfma_f32_16x16x32_bf16 v[52:55], v[172:175], a[148:151], v[52:55]
  v_and_b32 v30, s33, v133
  v_mul_f32 v28, v28, v29
  v_mfma_f32_16x16x32_bf16 v[56:59], v[172:175], a[152:155], v[56:59]
  v_mul_f32 v30, v30, v31
  v_cvt_pk_bf16_f32 v133, v28, v30
  v_mfma_f32_16x16x32_bf16 v[60:63], v[172:175], a[156:159], v[60:63]
  v_pk_max_i16 v134, v134, 0
  s_waitcnt lgkmcnt(7)
  v_mfma_f32_16x16x32_bf16 v[32:35], v[176:179], a[160:163], v[32:35]
  s_waitcnt lgkmcnt(6)
  s_barrier
  ds_read_b64_tr_b16 v[160:161], v14 offset:49152
  ds_read_b64_tr_b16 v[162:163], v14 offset:50176
  v_mfma_f32_16x16x32_bf16 v[36:39], v[176:179], a[164:167], v[36:39]
  s_add_u32 m0, s32, 106240
  v_lshlrev_b32 v25, 16, v150
  v_mfma_f32_16x16x32_bf16 v[40:43], v[176:179], a[168:171], v[40:43]
  buffer_load_dwordx4 v4, s[20:23], s78 offen offset:256 lds
  v_and_b32 v27, s33, v150
  v_mfma_f32_16x16x32_bf16 v[44:47], v[176:179], a[172:175], v[44:47]
  v_lshlrev_b32 v24, 16, v134
  s_waitcnt lgkmcnt(6)
  v_mfma_f32_16x16x32_bf16 v[48:51], v[180:183], a[160:163], v[48:51]
  ds_read_b64_tr_b16 v[164:165], v14 offset:51200
  ds_read_b64_tr_b16 v[166:167], v14 offset:52224
  v_mfma_f32_16x16x32_bf16 v[52:55], v[180:183], a[164:167], v[52:55]
  s_add_u32 m0, s32, 110336
  v_and_b32 v26, s33, v134
  v_mfma_f32_16x16x32_bf16 v[56:59], v[180:183], a[168:171], v[56:59]
  buffer_load_dwordx4 v4, s[20:23], s79 offen offset:256 lds
  v_mul_f32 v24, v24, v25
  v_mfma_f32_16x16x32_bf16 v[60:63], v[180:183], a[172:175], v[60:63]
  v_mul_f32 v26, v26, v27
  s_waitcnt lgkmcnt(6)
  v_mfma_f32_16x16x32_bf16 v[32:35], v[184:187], a[176:179], v[32:35]
  ds_read_b64_tr_b16 v[168:169], v14 offset:53248
  ds_read_b64_tr_b16 v[170:171], v14 offset:54272
  v_mfma_f32_16x16x32_bf16 v[36:39], v[184:187], a[180:183], v[36:39]
  s_add_u32 m0, s32, 114432
  v_cvt_pk_bf16_f32 v134, v24, v26
  v_mfma_f32_16x16x32_bf16 v[40:43], v[184:187], a[184:187], v[40:43]
  buffer_load_dwordx4 v4, s[20:23], s80 offen offset:256 lds
  v_pk_max_i16 v135, v135, 0
  v_mfma_f32_16x16x32_bf16 v[44:47], v[184:187], a[188:191], v[44:47]
  v_lshlrev_b32 v29, 16, v151
  s_waitcnt lgkmcnt(6)
  v_mfma_f32_16x16x32_bf16 v[48:51], v[188:191], a[176:179], v[48:51]
  ds_read_b64_tr_b16 v[172:173], v14 offset:55296
  ds_read_b64_tr_b16 v[174:175], v14 offset:56320
  v_mfma_f32_16x16x32_bf16 v[52:55], v[188:191], a[180:183], v[52:55]
  s_add_u32 m0, s32, 118528
  v_and_b32 v31, s33, v151
  v_mfma_f32_16x16x32_bf16 v[56:59], v[188:191], a[184:187], v[56:59]
  buffer_load_dwordx4 v4, s[20:23], s81 offen offset:256 lds
  v_lshlrev_b32 v28, 16, v135
  v_mfma_f32_16x16x32_bf16 v[60:63], v[188:191], a[188:191], v[60:63]
  v_and_b32 v30, s33, v135
  s_waitcnt lgkmcnt(6)
  v_mfma_f32_16x16x32_bf16 v[32:35], v[160:163], a[192:195], v[32:35]
  ds_read_b64_tr_b16 v[176:177], v14 offset:57344
  ds_read_b64_tr_b16 v[178:179], v14 offset:58368
  v_mfma_f32_16x16x32_bf16 v[36:39], v[160:163], a[196:199], v[36:39]
  s_add_u32 m0, s32, 122624
  v_mul_f32 v28, v28, v29
  v_mfma_f32_16x16x32_bf16 v[40:43], v[160:163], a[200:203], v[40:43]
  buffer_load_dwordx4 v4, s[20:23], s82 offen offset:256 lds
  v_mul_f32 v30, v30, v31
  v_mfma_f32_16x16x32_bf16 v[44:47], v[160:163], a[204:207], v[44:47]
  v_cvt_pk_bf16_f32 v135, v28, v30
  s_waitcnt lgkmcnt(6)
  v_mfma_f32_16x16x32_bf16 v[48:51], v[164:167], a[192:195], v[48:51]
  ds_read_b64_tr_b16 v[180:181], v14 offset:59392
  ds_read_b64_tr_b16 v[182:183], v14 offset:60416
  v_mfma_f32_16x16x32_bf16 v[52:55], v[164:167], a[196:199], v[52:55]
  s_add_u32 s47, s37, 0
  s_add_u32 m0, s32, 131072
  v_mfma_f32_16x16x32_bf16 v[56:59], v[164:167], a[200:203], v[56:59]
  buffer_load_dwordx4 v5, s[8:11], s47 offen offset:0 sc1 lds
  ds_write_b128 v20, v[132:135] offset:9216
  v_mfma_f32_16x16x32_bf16 v[60:63], v[164:167], a[204:207], v[60:63]
  buffer_store_dwordx4 v[132:135], v5, s[8:11], s57 offen offset:1024 sc1
  s_waitcnt lgkmcnt(7)
  v_mfma_f32_16x16x32_bf16 v[32:35], v[168:171], a[208:211], v[32:35]
  ds_read_b64_tr_b16 v[184:185], v14 offset:61440
  ds_read_b64_tr_b16 v[186:187], v14 offset:62464
  v_mfma_f32_16x16x32_bf16 v[36:39], v[168:171], a[212:215], v[36:39]
  s_add_u32 s47, s37, 4096
  s_add_u32 m0, s32, 135168
  v_mfma_f32_16x16x32_bf16 v[40:43], v[168:171], a[216:219], v[40:43]
  buffer_load_dwordx4 v5, s[8:11], s47 offen offset:0 sc1 lds
  v_pk_max_i16 v136, v136, 0
  v_mfma_f32_16x16x32_bf16 v[44:47], v[168:171], a[220:223], v[44:47]
  v_lshlrev_b32 v25, 16, v152
  s_waitcnt lgkmcnt(7)
  v_mfma_f32_16x16x32_bf16 v[48:51], v[172:175], a[208:211], v[48:51]
  ds_read_b64_tr_b16 v[188:189], v14 offset:63488
  ds_read_b64_tr_b16 v[190:191], v14 offset:64512
  v_mfma_f32_16x16x32_bf16 v[52:55], v[172:175], a[212:215], v[52:55]
  s_add_u32 m0, s32, 126720
  v_and_b32 v27, s33, v152
  v_mfma_f32_16x16x32_bf16 v[56:59], v[172:175], a[216:219], v[56:59]
  buffer_load_dwordx4 v4, s[20:23], s83 offen offset:256 lds
  v_lshlrev_b32 v24, 16, v136
  v_mfma_f32_16x16x32_bf16 v[60:63], v[172:175], a[220:223], v[60:63]
  v_and_b32 v26, s33, v136
  s_waitcnt lgkmcnt(7)
  v_mfma_f32_16x16x32_bf16 v[32:35], v[176:179], a[224:227], v[32:35]
  ds_read_b64_tr_b16 v[160:161], v14 offset:8192
  ds_read_b64_tr_b16 v[162:163], v14 offset:9216
  v_mfma_f32_16x16x32_bf16 v[36:39], v[176:179], a[228:231], v[36:39]
  v_mul_f32 v24, v24, v25
  v_mul_f32 v26, v26, v27
  v_mfma_f32_16x16x32_bf16 v[40:43], v[176:179], a[232:235], v[40:43]
  v_cvt_pk_bf16_f32 v136, v24, v26
  v_pk_max_i16 v137, v137, 0
  v_mfma_f32_16x16x32_bf16 v[44:47], v[176:179], a[236:239], v[44:47]
  v_lshlrev_b32 v29, 16, v153
  s_waitcnt lgkmcnt(7)
  v_mfma_f32_16x16x32_bf16 v[48:51], v[180:183], a[224:227], v[48:51]
  ds_read_b64_tr_b16 v[164:165], v14 offset:10240
  ds_read_b64_tr_b16 v[166:167], v14 offset:11264
  v_mfma_f32_16x16x32_bf16 v[52:55], v[180:183], a[228:231], v[52:55]
  v_and_b32 v31, s33, v153
  v_lshlrev_b32 v28, 16, v137
  v_mfma_f32_16x16x32_bf16 v[56:59], v[180:183], a[232:235], v[56:59]
  v_and_b32 v30, s33, v137
  v_mul_f32 v28, v28, v29
  v_mfma_f32_16x16x32_bf16 v[60:63], v[180:183], a[236:239], v[60:63]
  v_mul_f32 v30, v30, v31
  s_waitcnt lgkmcnt(6)
  v_mfma_f32_16x16x32_bf16 v[32:35], v[184:187], a[240:243], v[32:35]
  ds_read_b64_tr_b16 v[168:169], v14 offset:12288
  ds_read_b64_tr_b16 v[170:171], v14 offset:13312
  v_mfma_f32_16x16x32_bf16 v[36:39], v[184:187], a[244:247], v[36:39]
  v_cvt_pk_bf16_f32 v137, v28, v30
  v_pk_max_i16 v138, v138, 0
  v_mfma_f32_16x16x32_bf16 v[40:43], v[184:187], a[248:251], v[40:43]
  v_lshlrev_b32 v25, 16, v154
  v_and_b32 v27, s33, v154
  v_mfma_f32_16x16x32_bf16 v[44:47], v[184:187], a[252:255], v[44:47]
  v_lshlrev_b32 v24, 16, v138
  s_waitcnt lgkmcnt(6)
  v_mfma_f32_16x16x32_bf16 v[48:51], v[188:191], a[240:243], v[48:51]
  ds_read_b64_tr_b16 v[172:173], v14 offset:14336
  ds_read_b64_tr_b16 v[174:175], v14 offset:15360
  v_mfma_f32_16x16x32_bf16 v[52:55], v[188:191], a[244:247], v[52:55]
  v_and_b32 v26, s33, v138
  v_mul_f32 v24, v24, v25
  v_mfma_f32_16x16x32_bf16 v[56:59], v[188:191], a[248:251], v[56:59]
  v_mul_f32 v26, v26, v27
  v_cvt_pk_bf16_f32 v138, v24, v26
  v_mfma_f32_16x16x32_bf16 v[60:63], v[188:191], a[252:255], v[60:63]
  v_pk_max_i16 v139, v139, 0
  s_waitcnt lgkmcnt(6)
  v_mfma_f32_16x16x32_bf16 v[32:35], v[160:163], v[224:227], v[32:35]
  s_waitcnt vmcnt(16)
  s_barrier
  ds_read_b64_tr_b16 v[176:177], v10 offset:0
  ds_read_b64_tr_b16 v[178:179], v10 offset:2048
  v_mfma_f32_16x16x32_bf16 v[36:39], v[160:163], v[228:231], v[36:39]
  s_add_u32 m0, s32, 81920
  v_lshlrev_b32 v29, 16, v155
  v_mfma_f32_16x16x32_bf16 v[40:43], v[160:163], v[232:235], v[40:43]
  buffer_load_dwordx4 v4, s[20:23], s40 offen offset:0 lds
  v_and_b32 v31, s33, v155
  v_mfma_f32_16x16x32_bf16 v[44:47], v[160:163], v[236:239], v[44:47]
  v_lshlrev_b32 v28, 16, v139
  s_waitcnt lgkmcnt(6)
  v_mfma_f32_16x16x32_bf16 v[48:51], v[164:167], v[224:227], v[48:51]
  ds_read_b64_tr_b16 v[180:181], v11 offset:0
  ds_read_b64_tr_b16 v[182:183], v11 offset:2048
  v_mfma_f32_16x16x32_bf16 v[52:55], v[164:167], v[228:231], v[52:55]
  s_add_u32 m0, s32, 85888
  v_and_b32 v30, s33, v139
  v_mfma_f32_16x16x32_bf16 v[56:59], v[164:167], v[232:235], v[56:59]
  buffer_load_dwordx4 v4, s[20:23], s40 offen offset:128 lds
  v_mul_f32 v28, v28, v29
  v_mfma_f32_16x16x32_bf16 v[60:63], v[164:167], v[236:239], v[60:63]
  v_mul_f32 v30, v30, v31
  s_waitcnt lgkmcnt(6)
  v_mfma_f32_16x16x32_bf16 v[32:35], v[168:171], v[240:243], v[32:35]
  ds_read_b64_tr_b16 v[184:185], v10 offset:4096
  ds_read_b64_tr_b16 v[186:187], v10 offset:6144
  v_mfma_f32_16x16x32_bf16 v[36:39], v[168:171], v[244:247], v[36:39]
  s_add_u32 s47, s37, 8192
  s_add_u32 m0, s32, 0
  v_mfma_f32_16x16x32_bf16 v[40:43], v[168:171], v[248:251], v[40:43]
  buffer_load_dwordx4 v5, s[8:11], s47 offen offset:0 sc1 lds
  v_cvt_pk_bf16_f32 v139, v28, v30
  v_mfma_f32_16x16x32_bf16 v[44:47], v[168:171], v[252:255], v[44:47]
  ds_write_b128 v20, v[136:139] offset:10240
  s_waitcnt lgkmcnt(7)
  v_mfma_f32_16x16x32_bf16 v[48:51], v[172:175], v[240:243], v[48:51]
  ds_read_b64_tr_b16 v[188:189], v11 offset:4096
  ds_read_b64_tr_b16 v[190:191], v11 offset:6144
  v_mfma_f32_16x16x32_bf16 v[52:55], v[172:175], v[244:247], v[52:55]
  s_add_u32 s47, s37, 12288
  s_add_u32 m0, s32, 4096
  v_mfma_f32_16x16x32_bf16 v[56:59], v[172:175], v[248:251], v[56:59]
  buffer_load_dwordx4 v5, s[8:11], s47 offen offset:0 sc1 lds
  buffer_store_dwordx4 v[136:139], v5, s[8:11], s57 offen offset:2048 sc1
  v_mfma_f32_16x16x32_bf16 v[60:63], v[172:175], v[252:255], v[60:63]
  v_cvt_pk_bf16_f32 v192, v32, v33
  v_cvt_pk_bf16_f32 v193, v34, v35
  s_waitcnt lgkmcnt(7)
  v_mfma_f32_16x16x32_bf16 v[64:67], v[176:179], a[0:3], 0
  v_cvt_pk_bf16_f32 v194, v36, v37
  v_cvt_pk_bf16_f32 v195, v38, v39
  ds_read_b64_tr_b16 v[160:161], v10 offset:8192
  ds_read_b64_tr_b16 v[162:163], v10 offset:10240
  v_mfma_f32_16x16x32_bf16 v[72:75], v[176:179], a[4:7], 0
  v_cvt_pk_bf16_f32 v196, v40, v41
  v_cvt_pk_bf16_f32 v197, v42, v43
  s_add_u32 m0, s32, 32512
  v_mfma_f32_16x16x32_bf16 v[80:83], v[176:179], a[8:11], 0
  buffer_load_dwordx4 v4, s[20:23], s40 offen offset:256 lds
  v_cvt_pk_bf16_f32 v198, v44, v45
  v_cvt_pk_bf16_f32 v199, v46, v47
  v_mfma_f32_16x16x32_bf16 v[88:91], v[176:179], a[12:15], 0
  v_cvt_pk_bf16_f32 v208, v48, v49
  v_cvt_pk_bf16_f32 v209, v50, v51
  s_waitcnt lgkmcnt(7)
  v_mfma_f32_16x16x32_bf16 v[68:71], v[180:183], a[0:3], 0
  v_cvt_pk_bf16_f32 v210, v52, v53
  v_cvt_pk_bf16_f32 v211, v54, v55
  ds_read_b64_tr_b16 v[164:165], v11 offset:8192
  ds_read_b64_tr_b16 v[166:167], v11 offset:10240
  v_mfma_f32_16x16x32_bf16 v[76:79], v[180:183], a[4:7], 0
  v_cvt_pk_bf16_f32 v212, v56, v57
  v_cvt_pk_bf16_f32 v213, v58, v59
  s_add_u32 m0, s32, 36864
  v_mfma_f32_16x16x32_bf16 v[84:87], v[180:183], a[8:11], 0
  buffer_load_dwordx4 v4, s[20:23], s41 offen offset:0 lds
  v_cvt_pk_bf16_f32 v214, v60, v61
  v_cvt_pk_bf16_f32 v215, v62, v63
  v_mfma_f32_16x16x32_bf16 v[92:95], v[180:183], a[12:15], 0
  v_pk_max_i16 v140, v140, 0
  s_waitcnt lgkmcnt(7)
  v_mfma_f32_16x16x32_bf16 v[64:67], v[184:187], a[16:19], v[64:67]
  ds_read_b64_tr_b16 v[168:169], v10 offset:12288
  ds_read_b64_tr_b16 v[170:171], v10 offset:14336
  v_mfma_f32_16x16x32_bf16 v[72:75], v[184:187], a[20:23], v[72:75]
  s_add_u32 m0, s32, 40832
  v_lshlrev_b32 v25, 16, v156
  v_mfma_f32_16x16x32_bf16 v[80:83], v[184:187], a[24:27], v[80:83]
  buffer_load_dwordx4 v4, s[20:23], s41 offen offset:128 lds
  v_and_b32 v27, s33, v156
  v_mfma_f32_16x16x32_bf16 v[88:91], v[184:187], a[28:31], v[88:91]
  v_lshlrev_b32 v24, 16, v140
  s_waitcnt lgkmcnt(6)
  v_mfma_f32_16x16x32_bf16 v[68:71], v[188:191], a[16:19], v[68:71]
  ds_read_b64_tr_b16 v[172:173], v11 offset:12288
  ds_read_b64_tr_b16 v[174:175], v11 offset:14336
  v_mfma_f32_16x16x32_bf16 v[76:79], v[188:191], a[20:23], v[76:79]
  s_add_u32 s47, s37, 16384
  s_add_u32 m0, s32, 49152
  v_mfma_f32_16x16x32_bf16 v[84:87], v[188:191], a[24:27], v[84:87]
  buffer_load_dwordx4 v5, s[8:11], s47 offen offset:0 sc1 lds
  v_and_b32 v26, s33, v140
  v_mfma_f32_16x16x32_bf16 v[92:95], v[188:191], a[28:31], v[92:95]
  v_mul_f32 v24, v24, v25
  s_waitcnt lgkmcnt(6)
  v_mfma_f32_16x16x32_bf16 v[64:67], v[160:163], a[32:35], v[64:67]
  ds_read_b64_tr_b16 v[176:177], v10 offset:24576
  ds_read_b64_tr_b16 v[178:179], v10 offset:26624
  v_mfma_f32_16x16x32_bf16 v[72:75], v[160:163], a[36:39], v[72:75]
  s_add_u32 s47, s37, 20480
  s_add_u32 m0, s32, 53248
  v_mfma_f32_16x16x32_bf16 v[80:83], v[160:163], a[40:43], v[80:83]
  buffer_load_dwordx4 v5, s[8:11], s47 offen offset:0 sc1 lds
  v_mul_f32 v26, v26, v27
  v_mfma_f32_16x16x32_bf16 v[88:91], v[160:163], a[44:47], v[88:91]
  v_cvt_pk_bf16_f32 v140, v24, v26
  s_waitcnt lgkmcnt(6)
  v_mfma_f32_16x16x32_bf16 v[68:71], v[164:167], a[32:35], v[68:71]
  ds_read_b64_tr_b16 v[180:181], v11 offset:24576
  ds_read_b64_tr_b16 v[182:183], v11 offset:26624
  v_mfma_f32_16x16x32_bf16 v[76:79], v[164:167], a[36:39], v[76:79]
  s_add_u32 m0, s32, 44800
  v_pk_max_i16 v141, v141, 0
  v_mfma_f32_16x16x32_bf16 v[84:87], v[164:167], a[40:43], v[84:87]
  buffer_load_dwordx4 v4, s[20:23], s41 offen offset:256 lds
  v_lshlrev_b32 v29, 16, v157
  v_mfma_f32_16x16x32_bf16 v[92:95], v[164:167], a[44:47], v[92:95]
  v_and_b32 v31, s33, v157
  s_waitcnt lgkmcnt(6)
  v_mfma_f32_16x16x32_bf16 v[64:67], v[168:171], a[48:51], v[64:67]
  ds_read_b64_tr_b16 v[184:185], v10 offset:28672
  ds_read_b64_tr_b16 v[186:187], v10 offset:30720
  v_mfma_f32_16x16x32_bf16 v[72:75], v[168:171], a[52:55], v[72:75]
  v_lshlrev_b32 v28, 16, v141
  v_and_b32 v30, s33, v141
  v_mfma_f32_16x16x32_bf16 v[80:83], v[168:171], a[56:59], v[80:83]
  v_mul_f32 v28, v28, v29
  v_mul_f32 v30, v30, v31
  v_mfma_f32_16x16x32_bf16 v[88:91], v[168:171], a[60:63], v[88:91]
  v_cvt_pk_bf16_f32 v141, v28, v30
  s_waitcnt lgkmcnt(6)
  v_mfma_f32_16x16x32_bf16 v[68:71], v[172:175], a[48:51], v[68:71]
  ds_read_b64_tr_b16 v[188:189], v11 offset:28672
  ds_read_b64_tr_b16 v[190:191], v11 offset:30720
  v_mfma_f32_16x16x32_bf16 v[76:79], v[172:175], a[52:55], v[76:79]
  v_pk_max_i16 v142, v142, 0
  v_lshlrev_b32 v25, 16, v158
  v_mfma_f32_16x16x32_bf16 v[84:87], v[172:175], a[56:59], v[84:87]
  v_and_b32 v27, s33, v158
  v_lshlrev_b32 v24, 16, v142
  v_mfma_f32_16x16x32_bf16 v[92:95], v[172:175], a[60:63], v[92:95]
  v_and_b32 v26, s33, v142
  s_waitcnt lgkmcnt(6)
  v_mfma_f32_16x16x32_bf16 v[64:67], v[176:179], a[64:67], v[64:67]
  s_waitcnt vmcnt(21)
  s_barrier
  ds_read_b64_tr_b16 v[160:161], v10 offset:32768
  ds_read_b64_tr_b16 v[162:163], v10 offset:34816
  v_mfma_f32_16x16x32_bf16 v[72:75], v[176:179], a[68:71], v[72:75]
  s_add_u32 m0, s32, 57344
  v_mul_f32 v24, v24, v25
  v_mfma_f32_16x16x32_bf16 v[80:83], v[176:179], a[72:75], v[80:83]
  buffer_load_dwordx4 v4, s[20:23], s42 offen offset:0 lds
  v_mul_f32 v26, v26, v27
  v_mfma_f32_16x16x32_bf16 v[88:91], v[176:179], a[76:79], v[88:91]
  v_cvt_pk_bf16_f32 v142, v24, v26
  s_waitcnt lgkmcnt(6)
  v_mfma_f32_16x16x32_bf16 v[68:71], v[180:183], a[64:67], v[68:71]
  ds_read_b64_tr_b16 v[164:165], v11 offset:32768
  ds_read_b64_tr_b16 v[166:167], v11 offset:34816
  v_mfma_f32_16x16x32_bf16 v[76:79], v[180:183], a[68:71], v[76:79]
  s_add_u32 m0, s32, 61312
  v_pk_max_i16 v143, v143, 0
  v_mfma_f32_16x16x32_bf16 v[84:87], v[180:183], a[72:75], v[84:87]
  buffer_load_dwordx4 v4, s[20:23], s42 offen offset:128 lds
  v_lshlrev_b32 v29, 16, v159
  v_mfma_f32_16x16x32_bf16 v[92:95], v[180:183], a[76:79], v[92:95]
  v_and_b32 v31, s33, v159
  s_waitcnt lgkmcnt(6)
  v_mfma_f32_16x16x32_bf16 v[64:67], v[184:187], a[80:83], v[64:67]
  ds_read_b64_tr_b16 v[168:169], v10 offset:36864
  ds_read_b64_tr_b16 v[170:171], v10 offset:38912
  v_mfma_f32_16x16x32_bf16 v[72:75], v[184:187], a[84:87], v[72:75]
  s_add_u32 m0, s32, 7936
  v_lshlrev_b32 v28, 16, v143
  v_mfma_f32_16x16x32_bf16 v[80:83], v[184:187], a[88:91], v[80:83]
  buffer_load_dwordx4 v4, s[20:23], s42 offen offset:256 lds
  v_and_b32 v30, s33, v143
  v_mfma_f32_16x16x32_bf16 v[88:91], v[184:187], a[92:95], v[88:91]
  v_mul_f32 v28, v28, v29
  s_waitcnt lgkmcnt(6)
  v_mfma_f32_16x16x32_bf16 v[68:71], v[188:191], a[80:83], v[68:71]
  ds_read_b64_tr_b16 v[172:173], v11 offset:36864
  ds_read_b64_tr_b16 v[174:175], v11 offset:38912
  v_mfma_f32_16x16x32_bf16 v[76:79], v[188:191], a[84:87], v[76:79]
  s_add_u32 m0, s32, 12288
  v_mul_f32 v30, v30, v31
  v_mfma_f32_16x16x32_bf16 v[84:87], v[188:191], a[88:91], v[84:87]
  buffer_load_dwordx4 v4, s[20:23], s84 offen offset:0 lds
  v_cvt_pk_bf16_f32 v143, v28, v30
  v_mfma_f32_16x16x32_bf16 v[92:95], v[188:191], a[92:95], v[92:95]
  ds_write_b128 v20, v[140:143] offset:11264
  s_waitcnt lgkmcnt(7)
  v_mfma_f32_16x16x32_bf16 v[96:99], v[160:163], a[0:3], 0
  ds_read_b64_tr_b16 v[176:177], v8 offset:16384
  ds_read_b64_tr_b16 v[178:179], v8 offset:18432
  v_mfma_f32_16x16x32_bf16 v[104:107], v[160:163], a[4:7], 0
  s_add_u32 m0, s32, 65408
  buffer_store_dwordx4 v[140:143], v5, s[8:11], s57 offen offset:3072 sc1
  v_mfma_f32_16x16x32_bf16 v[112:115], v[160:163], a[8:11], 0
  buffer_load_dwordx4 v4, s[20:23], s84 offen offset:128 lds
  s_add_u32 s57, s57, 16384
  v_mfma_f32_16x16x32_bf16 v[120:123], v[160:163], a[12:15], 0
  v_pk_max_i16 v192, v192, 0
  s_waitcnt lgkmcnt(7)
  v_mfma_f32_16x16x32_bf16 v[100:103], v[164:167], a[0:3], 0
  ds_read_b64_tr_b16 v[180:181], v9 offset:16384
  ds_read_b64_tr_b16 v[182:183], v9 offset:18432
  v_mfma_f32_16x16x32_bf16 v[108:111], v[164:167], a[4:7], 0
  s_add_u32 m0, s32, 69376
  v_lshlrev_b32 v25, 16, v208
  v_mfma_f32_16x16x32_bf16 v[116:119], v[164:167], a[8:11], 0
  buffer_load_dwordx4 v4, s[20:23], s84 offen offset:256 lds
  v_and_b32 v27, s33, v208
  v_mfma_f32_16x16x32_bf16 v[124:127], v[164:167], a[12:15], 0
  v_lshlrev_b32 v24, 16, v192
  s_waitcnt lgkmcnt(7)
  v_mfma_f32_16x16x32_bf16 v[96:99], v[168:171], a[16:19], v[96:99]
  ds_read_b64_tr_b16 v[184:185], v8 offset:20480
  ds_read_b64_tr_b16 v[186:187], v8 offset:22528
  v_mfma_f32_16x16x32_bf16 v[104:107], v[168:171], a[20:23], v[104:107]
  v_and_b32 v26, s33, v192
  v_mul_f32 v24, v24, v25
  v_mfma_f32_16x16x32_bf16 v[112:115], v[168:171], a[24:27], v[112:115]
  v_mul_f32 v26, v26, v27
  v_cvt_pk_bf16_f32 v192, v24, v26
  v_mfma_f32_16x16x32_bf16 v[120:123], v[168:171], a[28:31], v[120:123]
  v_pk_max_i16 v193, v193, 0
  s_waitcnt lgkmcnt(7)
  v_mfma_f32_16x16x32_bf16 v[100:103], v[172:175], a[16:19], v[100:103]
  ds_read_b64_tr_b16 v[188:189], v9 offset:20480
  ds_read_b64_tr_b16 v[190:191], v9 offset:22528
  v_mfma_f32_16x16x32_bf16 v[108:111], v[172:175], a[20:23], v[108:111]
  v_lshlrev_b32 v29, 16, v209
  v_and_b32 v31, s33, v209
  v_mfma_f32_16x16x32_bf16 v[116:119], v[172:175], a[24:27], v[116:119]
  v_lshlrev_b32 v28, 16, v193
  v_and_b32 v30, s33, v193
  v_mfma_f32_16x16x32_bf16 v[124:127], v[172:175], a[28:31], v[124:127]
  v_mul_f32 v28, v28, v29
  s_waitcnt lgkmcnt(6)
  v_mfma_f32_16x16x32_bf16 v[96:99], v[176:179], a[32:35], v[96:99]
  ds_read_b64_tr_b16 v[160:161], v8 offset:24576
  ds_read_b64_tr_b16 v[162:163], v8 offset:26624
  v_mfma_f32_16x16x32_bf16 v[104:107], v[176:179], a[36:39], v[104:107]
  v_mul_f32 v30, v30, v31
  v_cvt_pk_bf16_f32 v193, v28, v30
  v_mfma_f32_16x16x32_bf16 v[112:115], v[176:179], a[40:43], v[112:115]
  ds_write_b64 v21, v[192:193] offset:24576
  v_pk_max_i16 v194, v194, 0
  v_mfma_f32_16x16x32_bf16 v[120:123], v[176:179], a[44:47], v[120:123]
  v_lshlrev_b32 v25, 16, v210
  s_waitcnt lgkmcnt(7)
  v_mfma_f32_16x16x32_bf16 v[100:103], v[180:183], a[32:35], v[100:103]
  ds_read_b64_tr_b16 v[164:165], v9 offset:24576
  ds_read_b64_tr_b16 v[166:167], v9 offset:26624
  v_mfma_f32_16x16x32_bf16 v[108:111], v[180:183], a[36:39], v[108:111]
  v_and_b32 v27, s33, v210
  v_lshlrev_b32 v24, 16, v194
  v_mfma_f32_16x16x32_bf16 v[116:119], v[180:183], a[40:43], v[116:119]
  v_and_b32 v26, s33, v194
  v_mul_f32 v24, v24, v25
  v_mfma_f32_16x16x32_bf16 v[124:127], v[180:183], a[44:47], v[124:127]
  v_mul_f32 v26, v26, v27
  s_waitcnt lgkmcnt(7)
  v_mfma_f32_16x16x32_bf16 v[96:99], v[184:187], a[48:51], v[96:99]
  ds_read_b64_tr_b16 v[168:169], v8 offset:28672
  ds_read_b64_tr_b16 v[170:171], v8 offset:30720
  v_mfma_f32_16x16x32_bf16 v[104:107], v[184:187], a[52:55], v[104:107]
  v_cvt_pk_bf16_f32 v194, v24, v26
  v_pk_max_i16 v195, v195, 0
  v_mfma_f32_16x16x32_bf16 v[112:115], v[184:187], a[56:59], v[112:115]
  v_lshlrev_b32 v29, 16, v211
  v_and_b32 v31, s33, v211
  v_mfma_f32_16x16x32_bf16 v[120:123], v[184:187], a[60:63], v[120:123]
  v_lshlrev_b32 v28, 16, v195
  s_waitcnt lgkmcnt(7)
  v_mfma_f32_16x16x32_bf16 v[100:103], v[188:191], a[48:51], v[100:103]
  ds_read_b64_tr_b16 v[172:173], v9 offset:28672
  ds_read_b64_tr_b16 v[174:175], v9 offset:30720
  v_mfma_f32_16x16x32_bf16 v[108:111], v[188:191], a[52:55], v[108:111]
  v_and_b32 v30, s33, v195
  v_mul_f32 v28, v28, v29
  v_mfma_f32_16x16x32_bf16 v[116:119], v[188:191], a[56:59], v[116:119]
  v_mul_f32 v30, v30, v31
  v_cvt_pk_bf16_f32 v195, v28, v30
  v_mfma_f32_16x16x32_bf16 v[124:127], v[188:191], a[60:63], v[124:127]
  ds_write_b64 v21, v[194:195] offset:25600
  s_waitcnt lgkmcnt(8)
  v_mfma_f32_16x16x32_bf16 v[96:99], v[160:163], a[64:67], v[96:99]
  s_waitcnt vmcnt(18)
  s_waitcnt lgkmcnt(0)
  s_barrier
  ds_read_b64_tr_b16 v[176:177], v10 offset:40960
  ds_read_b64_tr_b16 v[178:179], v10 offset:43008
  v_mfma_f32_16x16x32_bf16 v[104:107], v[160:163], a[68:71], v[104:107]
  s_add_u32 m0, s32, 73728
  ds_read_b128 a[96:99], v19 offset:8192
  v_mfma_f32_16x16x32_bf16 v[112:115], v[160:163], a[72:75], v[112:115]
  buffer_load_dwordx4 v4, s[20:23], s85 offen offset:0 lds
  ds_read_b128 a[100:103], v19 offset:9216
  v_mfma_f32_16x16x32_bf16 v[120:123], v[160:163], a[76:79], v[120:123]
  ds_read_b128 a[104:107], v19 offset:10240
  v_mfma_f32_16x16x32_bf16 v[100:103], v[164:167], a[64:67], v[100:103]
  ds_read_b64_tr_b16 v[180:181], v11 offset:40960
  ds_read_b64_tr_b16 v[182:183], v11 offset:43008
  v_mfma_f32_16x16x32_bf16 v[108:111], v[164:167], a[68:71], v[108:111]
  s_add_u32 m0, s32, 77696
  ds_read_b128 a[108:111], v19 offset:11264
  v_mfma_f32_16x16x32_bf16 v[116:119], v[164:167], a[72:75], v[116:119]
  buffer_load_dwordx4 v4, s[20:23], s85 offen offset:128 lds
  ds_read_b128 a[112:115], v19 offset:16384
  v_mfma_f32_16x16x32_bf16 v[124:127], v[164:167], a[76:79], v[124:127]
  ds_read_b128 a[116:119], v19 offset:17408
  v_mfma_f32_16x16x32_bf16 v[96:99], v[168:171], a[80:83], v[96:99]
  ds_read_b64_tr_b16 v[184:185], v10 offset:45056
  ds_read_b64_tr_b16 v[186:187], v10 offset:47104
  v_mfma_f32_16x16x32_bf16 v[104:107], v[168:171], a[84:87], v[104:107]
  s_add_u32 s47, s37, 24576
  s_add_u32 m0, s32, 16384
  v_mfma_f32_16x16x32_bf16 v[112:115], v[168:171], a[88:91], v[112:115]
  buffer_load_dwordx4 v5, s[8:11], s47 offen offset:0 sc1 lds
  ds_read_b128 a[120:123], v19 offset:18432
  v_mfma_f32_16x16x32_bf16 v[120:123], v[168:171], a[92:95], v[120:123]
  ds_read_b128 a[124:127], v19 offset:19456
  v_mfma_f32_16x16x32_bf16 v[100:103], v[172:175], a[80:83], v[100:103]
  ds_read_b64_tr_b16 v[188:189], v11 offset:45056
  ds_read_b64_tr_b16 v[190:191], v11 offset:47104
  v_mfma_f32_16x16x32_bf16 v[108:111], v[172:175], a[84:87], v[108:111]
  s_add_u32 s47, s37, 28672
  s_add_u32 m0, s32, 20480
  v_mfma_f32_16x16x32_bf16 v[116:119], v[172:175], a[88:91], v[116:119]
  buffer_load_dwordx4 v5, s[8:11], s47 offen offset:0 sc1 lds
  buffer_store_dwordx4 v[192:195], v5, s[8:11], s38 offen offset:0 sc1
  v_mfma_f32_16x16x32_bf16 v[124:127], v[172:175], a[92:95], v[124:127]
  v_pk_max_i16 v196, v196, 0
  s_waitcnt lgkmcnt(14)
  v_mfma_f32_16x16x32_bf16 v[32:35], v[176:179], a[0:3], 0
  ds_read_b64_tr_b16 v[160:161], v10 offset:49152
  ds_read_b64_tr_b16 v[162:163], v10 offset:51200
  v_mfma_f32_16x16x32_bf16 v[40:43], v[176:179], a[4:7], 0
  s_add_u32 m0, s32, 89856
  v_lshlrev_b32 v25, 16, v212
  v_mfma_f32_16x16x32_bf16 v[48:51], v[176:179], a[8:11], 0
  buffer_load_dwordx4 v4, s[20:23], s85 offen offset:256 lds
  v_and_b32 v27, s33, v212
  v_mfma_f32_16x16x32_bf16 v[56:59], v[176:179], a[12:15], 0
  v_lshlrev_b32 v24, 16, v196
  s_waitcnt lgkmcnt(11)
  v_mfma_f32_16x16x32_bf16 v[36:39], v[180:183], a[0:3], 0
  ds_read_b64_tr_b16 v[164:165], v11 offset:49152
  ds_read_b64_tr_b16 v[166:167], v11 offset:51200
  v_mfma_f32_16x16x32_bf16 v[44:47], v[180:183], a[4:7], 0
  s_add_u32 m0, s32, 94208
  v_and_b32 v26, s33, v196
  v_mfma_f32_16x16x32_bf16 v[52:55], v[180:183], a[8:11], 0
  buffer_load_dwordx4 v4, s[20:23], s43 offen offset:0 lds
  v_mul_f32 v24, v24, v25
  v_mfma_f32_16x16x32_bf16 v[60:63], v[180:183], a[12:15], 0
  v_mul_f32 v26, v26, v27
  s_waitcnt lgkmcnt(8)
  v_mfma_f32_16x16x32_bf16 v[32:35], v[184:187], a[16:19], v[32:35]
  ds_read_b64_tr_b16 v[168:169], v10 offset:53248
  ds_read_b64_tr_b16 v[170:171], v10 offset:55296
  v_mfma_f32_16x16x32_bf16 v[40:43], v[184:187], a[20:23], v[40:43]
  s_add_u32 m0, s32, 98176
  v_cvt_pk_bf16_f32 v196, v24, v26
  v_mfma_f32_16x16x32_bf16 v[48:51], v[184:187], a[24:27], v[48:51]
  buffer_load_dwordx4 v4, s[20:23], s43 offen offset:128 lds
  v_pk_max_i16 v197, v197, 0
  v_mfma_f32_16x16x32_bf16 v[56:59], v[184:187], a[28:31], v[56:59]
  v_lshlrev_b32 v29, 16, v213
  s_waitcnt lgkmcnt(6)
  v_mfma_f32_16x16x32_bf16 v[36:39], v[188:191], a[16:19], v[36:39]
  ds_read_b64_tr_b16 v[172:173], v11 offset:53248
  ds_read_b64_tr_b16 v[174:175], v11 offset:55296
  v_mfma_f32_16x16x32_bf16 v[44:47], v[188:191], a[20:23], v[44:47]
  v_and_b32 v31, s33, v213
  v_lshlrev_b32 v28, 16, v197
  v_mfma_f32_16x16x32_bf16 v[52:55], v[188:191], a[24:27], v[52:55]
  v_and_b32 v30, s33, v197
  v_mul_f32 v28, v28, v29
  v_mfma_f32_16x16x32_bf16 v[60:63], v[188:191], a[28:31], v[60:63]
  v_mul_f32 v30, v30, v31
  s_waitcnt lgkmcnt(6)
  v_mfma_f32_16x16x32_bf16 v[32:35], v[160:163], a[32:35], v[32:35]
  ds_read_b64_tr_b16 v[176:177], v10 offset:57344
  ds_read_b64_tr_b16 v[178:179], v10 offset:59392
  v_mfma_f32_16x16x32_bf16 v[40:43], v[160:163], a[36:39], v[40:43]
  v_cvt_pk_bf16_f32 v197, v28, v30
  ds_write_b64 v21, v[196:197] offset:26624
  v_mfma_f32_16x16x32_bf16 v[48:51], v[160:163], a[40:43], v[48:51]
  ds_read_b128 a[144:147], v19 offset:0
  v_pk_max_i16 v198, v198, 0
  v_mfma_f32_16x16x32_bf16 v[56:59], v[160:163], a[44:47], v[56:59]
  v_lshlrev_b32 v25, 16, v214
  s_waitcnt lgkmcnt(8)
  v_mfma_f32_16x16x32_bf16 v[36:39], v[164:167], a[32:35], v[36:39]
  ds_read_b64_tr_b16 v[180:181], v11 offset:57344
  ds_read_b64_tr_b16 v[182:183], v11 offset:59392
  v_mfma_f32_16x16x32_bf16 v[44:47], v[164:167], a[36:39], v[44:47]
  v_and_b32 v27, s33, v214
  v_lshlrev_b32 v24, 16, v198
  v_mfma_f32_16x16x32_bf16 v[52:55], v[164:167], a[40:43], v[52:55]
  ds_read_b128 a[148:151], v19 offset:1024
  v_and_b32 v26, s33, v198
  v_mfma_f32_16x16x32_bf16 v[60:63], v[164:167], a[44:47], v[60:63]
  v_mul_f32 v24, v24, v25
  s_waitcnt lgkmcnt(9)
  v_mfma_f32_16x16x32_bf16 v[32:35], v[168:171], a[48:51], v[32:35]
  ds_read_b64_tr_b16 v[184:185], v10 offset:61440
  ds_read_b64_tr_b16 v[186:187], v10 offset:63488
  v_mfma_f32_16x16x32_bf16 v[40:43], v[168:171], a[52:55], v[40:43]
  v_mul_f32 v26, v26, v27
  v_cvt_pk_bf16_f32 v198, v24, v26
  v_mfma_f32_16x16x32_bf16 v[48:51], v[168:171], a[56:59], v[48:51]
  ds_read_b128 a[152:155], v19 offset:2048
  v_pk_max_i16 v199, v199, 0
  v_mfma_f32_16x16x32_bf16 v[56:59], v[168:171], a[60:63], v[56:59]
  v_lshlrev_b32 v29, 16, v215
  s_waitcnt lgkmcnt(10)
  v_mfma_f32_16x16x32_bf16 v[36:39], v[172:175], a[48:51], v[36:39]
  ds_read_b64_tr_b16 v[188:189], v11 offset:61440
  ds_read_b64_tr_b16 v[190:191], v11 offset:63488
  v_mfma_f32_16x16x32_bf16 v[44:47], v[172:175], a[52:55], v[44:47]
  v_and_b32 v31, s33, v215
  v_lshlrev_b32 v28, 16, v199
  v_mfma_f32_16x16x32_bf16 v[52:55], v[172:175], a[56:59], v[52:55]
  ds_read_b128 a[156:159], v19 offset:3072
  v_and_b32 v30, s33, v199
  v_mfma_f32_16x16x32_bf16 v[60:63], v[172:175], a[60:63], v[60:63]
  v_mul_f32 v28, v28, v29
  s_waitcnt lgkmcnt(11)
  v_mfma_f32_16x16x32_bf16 v[32:35], v[176:179], a[64:67], v[32:35]
  s_waitcnt vmcnt(15)
  s_waitcnt lgkmcnt(10)
  s_waitcnt vmcnt(10)
  v_mov_b32 v1, 1
  s_barrier
  buffer_store_dword v1, v7, s[8:11], 0 offen sc1
  ds_read_b64_tr_b16 v[160:161], v10 offset:16384
  ds_read_b64_tr_b16 v[162:163], v10 offset:18432
  v_mfma_f32_16x16x32_bf16 v[40:43], v[176:179], a[68:71], v[40:43]
  s_add_u32 s47, s37, 32768
  s_add_u32 m0, s32, 24576
  v_mfma_f32_16x16x32_bf16 v[48:51], v[176:179], a[72:75], v[48:51]
  buffer_load_dwordx4 v5, s[8:11], s47 offen offset:0 sc1 lds
  v_mul_f32 v30, v30, v31
  v_mfma_f32_16x16x32_bf16 v[56:59], v[176:179], a[76:79], v[56:59]
  v_cvt_pk_bf16_f32 v199, v28, v30
  s_waitcnt lgkmcnt(9)
  v_mfma_f32_16x16x32_bf16 v[36:39], v[180:183], a[64:67], v[36:39]
  ds_read_b64_tr_b16 v[164:165], v11 offset:16384
  ds_read_b64_tr_b16 v[166:167], v11 offset:18432
  v_mfma_f32_16x16x32_bf16 v[44:47], v[180:183], a[68:71], v[44:47]
  s_add_u32 s47, s37, 36864
  s_add_u32 m0, s32, 28672
  v_mfma_f32_16x16x32_bf16 v[52:55], v[180:183], a[72:75], v[52:55]
  buffer_load_dwordx4 v5, s[8:11], s47 offen offset:0 sc1 lds
  ds_write_b64 v21, v[198:199] offset:27648
  v_mfma_f32_16x16x32_bf16 v[60:63], v[180:183], a[76:79], v[60:63]
  buffer_store_dwordx4 v[196:199], v5, s[8:11], s38 offen offset:1024 sc1
  s_waitcnt lgkmcnt(9)
  v_mfma_f32_16x16x32_bf16 v[32:35], v[184:187], a[80:83], v[32:35]
  ds_read_b64_tr_b16 v[168:169], v10 offset:20480
  ds_read_b64_tr_b16 v[170:171], v10 offset:22528
  v_mfma_f32_16x16x32_bf16 v[40:43], v[184:187], a[84:87], v[40:43]
  s_add_u32 m0, s32, 102144
  v_mfma_f32_16x16x32_bf16 v[48:51], v[184:187], a[88:91], v[48:51]
  buffer_load_dwordx4 v4, s[20:23], s43 offen offset:256 lds
  ds_read_b128 a[160:163], v17 offset:0
  v_mfma_f32_16x16x32_bf16 v[56:59], v[184:187], a[92:95], v[56:59]
  s_waitcnt lgkmcnt(9)
  v_mfma_f32_16x16x32_bf16 v[36:39], v[188:191], a[80:83], v[36:39]
  ds_read_b64_tr_b16 v[172:173], v11 offset:20480
  ds_read_b64_tr_b16 v[174:175], v11 offset:22528
  v_mfma_f32_16x16x32_bf16 v[44:47], v[188:191], a[84:87], v[44:47]
  s_add_u32 m0, s32, 106496
  v_mfma_f32_16x16x32_bf16 v[52:55], v[188:191], a[88:91], v[52:55]
  buffer_load_dwordx4 v4, s[20:23], s44 offen offset:0 lds
  ds_read_b128 a[164:167], v17 offset:1024
  v_mfma_f32_16x16x32_bf16 v[60:63], v[188:191], a[92:95], v[60:63]
  s_waitcnt lgkmcnt(9)
  v_mfma_f32_16x16x32_bf16 v[64:67], v[160:163], a[144:147], v[64:67]
  ds_read_b64_tr_b16 v[176:177], v8 offset:32768
  ds_read_b64_tr_b16 v[178:179], v8 offset:34816
  v_mfma_f32_16x16x32_bf16 v[72:75], v[160:163], a[148:151], v[72:75]
  s_add_u32 m0, s32, 110464
  v_mfma_f32_16x16x32_bf16 v[80:83], v[160:163], a[152:155], v[80:83]
  buffer_load_dwordx4 v4, s[20:23], s44 offen offset:128 lds
  ds_read_b128 a[168:171], v17 offset:2048
  v_mfma_f32_16x16x32_bf16 v[88:91], v[160:163], a[156:159], v[88:91]
  s_waitcnt lgkmcnt(10)
  v_mfma_f32_16x16x32_bf16 v[68:71], v[164:167], a[144:147], v[68:71]
  ds_read_b64_tr_b16 v[180:181], v9 offset:32768
  ds_read_b64_tr_b16 v[182:183], v9 offset:34816
  v_mfma_f32_16x16x32_bf16 v[76:79], v[164:167], a[148:151], v[76:79]
  s_add_u32 s47, s37, 40960
  s_add_u32 m0, s32, 114688
  v_mfma_f32_16x16x32_bf16 v[84:87], v[164:167], a[152:155], v[84:87]
  buffer_load_dwordx4 v5, s[8:11], s47 offen offset:0 sc1 lds
  ds_read_b128 a[172:175], v17 offset:3072
  v_mfma_f32_16x16x32_bf16 v[92:95], v[164:167], a[156:159], v[92:95]
  s_waitcnt lgkmcnt(10)
  v_mfma_f32_16x16x32_bf16 v[96:99], v[168:171], a[144:147], v[96:99]
  ds_read_b64_tr_b16 v[184:185], v8 offset:36864
  ds_read_b64_tr_b16 v[186:187], v8 offset:38912
  v_mfma_f32_16x16x32_bf16 v[104:107], v[168:171], a[148:151], v[104:107]
  s_add_u32 s47, s37, 45056
  s_add_u32 m0, s32, 118784
  v_mfma_f32_16x16x32_bf16 v[112:115], v[168:171], a[152:155], v[112:115]
  buffer_load_dwordx4 v5, s[8:11], s47 offen offset:0 sc1 lds
  v_mfma_f32_16x16x32_bf16 v[120:123], v[168:171], a[156:159], v[120:123]
  s_waitcnt lgkmcnt(9)
  v_mfma_f32_16x16x32_bf16 v[100:103], v[172:175], a[144:147], v[100:103]
  ds_read_b64_tr_b16 v[188:189], v9 offset:36864
  ds_read_b64_tr_b16 v[190:191], v9 offset:38912
  v_mfma_f32_16x16x32_bf16 v[108:111], v[172:175], a[148:151], v[108:111]
  v_mfma_f32_16x16x32_bf16 v[116:119], v[172:175], a[152:155], v[116:119]
  v_mfma_f32_16x16x32_bf16 v[124:127], v[172:175], a[156:159], v[124:127]
  s_waitcnt lgkmcnt(8)
  v_mfma_f32_16x16x32_bf16 v[32:35], v[176:179], a[144:147], v[32:35]
  ds_read_b64_tr_b16 v[160:161], v8 offset:40960
  ds_read_b64_tr_b16 v[162:163], v8 offset:43008
  v_mfma_f32_16x16x32_bf16 v[40:43], v[176:179], a[148:151], v[40:43]
  v_mfma_f32_16x16x32_bf16 v[48:51], v[176:179], a[152:155], v[48:51]
  ds_read_b128 a[176:179], v17 offset:49152
  v_mfma_f32_16x16x32_bf16 v[56:59], v[176:179], a[156:159], v[56:59]
  s_waitcnt lgkmcnt(8)
  v_mfma_f32_16x16x32_bf16 v[36:39], v[180:183], a[144:147], v[36:39]
  ds_read_b64_tr_b16 v[164:165], v9 offset:40960
  ds_read_b64_tr_b16 v[166:167], v9 offset:43008
  v_mfma_f32_16x16x32_bf16 v[44:47], v[180:183], a[148:151], v[44:47]
  v_mfma_f32_16x16x32_bf16 v[52:55], v[180:183], a[152:155], v[52:55]
  ds_read_b128 a[180:183], v17 offset:50176
  v_mfma_f32_16x16x32_bf16 v[60:63], v[180:183], a[156:159], v[60:63]
  s_waitcnt lgkmcnt(8)
  v_mfma_f32_16x16x32_bf16 v[64:67], v[184:187], a[160:163], v[64:67]
  ds_read_b64_tr_b16 v[168:169], v8 offset:45056
  ds_read_b64_tr_b16 v[170:171], v8 offset:47104
  v_mfma_f32_16x16x32_bf16 v[72:75], v[184:187], a[164:167], v[72:75]
  v_mfma_f32_16x16x32_bf16 v[80:83], v[184:187], a[168:171], v[80:83]
  ds_read_b128 a[184:187], v17 offset:51200
  v_mfma_f32_16x16x32_bf16 v[88:91], v[184:187], a[172:175], v[88:91]
  s_waitcnt lgkmcnt(9)
  v_mfma_f32_16x16x32_bf16 v[68:71], v[188:191], a[160:163], v[68:71]
  ds_read_b64_tr_b16 v[172:173], v9 offset:45056
  ds_read_b64_tr_b16 v[174:175], v9 offset:47104
  v_mfma_f32_16x16x32_bf16 v[76:79], v[188:191], a[164:167], v[76:79]
  v_mfma_f32_16x16x32_bf16 v[84:87], v[188:191], a[168:171], v[84:87]
  ds_read_b128 a[188:191], v17 offset:52224
  v_mfma_f32_16x16x32_bf16 v[92:95], v[188:191], a[172:175], v[92:95]
  buffer_load_dword v23, off, s[8:11], s59 sc1
  s_waitcnt lgkmcnt(10)
  v_mfma_f32_16x16x32_bf16 v[96:99], v[160:163], a[160:163], v[96:99]
  s_waitcnt vmcnt(18)
  s_barrier
  ds_read_b64_tr_b16 v[176:177], v8 offset:57344
  ds_read_b64_tr_b16 v[178:179], v8 offset:59392
  v_mfma_f32_16x16x32_bf16 v[104:107], v[160:163], a[164:167], v[104:107]
  s_add_u32 m0, s32, 139008
  ds_read_b128 a[128:131], v19 offset:24576
  v_mfma_f32_16x16x32_bf16 v[112:115], v[160:163], a[168:171], v[112:115]
  buffer_load_dwordx4 v4, s[20:23], s44 offen offset:256 lds
  ds_read_b128 a[132:135], v19 offset:25600
  v_mfma_f32_16x16x32_bf16 v[120:123], v[160:163], a[172:175], v[120:123]
  ds_read_b128 a[136:139], v19 offset:26624
  s_waitcnt lgkmcnt(12)
  v_mfma_f32_16x16x32_bf16 v[100:103], v[164:167], a[160:163], v[100:103]
  ds_read_b64_tr_b16 v[180:181], v9 offset:57344
  ds_read_b64_tr_b16 v[182:183], v9 offset:59392
  v_mfma_f32_16x16x32_bf16 v[108:111], v[164:167], a[164:167], v[108:111]
  s_add_u32 m0, s32, 143360
  ds_read_b128 a[140:143], v19 offset:27648
  v_mfma_f32_16x16x32_bf16 v[116:119], v[164:167], a[168:171], v[116:119]
  buffer_load_dwordx4 v4, s[20:23], s45 offen offset:0 lds
  v_mfma_f32_16x16x32_bf16 v[124:127], v[164:167], a[172:175], v[124:127]
  s_waitcnt lgkmcnt(12)
  v_mfma_f32_16x16x32_bf16 v[32:35], v[168:171], a[160:163], v[32:35]
  ds_read_b64_tr_b16 v[184:185], v8 offset:61440
  ds_read_b64_tr_b16 v[186:187], v8 offset:63488
  v_mfma_f32_16x16x32_bf16 v[40:43], v[168:171], a[164:167], v[40:43]
  s_add_u32 m0, s32, 147328
  v_mfma_f32_16x16x32_bf16 v[48:51], v[168:171], a[168:171], v[48:51]
  buffer_load_dwordx4 v4, s[20:23], s45 offen offset:128 lds
  v_mfma_f32_16x16x32_bf16 v[56:59], v[168:171], a[172:175], v[56:59]
  s_waitcnt lgkmcnt(11)
  v_mfma_f32_16x16x32_bf16 v[36:39], v[172:175], a[160:163], v[36:39]
  ds_read_b64_tr_b16 v[188:189], v9 offset:61440
  ds_read_b64_tr_b16 v[190:191], v9 offset:63488
  v_mfma_f32_16x16x32_bf16 v[44:47], v[172:175], a[164:167], v[44:47]
  s_add_u32 m0, s32, 151296
  v_mfma_f32_16x16x32_bf16 v[52:55], v[172:175], a[168:171], v[52:55]
  buffer_load_dwordx4 v4, s[20:23], s45 offen offset:256 lds
  v_mfma_f32_16x16x32_bf16 v[60:63], v[172:175], a[172:175], v[60:63]
  s_waitcnt lgkmcnt(10)
  v_mfma_f32_16x16x32_bf16 v[64:67], v[176:179], a[176:179], v[64:67]
  ds_read_b64_tr_b16 v[160:161], v8 offset:8192
  ds_read_b64_tr_b16 v[162:163], v8 offset:10240
  v_mfma_f32_16x16x32_bf16 v[72:75], v[176:179], a[180:183], v[72:75]
  s_add_u32 m0, s32, 0
  v_mfma_f32_16x16x32_bf16 v[80:83], v[176:179], a[184:187], v[80:83]
  buffer_load_dwordx4 v4, s[20:23], s86 offen offset:0 lds
  v_mfma_f32_16x16x32_bf16 v[88:91], v[176:179], a[188:191], v[88:91]
  s_waitcnt lgkmcnt(7)
  v_mfma_f32_16x16x32_bf16 v[68:71], v[180:183], a[176:179], v[68:71]
  ds_read_b64_tr_b16 v[164:165], v9 offset:8192
  ds_read_b64_tr_b16 v[166:167], v9 offset:10240
  v_mfma_f32_16x16x32_bf16 v[76:79], v[180:183], a[180:183], v[76:79]
  s_add_u32 m0, s32, 3968
  v_mfma_f32_16x16x32_bf16 v[84:87], v[180:183], a[184:187], v[84:87]
  buffer_load_dwordx4 v4, s[20:23], s86 offen offset:128 lds
  v_mfma_f32_16x16x32_bf16 v[92:95], v[180:183], a[188:191], v[92:95]
  s_waitcnt lgkmcnt(6)
  v_mfma_f32_16x16x32_bf16 v[96:99], v[184:187], a[176:179], v[96:99]
  ds_read_b64_tr_b16 v[168:169], v8 offset:12288
  ds_read_b64_tr_b16 v[170:171], v8 offset:14336
  v_mfma_f32_16x16x32_bf16 v[104:107], v[184:187], a[180:183], v[104:107]
  s_add_u32 m0, s32, 32512
  v_mfma_f32_16x16x32_bf16 v[112:115], v[184:187], a[184:187], v[112:115]
  buffer_load_dwordx4 v4, s[20:23], s86 offen offset:256 lds
  v_mfma_f32_16x16x32_bf16 v[120:123], v[184:187], a[188:191], v[120:123]
  s_waitcnt lgkmcnt(6)
  v_mfma_f32_16x16x32_bf16 v[100:103], v[188:191], a[176:179], v[100:103]
  ds_read_b64_tr_b16 v[172:173], v9 offset:12288
  ds_read_b64_tr_b16 v[174:175], v9 offset:14336
  v_mfma_f32_16x16x32_bf16 v[108:111], v[188:191], a[180:183], v[108:111]
  s_add_u32 s47, s34, 0
  s_add_u32 m0, s32, 36864
  v_mfma_f32_16x16x32_bf16 v[116:119], v[188:191], a[184:187], v[116:119]
  buffer_load_dwordx4 v22, s[20:23], s47 offen offset:0 lds
  v_mfma_f32_16x16x32_bf16 v[124:127], v[188:191], a[188:191], v[124:127]
  s_waitcnt lgkmcnt(6)
  v_mfma_f32_16x16x32_bf16 v[32:35], v[160:163], a[176:179], v[32:35]
  ds_read_b64_tr_b16 v[176:177], v10 offset:0
  ds_read_b64_tr_b16 v[178:179], v10 offset:2048
  v_mfma_f32_16x16x32_bf16 v[40:43], v[160:163], a[180:183], v[40:43]
  s_add_u32 s47, s34, 36864
  s_add_u32 m0, s32, 81920
  v_mfma_f32_16x16x32_bf16 v[48:51], v[160:163], a[184:187], v[48:51]
  buffer_load_dwordx4 v22, s[20:23], s47 offen offset:0 lds
  v_mfma_f32_16x16x32_bf16 v[56:59], v[160:163], a[188:191], v[56:59]
  s_waitcnt lgkmcnt(6)
  v_mfma_f32_16x16x32_bf16 v[36:39], v[164:167], a[176:179], v[36:39]
  ds_read_b64_tr_b16 v[180:181], v11 offset:0
  ds_read_b64_tr_b16 v[182:183], v11 offset:2048
  v_mfma_f32_16x16x32_bf16 v[44:47], v[164:167], a[180:183], v[44:47]
  s_add_u32 s47, s34, 73728
  s_add_u32 m0, s32, 86016
  v_mfma_f32_16x16x32_bf16 v[52:55], v[164:167], a[184:187], v[52:55]
  buffer_load_dwordx4 v22, s[20:23], s47 offen offset:0 lds
  v_mfma_f32_16x16x32_bf16 v[60:63], v[164:167], a[188:191], v[60:63]
  s_waitcnt vmcnt(10)
  v_readfirstlane_b32 s30, v23
  s_nop 0
  s_cmp_ge_i32 s30, 1
  s_cbranch_scc0 slow_31
back_32:
  s_waitcnt lgkmcnt(6)
  v_mfma_f32_16x16x32_bf16 v[64:67], v[168:171], a[96:99], v[64:67]
  ds_read_b64_tr_b16 v[184:185], v10 offset:4096
  ds_read_b64_tr_b16 v[186:187], v10 offset:6144
  v_mfma_f32_16x16x32_bf16 v[72:75], v[168:171], a[100:103], v[72:75]
  v_mfma_f32_16x16x32_bf16 v[80:83], v[168:171], a[104:107], v[80:83]
  v_mfma_f32_16x16x32_bf16 v[88:91], v[168:171], a[108:111], v[88:91]
  s_waitcnt lgkmcnt(6)
  v_mfma_f32_16x16x32_bf16 v[68:71], v[172:175], a[96:99], v[68:71]
  ds_read_b64_tr_b16 v[188:189], v11 offset:4096
  ds_read_b64_tr_b16 v[190:191], v11 offset:6144
  v_mfma_f32_16x16x32_bf16 v[76:79], v[172:175], a[100:103], v[76:79]
  v_mfma_f32_16x16x32_bf16 v[84:87], v[172:175], a[104:107], v[84:87]
  v_mfma_f32_16x16x32_bf16 v[92:95], v[172:175], a[108:111], v[92:95]
  s_waitcnt lgkmcnt(6)
  v_mfma_f32_16x16x32_bf16 v[96:99], v[176:179], a[96:99], v[96:99]
  v_mov_b32 v1, 2
  s_barrier
  buffer_store_dword v1, v7, s[8:11], 0 offen sc1
  ds_read_b64_tr_b16 v[160:161], v10 offset:8192
  ds_read_b64_tr_b16 v[162:163], v10 offset:10240
  v_mfma_f32_16x16x32_bf16 v[104:107], v[176:179], a[100:103], v[104:107]
  s_add_u32 s47, s34, 110592
  s_add_u32 m0, s32, 122880
  v_mfma_f32_16x16x32_bf16 v[112:115], v[176:179], a[104:107], v[112:115]
  buffer_load_dwordx4 v22, s[20:23], s47 offen offset:0 lds
  v_mfma_f32_16x16x32_bf16 v[120:123], v[176:179], a[108:111], v[120:123]
  s_waitcnt lgkmcnt(6)
  v_mfma_f32_16x16x32_bf16 v[100:103], v[180:183], a[96:99], v[100:103]
  ds_read_b64_tr_b16 v[164:165], v11 offset:8192
  ds_read_b64_tr_b16 v[166:167], v11 offset:10240
  v_mfma_f32_16x16x32_bf16 v[108:111], v[180:183], a[100:103], v[108:111]
  s_add_u32 s47, s37, 49152
  s_add_u32 m0, s32, 131072
  v_mfma_f32_16x16x32_bf16 v[116:119], v[180:183], a[104:107], v[116:119]
  buffer_load_dwordx4 v5, s[8:11], s47 offen offset:0 sc1 lds
  v_mfma_f32_16x16x32_bf16 v[124:127], v[180:183], a[108:111], v[124:127]
  s_waitcnt lgkmcnt(6)
  v_mfma_f32_16x16x32_bf16 v[32:35], v[184:187], a[96:99], v[32:35]
  ds_read_b64_tr_b16 v[168:169], v10 offset:12288
  ds_read_b64_tr_b16 v[170:171], v10 offset:14336
  v_mfma_f32_16x16x32_bf16 v[40:43], v[184:187], a[100:103], v[40:43]
  s_add_u32 s47, s37, 53248
  s_add_u32 m0, s32, 135168
  v_mfma_f32_16x16x32_bf16 v[48:51], v[184:187], a[104:107], v[48:51]
  buffer_load_dwordx4 v5, s[8:11], s47 offen offset:0 sc1 lds
  ds_read_b128 a[192:195], v17 offset:16384
  v_mfma_f32_16x16x32_bf16 v[56:59], v[184:187], a[108:111], v[56:59]
  s_waitcnt lgkmcnt(7)
  v_mfma_f32_16x16x32_bf16 v[36:39], v[188:191], a[96:99], v[36:39]
  ds_read_b64_tr_b16 v[172:173], v11 offset:12288
  ds_read_b64_tr_b16 v[174:175], v11 offset:14336
  v_mfma_f32_16x16x32_bf16 v[44:47], v[188:191], a[100:103], v[44:47]
  s_add_u32 s47, s34, 147456
  s_add_u32 m0, s32, 126976
  v_mfma_f32_16x16x32_bf16 v[52:55], v[188:191], a[104:107], v[52:55]
  buffer_load_dwordx4 v22, s[20:23], s47 offen offset:0 lds
  ds_read_b128 a[196:199], v17 offset:17408
  v_mfma_f32_16x16x32_bf16 v[60:63], v[188:191], a[108:111], v[60:63]
  s_waitcnt lgkmcnt(8)
  v_mfma_f32_16x16x32_bf16 v[64:67], v[160:163], a[112:115], v[64:67]
  ds_read_b64_tr_b16 v[176:177], v10 offset:24576
  ds_read_b64_tr_b16 v[178:179], v10 offset:26624
  v_mfma_f32_16x16x32_bf16 v[72:75], v[160:163], a[116:119], v[72:75]
  s_add_u32 s47, s34, 184320
  s_add_u32 m0, s32, 8192
  v_mfma_f32_16x16x32_bf16 v[80:83], v[160:163], a[120:123], v[80:83]
  buffer_load_dwordx4 v22, s[20:23], s47 offen offset:0 lds
  ds_read_b128 a[200:203], v17 offset:18432
  v_mfma_f32_16x16x32_bf16 v[88:91], v[160:163], a[124:127], v[88:91]
  s_waitcnt lgkmcnt(9)
  v_mfma_f32_16x16x32_bf16 v[68:71], v[164:167], a[112:115], v[68:71]
  ds_read_b64_tr_b16 v[180:181], v11 offset:24576
  ds_read_b64_tr_b16 v[182:183], v11 offset:26624
  v_mfma_f32_16x16x32_bf16 v[76:79], v[164:167], a[116:119], v[76:79]
  s_add_u32 s47, s37, 57344
  s_add_u32 m0, s32, 40960
  v_mfma_f32_16x16x32_bf16 v[84:87], v[164:167], a[120:123], v[84:87]
  buffer_load_dwordx4 v5, s[8:11], s47 offen offset:0 sc1 lds
  ds_read_b128 a[204:207], v17 offset:19456
  v_mfma_f32_16x16x32_bf16 v[92:95], v[164:167], a[124:127], v[92:95]
  s_waitcnt lgkmcnt(10)
  v_mfma_f32_16x16x32_bf16 v[96:99], v[168:171], a[112:115], v[96:99]
  ds_read_b64_tr_b16 v[184:185], v10 offset:28672
  ds_read_b64_tr_b16 v[186:187], v10 offset:30720
  v_mfma_f32_16x16x32_bf16 v[104:107], v[168:171], a[116:119], v[104:107]
  s_add_u32 s47, s37, 61440
  s_add_u32 m0, s32, 45056
  v_mfma_f32_16x16x32_bf16 v[112:115], v[168:171], a[120:123], v[112:115]
  buffer_load_dwordx4 v5, s[8:11], s47 offen offset:0 sc1 lds
  v_mfma_f32_16x16x32_bf16 v[120:123], v[168:171], a[124:127], v[120:123]
  s_waitcnt lgkmcnt(9)
  v_mfma_f32_16x16x32_bf16 v[100:103], v[172:175], a[112:115], v[100:103]
  ds_read_b64_tr_b16 v[188:189], v11 offset:28672
  ds_read_b64_tr_b16 v[190:191], v11 offset:30720
  v_mfma_f32_16x16x32_bf16 v[108:111], v[172:175], a[116:119], v[108:111]
  s_add_u32 m0, s32, 12288
  v_mfma_f32_16x16x32_bf16 v[116:119], v[172:175], a[120:123], v[116:119]
  buffer_load_dwordx4 v4, s[20:23], s48 offen offset:0 lds
  v_mfma_f32_16x16x32_bf16 v[124:127], v[172:175], a[124:127], v[124:127]
  s_waitcnt lgkmcnt(8)
  v_mfma_f32_16x16x32_bf16 v[32:35], v[176:179], a[112:115], v[32:35]
  ds_read_b64_tr_b16 v[160:161], v10 offset:32768
  ds_read_b64_tr_b16 v[162:163], v10 offset:34816
  v_mfma_f32_16x16x32_bf16 v[40:43], v[176:179], a[116:119], v[40:43]
  s_add_u32 m0, s32, 49152
  v_mfma_f32_16x16x32_bf16 v[48:51], v[176:179], a[120:123], v[48:51]
  buffer_load_dwordx4 v4, s[20:23], s49 offen offset:0 lds
  ds_read_b128 a[208:211], v17 offset:24576
  v_mfma_f32_16x16x32_bf16 v[56:59], v[176:179], a[124:127], v[56:59]
  s_waitcnt lgkmcnt(8)
  v_mfma_f32_16x16x32_bf16 v[36:39], v[180:183], a[112:115], v[36:39]
  ds_read_b64_tr_b16 v[164:165], v11 offset:32768
  ds_read_b64_tr_b16 v[166:167], v11 offset:34816
  v_mfma_f32_16x16x32_bf16 v[44:47], v[180:183], a[116:119], v[44:47]
  s_add_u32 m0, s32, 53120
  v_mfma_f32_16x16x32_bf16 v[52:55], v[180:183], a[120:123], v[52:55]
  buffer_load_dwordx4 v4, s[20:23], s48 offen offset:128 lds
  ds_read_b128 a[212:215], v17 offset:25600
  v_mfma_f32_16x16x32_bf16 v[60:63], v[180:183], a[124:127], v[60:63]
  s_waitcnt lgkmcnt(8)
  v_mfma_f32_16x16x32_bf16 v[64:67], v[184:187], a[192:195], v[64:67]
  ds_read_b64_tr_b16 v[168:169], v10 offset:36864
  ds_read_b64_tr_b16 v[170:171], v10 offset:38912
  v_mfma_f32_16x16x32_bf16 v[72:75], v[184:187], a[196:199], v[72:75]
  v_mfma_f32_16x16x32_bf16 v[80:83], v[184:187], a[200:203], v[80:83]
  ds_read_b128 a[216:219], v17 offset:26624
  v_mfma_f32_16x16x32_bf16 v[88:91], v[184:187], a[204:207], v[88:91]
  s_waitcnt lgkmcnt(9)
  v_mfma_f32_16x16x32_bf16 v[68:71], v[188:191], a[192:195], v[68:71]
  ds_read_b64_tr_b16 v[172:173], v11 offset:36864
  ds_read_b64_tr_b16 v[174:175], v11 offset:38912
  v_mfma_f32_16x16x32_bf16 v[76:79], v[188:191], a[196:199], v[76:79]
  v_mfma_f32_16x16x32_bf16 v[84:87], v[188:191], a[200:203], v[84:87]
  ds_read_b128 a[220:223], v17 offset:27648
  v_mfma_f32_16x16x32_bf16 v[92:95], v[188:191], a[204:207], v[92:95]
  buffer_load_dword v23, off, s[8:11], s59 sc1
  s_waitcnt lgkmcnt(10)
  v_mfma_f32_16x16x32_bf16 v[96:99], v[160:163], a[192:195], v[96:99]
  s_waitcnt vmcnt(18)
  s_barrier
  ds_read_b64_tr_b16 v[176:177], v10 offset:40960
  ds_read_b64_tr_b16 v[178:179], v10 offset:43008
  v_mfma_f32_16x16x32_bf16 v[104:107], v[160:163], a[196:199], v[104:107]
  s_add_u32 m0, s32, 155520
  v_mfma_f32_16x16x32_bf16 v[112:115], v[160:163], a[200:203], v[112:115]
  buffer_load_dwordx4 v4, s[20:23], s49 offen offset:128 lds
  v_mfma_f32_16x16x32_bf16 v[120:123], v[160:163], a[204:207], v[120:123]
  s_waitcnt lgkmcnt(9)
  v_mfma_f32_16x16x32_bf16 v[100:103], v[164:167], a[192:195], v[100:103]
  ds_read_b64_tr_b16 v[180:181], v11 offset:40960
  ds_read_b64_tr_b16 v[182:183], v11 offset:43008
  v_mfma_f32_16x16x32_bf16 v[108:111], v[164:167], a[196:199], v[108:111]
  s_add_u32 m0, s32, 159488
  v_mfma_f32_16x16x32_bf16 v[116:119], v[164:167], a[200:203], v[116:119]
  buffer_load_dwordx4 v4, s[20:23], s48 offen offset:256 lds
  v_mfma_f32_16x16x32_bf16 v[124:127], v[164:167], a[204:207], v[124:127]
  s_waitcnt lgkmcnt(8)
  v_mfma_f32_16x16x32_bf16 v[32:35], v[168:171], a[192:195], v[32:35]
  ds_read_b64_tr_b16 v[184:185], v10 offset:45056
  ds_read_b64_tr_b16 v[186:187], v10 offset:47104
  v_mfma_f32_16x16x32_bf16 v[40:43], v[168:171], a[196:199], v[40:43]
  s_add_u32 m0, s32, 57088
  v_mfma_f32_16x16x32_bf16 v[48:51], v[168:171], a[200:203], v[48:51]
  buffer_load_dwordx4 v4, s[20:23], s49 offen offset:256 lds
  ds_read_b128 a[224:227], v18 offset:49152
  v_mfma_f32_16x16x32_bf16 v[56:59], v[168:171], a[204:207], v[56:59]
  s_waitcnt lgkmcnt(8)
  v_mfma_f32_16x16x32_bf16 v[36:39], v[172:175], a[192:195], v[36:39]
  ds_read_b64_tr_b16 v[188:189], v11 offset:45056
  ds_read_b64_tr_b16 v[190:191], v11 offset:47104
  v_mfma_f32_16x16x32_bf16 v[44:47], v[172:175], a[196:199], v[44:47]
  s_add_u32 s47, s34, 221184
  s_add_u32 m0, s32, 61440
  v_mfma_f32_16x16x32_bf16 v[52:55], v[172:175], a[200:203], v[52:55]
  buffer_load_dwordx4 v22, s[20:23], s47 offen offset:0 lds
  ds_read_b128 a[228:231], v18 offset:50176
  v_mfma_f32_16x16x32_bf16 v[60:63], v[172:175], a[204:207], v[60:63]
  s_waitcnt lgkmcnt(8)
  v_mfma_f32_16x16x32_bf16 v[64:67], v[176:179], a[208:211], v[64:67]
  ds_read_b64_tr_b16 v[160:161], v12 offset:8192
  ds_read_b64_tr_b16 v[162:163], v12 offset:10240
  v_mfma_f32_16x16x32_bf16 v[72:75], v[176:179], a[212:215], v[72:75]
  s_add_u32 s47, s34, 258048
  s_add_u32 m0, s32, 16384
  v_mfma_f32_16x16x32_bf16 v[80:83], v[176:179], a[216:219], v[80:83]
  buffer_load_dwordx4 v22, s[20:23], s47 offen offset:0 lds
  ds_read_b128 a[232:235], v18 offset:51200
  v_mfma_f32_16x16x32_bf16 v[88:91], v[176:179], a[220:223], v[88:91]
  s_waitcnt lgkmcnt(9)
  v_mfma_f32_16x16x32_bf16 v[68:71], v[180:183], a[208:211], v[68:71]
  ds_read_b64_tr_b16 v[164:165], v13 offset:8192
  ds_read_b64_tr_b16 v[166:167], v13 offset:10240
  v_mfma_f32_16x16x32_bf16 v[76:79], v[180:183], a[212:215], v[76:79]
  s_add_u32 m0, s32, 20480
  v_mfma_f32_16x16x32_bf16 v[84:87], v[180:183], a[216:219], v[84:87]
  buffer_load_dwordx4 v4, s[20:23], s50 offen offset:0 lds
  ds_read_b128 a[236:239], v18 offset:52224
  v_mfma_f32_16x16x32_bf16 v[92:95], v[180:183], a[220:223], v[92:95]
  s_waitcnt lgkmcnt(10)
  v_mfma_f32_16x16x32_bf16 v[96:99], v[184:187], a[208:211], v[96:99]
  ds_read_b64_tr_b16 v[168:169], v12 offset:12288
  ds_read_b64_tr_b16 v[170:171], v12 offset:14336
  v_mfma_f32_16x16x32_bf16 v[104:107], v[184:187], a[212:215], v[104:107]
  v_mfma_f32_16x16x32_bf16 v[112:115], v[184:187], a[216:219], v[112:115]
  v_mfma_f32_16x16x32_bf16 v[120:123], v[184:187], a[220:223], v[120:123]
  s_waitcnt lgkmcnt(9)
  v_mfma_f32_16x16x32_bf16 v[100:103], v[188:191], a[208:211], v[100:103]
  ds_read_b64_tr_b16 v[172:173], v13 offset:12288
  ds_read_b64_tr_b16 v[174:175], v13 offset:14336
  v_mfma_f32_16x16x32_bf16 v[108:111], v[188:191], a[212:215], v[108:111]
  v_mfma_f32_16x16x32_bf16 v[116:119], v[188:191], a[216:219], v[116:119]
  v_mfma_f32_16x16x32_bf16 v[124:127], v[188:191], a[220:223], v[124:127]
  s_waitcnt lgkmcnt(8)
  v_mfma_f32_16x16x32_bf16 v[32:35], v[160:163], a[208:211], v[32:35]
  ds_read_b64_tr_b16 v[176:177], v12 offset:16384
  ds_read_b64_tr_b16 v[178:179], v12 offset:18432
  v_mfma_f32_16x16x32_bf16 v[40:43], v[160:163], a[212:215], v[40:43]
  v_mfma_f32_16x16x32_bf16 v[48:51], v[160:163], a[216:219], v[48:51]
  v_mfma_f32_16x16x32_bf16 v[56:59], v[160:163], a[220:223], v[56:59]
  s_waitcnt lgkmcnt(7)
  v_mfma_f32_16x16x32_bf16 v[36:39], v[164:167], a[208:211], v[36:39]
  ds_read_b64_tr_b16 v[180:181], v13 offset:16384
  ds_read_b64_tr_b16 v[182:183], v13 offset:18432
  v_mfma_f32_16x16x32_bf16 v[44:47], v[164:167], a[212:215], v[44:47]
  v_mfma_f32_16x16x32_bf16 v[52:55], v[164:167], a[216:219], v[52:55]
  v_mfma_f32_16x16x32_bf16 v[60:63], v[164:167], a[220:223], v[60:63]
  s_waitcnt vmcnt(6)
  v_readfirstlane_b32 s30, v23
  s_nop 0
  s_cmp_ge_i32 s30, 2
  s_cbranch_scc0 slow_33
back_34:
  s_waitcnt lgkmcnt(6)
  v_mfma_f32_16x16x32_bf16 v[64:67], v[168:171], a[224:227], v[64:67]
  ds_read_b64_tr_b16 v[184:185], v12 offset:20480
  ds_read_b64_tr_b16 v[186:187], v12 offset:22528
  v_mfma_f32_16x16x32_bf16 v[72:75], v[168:171], a[228:231], v[72:75]
  v_mfma_f32_16x16x32_bf16 v[80:83], v[168:171], a[232:235], v[80:83]
  v_mfma_f32_16x16x32_bf16 v[88:91], v[168:171], a[236:239], v[88:91]
  s_waitcnt lgkmcnt(6)
  v_mfma_f32_16x16x32_bf16 v[68:71], v[172:175], a[224:227], v[68:71]
  ds_read_b64_tr_b16 v[188:189], v13 offset:20480
  ds_read_b64_tr_b16 v[190:191], v13 offset:22528
  v_mfma_f32_16x16x32_bf16 v[76:79], v[172:175], a[228:231], v[76:79]
  v_mfma_f32_16x16x32_bf16 v[84:87], v[172:175], a[232:235], v[84:87]
  v_mfma_f32_16x16x32_bf16 v[92:95], v[172:175], a[236:239], v[92:95]
  s_waitcnt lgkmcnt(6)
  v_mfma_f32_16x16x32_bf16 v[96:99], v[176:179], a[224:227], v[96:99]
  s_barrier
  ds_read_b64_tr_b16 v[160:161], v8 offset:0
  ds_read_b64_tr_b16 v[162:163], v8 offset:2048
  v_mfma_f32_16x16x32_bf16 v[104:107], v[176:179], a[228:231], v[104:107]
  s_add_u32 s47, s37, 65536
  s_add_u32 m0, s32, 65536
  v_mfma_f32_16x16x32_bf16 v[112:115], v[176:179], a[232:235], v[112:115]
  buffer_load_dwordx4 v5, s[8:11], s47 offen offset:0 sc1 lds
  v_mfma_f32_16x16x32_bf16 v[120:123], v[176:179], a[236:239], v[120:123]
  s_waitcnt lgkmcnt(6)
  v_mfma_f32_16x16x32_bf16 v[100:103], v[180:183], a[224:227], v[100:103]
  ds_read_b64_tr_b16 v[164:165], v9 offset:0
  ds_read_b64_tr_b16 v[166:167], v9 offset:2048
  v_mfma_f32_16x16x32_bf16 v[108:111], v[180:183], a[228:231], v[108:111]
  s_add_u32 s47, s37, 69632
  s_add_u32 m0, s32, 69632
  v_mfma_f32_16x16x32_bf16 v[116:119], v[180:183], a[232:235], v[116:119]
  buffer_load_dwordx4 v5, s[8:11], s47 offen offset:0 sc1 lds
  v_mfma_f32_16x16x32_bf16 v[124:127], v[180:183], a[236:239], v[124:127]
  s_waitcnt lgkmcnt(6)
  v_mfma_f32_16x16x32_bf16 v[32:35], v[184:187], a[224:227], v[32:35]
  ds_read_b64_tr_b16 v[168:169], v8 offset:4096
  ds_read_b64_tr_b16 v[170:171], v8 offset:6144
  v_mfma_f32_16x16x32_bf16 v[40:43], v[184:187], a[228:231], v[40:43]
  s_add_u32 m0, s32, 73600
  v_mfma_f32_16x16x32_bf16 v[48:51], v[184:187], a[232:235], v[48:51]
  buffer_load_dwordx4 v4, s[20:23], s50 offen offset:128 lds
  v_mfma_f32_16x16x32_bf16 v[56:59], v[184:187], a[236:239], v[56:59]
  s_waitcnt lgkmcnt(6)
  v_mfma_f32_16x16x32_bf16 v[36:39], v[188:191], a[224:227], v[36:39]
  ds_read_b64_tr_b16 v[172:173], v9 offset:4096
  ds_read_b64_tr_b16 v[174:175], v9 offset:6144
  v_mfma_f32_16x16x32_bf16 v[44:47], v[188:191], a[228:231], v[44:47]
  s_add_u32 m0, s32, 77568
  v_mfma_f32_16x16x32_bf16 v[52:55], v[188:191], a[232:235], v[52:55]
  buffer_load_dwordx4 v4, s[20:23], s50 offen offset:256 lds
  v_mfma_f32_16x16x32_bf16 v[60:63], v[188:191], a[236:239], v[60:63]
  s_waitcnt lgkmcnt(6)
  v_mfma_f32_16x16x32_bf16 v[64:67], v[160:163], a[128:131], v[64:67]
  ds_read_b64_tr_b16 v[176:177], v8 offset:32768
  ds_read_b64_tr_b16 v[178:179], v8 offset:34816
  v_mfma_f32_16x16x32_bf16 v[72:75], v[160:163], a[132:135], v[72:75]
  s_add_u32 m0, s32, 90112
  v_mfma_f32_16x16x32_bf16 v[80:83], v[160:163], a[136:139], v[80:83]
  buffer_load_dwordx4 v22, s[20:23], s36 offen offset:0 lds
  v_mfma_f32_16x16x32_bf16 v[88:91], v[160:163], a[140:143], v[88:91]
  s_waitcnt lgkmcnt(6)
  v_mfma_f32_16x16x32_bf16 v[68:71], v[164:167], a[128:131], v[68:71]
  ds_read_b64_tr_b16 v[180:181], v9 offset:32768
  ds_read_b64_tr_b16 v[182:183], v9 offset:34816
  v_mfma_f32_16x16x32_bf16 v[76:79], v[164:167], a[132:135], v[76:79]
  s_add_u32 m0, s32, 93824
  v_mfma_f32_16x16x32_bf16 v[84:87], v[164:167], a[136:139], v[84:87]
  buffer_load_dwordx4 v4, s[20:23], s78 offen offset:384 lds
  v_mfma_f32_16x16x32_bf16 v[92:95], v[164:167], a[140:143], v[92:95]
  s_waitcnt lgkmcnt(6)
  v_mfma_f32_16x16x32_bf16 v[96:99], v[168:171], a[128:131], v[96:99]
  ds_read_b64_tr_b16 v[184:185], v14 offset:36864
  ds_read_b64_tr_b16 v[186:187], v14 offset:37888
  v_mfma_f32_16x16x32_bf16 v[104:107], v[168:171], a[132:135], v[104:107]
  s_add_u32 m0, s32, 24192
  v_mfma_f32_16x16x32_bf16 v[112:115], v[168:171], a[136:139], v[112:115]
  buffer_load_dwordx4 v4, s[20:23], s79 offen offset:384 lds
  v_mfma_f32_16x16x32_bf16 v[120:123], v[168:171], a[140:143], v[120:123]
  s_waitcnt lgkmcnt(6)
  v_mfma_f32_16x16x32_bf16 v[100:103], v[172:175], a[128:131], v[100:103]
  ds_read_b64_tr_b16 v[188:189], v14 offset:38912
  ds_read_b64_tr_b16 v[190:191], v14 offset:39936
  v_mfma_f32_16x16x32_bf16 v[108:111], v[172:175], a[132:135], v[108:111]
  s_add_u32 m0, s32, 28288
  v_mfma_f32_16x16x32_bf16 v[116:119], v[172:175], a[136:139], v[116:119]
  buffer_load_dwordx4 v4, s[20:23], s80 offen offset:384 lds
  v_mfma_f32_16x16x32_bf16 v[124:127], v[172:175], a[140:143], v[124:127]
  s_waitcnt lgkmcnt(6)
  v_mfma_f32_16x16x32_bf16 v[32:35], v[176:179], a[128:131], v[32:35]
  ds_read_b64_tr_b16 v[160:161], v15 offset:16384
  ds_read_b64_tr_b16 v[162:163], v15 offset:17408
  v_mfma_f32_16x16x32_bf16 v[40:43], v[176:179], a[132:135], v[40:43]
  v_mfma_f32_16x16x32_bf16 v[48:51], v[176:179], a[136:139], v[48:51]
  v_mfma_f32_16x16x32_bf16 v[56:59], v[176:179], a[140:143], v[56:59]
  s_waitcnt lgkmcnt(6)
  v_mfma_f32_16x16x32_bf16 v[36:39], v[180:183], a[128:131], v[36:39]
  ds_read_b64_tr_b16 v[164:165], v15 offset:18432
  ds_read_b64_tr_b16 v[166:167], v15 offset:19456
  v_mfma_f32_16x16x32_bf16 v[44:47], v[180:183], a[132:135], v[44:47]
  v_mfma_f32_16x16x32_bf16 v[52:55], v[180:183], a[136:139], v[52:55]
  v_mfma_f32_16x16x32_bf16 v[60:63], v[180:183], a[140:143], v[60:63]
  s_waitcnt lgkmcnt(6)
  v_mfma_f32_16x16x32_bf16 v[128:131], v[184:187], a[0:3], 0
  ds_read_b64_tr_b16 v[168:169], v15 offset:20480
  ds_read_b64_tr_b16 v[170:171], v15 offset:21504
  v_mfma_f32_16x16x32_bf16 v[132:135], v[184:187], a[4:7], 0
  v_mfma_f32_16x16x32_bf16 v[136:139], v[184:187], a[8:11], 0
  v_mfma_f32_16x16x32_bf16 v[140:143], v[184:187], a[12:15], 0
  s_waitcnt lgkmcnt(6)
  v_mfma_f32_16x16x32_bf16 v[128:131], v[188:191], a[144:147], v[128:131]
  ds_read_b64_tr_b16 v[172:173], v15 offset:22528
  ds_read_b64_tr_b16 v[174:175], v15 offset:23552
  v_mfma_f32_16x16x32_bf16 v[132:135], v[188:191], a[148:151], v[132:135]
  v_mfma_f32_16x16x32_bf16 v[136:139], v[188:191], a[152:155], v[136:139]
  v_mfma_f32_16x16x32_bf16 v[140:143], v[188:191], a[156:159], v[140:143]
  s_waitcnt lgkmcnt(6)
  v_mfma_f32_16x16x32_bf16 v[128:131], v[160:163], a[16:19], v[128:131]
  s_barrier
  ds_read_b64_tr_b16 v[176:177], v15 offset:57344
  ds_read_b64_tr_b16 v[178:179], v15 offset:58368
  v_mfma_f32_16x16x32_bf16 v[132:135], v[160:163], a[20:23], v[132:135]
  s_add_u32 m0, s32, 97920
  v_mfma_f32_16x16x32_bf16 v[136:139], v[160:163], a[24:27], v[136:139]
  buffer_load_dwordx4 v4, s[20:23], s81 offen offset:384 lds
  ds_read_b128 a[240:243], v19 offset:0
  v_mfma_f32_16x16x32_bf16 v[140:143], v[160:163], a[28:31], v[140:143]
  s_waitcnt lgkmcnt(7)
  v_mfma_f32_16x16x32_bf16 v[128:131], v[164:167], a[160:163], v[128:131]
  ds_read_b64_tr_b16 v[180:181], v15 offset:59392
  ds_read_b64_tr_b16 v[182:183], v15 offset:60416
  v_mfma_f32_16x16x32_bf16 v[132:135], v[164:167], a[164:167], v[132:135]
  s_add_u32 m0, s32, 102016
  v_mfma_f32_16x16x32_bf16 v[136:139], v[164:167], a[168:171], v[136:139]
  buffer_load_dwordx4 v4, s[20:23], s82 offen offset:384 lds
  ds_read_b128 a[244:247], v19 offset:1024
  v_mfma_f32_16x16x32_bf16 v[140:143], v[164:167], a[172:175], v[140:143]
  s_waitcnt lgkmcnt(8)
  v_mfma_f32_16x16x32_bf16 v[128:131], v[168:171], a[32:35], v[128:131]
  ds_read_b64_tr_b16 v[184:185], v15 offset:61440
  ds_read_b64_tr_b16 v[186:187], v15 offset:62464
  v_mfma_f32_16x16x32_bf16 v[132:135], v[168:171], a[36:39], v[132:135]
  s_add_u32 m0, s32, 106112
  v_mfma_f32_16x16x32_bf16 v[136:139], v[168:171], a[40:43], v[136:139]
  buffer_load_dwordx4 v4, s[20:23], s83 offen offset:384 lds
  ds_read_b128 a[248:251], v19 offset:2048
  v_mfma_f32_16x16x32_bf16 v[140:143], v[168:171], a[44:47], v[140:143]
  s_waitcnt lgkmcnt(9)
  v_mfma_f32_16x16x32_bf16 v[128:131], v[172:175], a[176:179], v[128:131]
  ds_read_b64_tr_b16 v[188:189], v15 offset:63488
  ds_read_b64_tr_b16 v[190:191], v15 offset:64512
  v_mfma_f32_16x16x32_bf16 v[132:135], v[172:175], a[180:183], v[132:135]
  s_add_u32 m0, s32, 110208
  v_mfma_f32_16x16x32_bf16 v[136:139], v[172:175], a[184:187], v[136:139]
  buffer_load_dwordx4 v4, s[20:23], s84 offen offset:384 lds
  ds_read_b128 a[252:255], v19 offset:3072
  v_mfma_f32_16x16x32_bf16 v[140:143], v[172:175], a[188:191], v[140:143]
  s_waitcnt lgkmcnt(10)
  v_mfma_f32_16x16x32_bf16 v[128:131], v[176:179], a[48:51], v[128:131]
  ds_read_b64_tr_b16 v[160:161], v14 offset:8192
  ds_read_b64_tr_b16 v[162:163], v14 offset:9216
  v_mfma_f32_16x16x32_bf16 v[132:135], v[176:179], a[52:55], v[132:135]
  s_add_u32 m0, s32, 114304
  v_mfma_f32_16x16x32_bf16 v[136:139], v[176:179], a[56:59], v[136:139]
  buffer_load_dwordx4 v4, s[20:23], s85 offen offset:384 lds
  ds_read_b128 v[224:227], v17 offset:40960
  v_mfma_f32_16x16x32_bf16 v[140:143], v[176:179], a[60:63], v[140:143]
  s_waitcnt lgkmcnt(10)
  v_mfma_f32_16x16x32_bf16 v[128:131], v[180:183], a[192:195], v[128:131]
  ds_read_b64_tr_b16 v[164:165], v14 offset:10240
  ds_read_b64_tr_b16 v[166:167], v14 offset:11264
  v_mfma_f32_16x16x32_bf16 v[132:135], v[180:183], a[196:199], v[132:135]
  s_add_u32 m0, s32, 118400
  v_mfma_f32_16x16x32_bf16 v[136:139], v[180:183], a[200:203], v[136:139]
  buffer_load_dwordx4 v4, s[20:23], s86 offen offset:384 lds
  ds_read_b128 v[228:231], v17 offset:41984
  v_mfma_f32_16x16x32_bf16 v[140:143], v[180:183], a[204:207], v[140:143]
  s_waitcnt lgkmcnt(10)
  v_mfma_f32_16x16x32_bf16 v[128:131], v[184:187], a[64:67], v[128:131]
  ds_read_b64_tr_b16 v[168:169], v8 offset:12288
  ds_read_b64_tr_b16 v[170:171], v8 offset:14336
  v_mfma_f32_16x16x32_bf16 v[132:135], v[184:187], a[68:71], v[132:135]
  v_mfma_f32_16x16x32_bf16 v[136:139], v[184:187], a[72:75], v[136:139]
  ds_read_b128 v[232:235], v17 offset:43008
  v_mfma_f32_16x16x32_bf16 v[140:143], v[184:187], a[76:79], v[140:143]
  s_waitcnt lgkmcnt(10)
  v_mfma_f32_16x16x32_bf16 v[128:131], v[188:191], a[208:211], v[128:131]
  ds_read_b64_tr_b16 v[172:173], v9 offset:12288
  ds_read_b64_tr_b16 v[174:175], v9 offset:14336
  v_mfma_f32_16x16x32_bf16 v[132:135], v[188:191], a[212:215], v[132:135]
  v_mfma_f32_16x16x32_bf16 v[136:139], v[188:191], a[216:219], v[136:139]
  ds_read_b128 v[236:239], v17 offset:44032
  v_mfma_f32_16x16x32_bf16 v[140:143], v[188:191], a[220:223], v[140:143]
  s_waitcnt lgkmcnt(10)
  v_mfma_f32_16x16x32_bf16 v[128:131], v[160:163], a[80:83], v[128:131]
  ds_read_b64_tr_b16 v[176:177], v8 offset:49152
  ds_read_b64_tr_b16 v[178:179], v8 offset:51200
  v_mfma_f32_16x16x32_bf16 v[132:135], v[160:163], a[84:87], v[132:135]
  v_mfma_f32_16x16x32_bf16 v[136:139], v[160:163], a[88:91], v[136:139]
  v_mfma_f32_16x16x32_bf16 v[140:143], v[160:163], a[92:95], v[140:143]
  s_waitcnt lgkmcnt(9)
  v_mfma_f32_16x16x32_bf16 v[128:131], v[164:167], a[224:227], v[128:131]
  ds_read_b64_tr_b16 v[180:181], v9 offset:49152
  ds_read_b64_tr_b16 v[182:183], v9 offset:51200
  v_mfma_f32_16x16x32_bf16 v[132:135], v[164:167], a[228:231], v[132:135]
  v_mfma_f32_16x16x32_bf16 v[136:139], v[164:167], a[232:235], v[136:139]
  v_mfma_f32_16x16x32_bf16 v[140:143], v[164:167], a[236:239], v[140:143]
  s_waitcnt lgkmcnt(8)
  v_mfma_f32_16x16x32_bf16 v[64:67], v[168:171], a[240:243], v[64:67]
  ds_read_b64_tr_b16 v[184:185], v8 offset:53248
  ds_read_b64_tr_b16 v[186:187], v8 offset:55296
  v_mfma_f32_16x16x32_bf16 v[72:75], v[168:171], a[244:247], v[72:75]
  v_mfma_f32_16x16x32_bf16 v[80:83], v[168:171], a[248:251], v[80:83]
  v_mfma_f32_16x16x32_bf16 v[88:91], v[168:171], a[252:255], v[88:91]
  s_waitcnt lgkmcnt(7)
  v_mfma_f32_16x16x32_bf16 v[68:71], v[172:175], a[240:243], v[68:71]
  ds_read_b64_tr_b16 v[188:189], v9 offset:53248
  ds_read_b64_tr_b16 v[190:191], v9 offset:55296
  v_mfma_f32_16x16x32_bf16 v[76:79], v[172:175], a[244:247], v[76:79]
  v_mfma_f32_16x16x32_bf16 v[84:87], v[172:175], a[248:251], v[84:87]
  v_mfma_f32_16x16x32_bf16 v[92:95], v[172:175], a[252:255], v[92:95]
  s_waitcnt lgkmcnt(6)
  v_mfma_f32_16x16x32_bf16 v[64:67], v[176:179], v[224:227], v[64:67]
  s_waitcnt vmcnt(12)
  s_barrier
  ds_read_b64_tr_b16 v[160:161], v12 offset:24576
  ds_read_b64_tr_b16 v[162:163], v12 offset:26624
  v_mfma_f32_16x16x32_bf16 v[72:75], v[176:179], v[228:231], v[72:75]
  s_add_u32 m0, s32, 138880
  v_mfma_f32_16x16x32_bf16 v[80:83], v[176:179], v[232:235], v[80:83]
  buffer_load_dwordx4 v4, s[20:23], s40 offen offset:384 lds
  v_mfma_f32_16x16x32_bf16 v[88:91], v[176:179], v[236:239], v[88:91]
  s_waitcnt lgkmcnt(6)
  v_mfma_f32_16x16x32_bf16 v[68:71], v[180:183], v[224:227], v[68:71]
  ds_read_b64_tr_b16 v[164:165], v13 offset:24576
  ds_read_b64_tr_b16 v[166:167], v13 offset:26624
  v_mfma_f32_16x16x32_bf16 v[76:79], v[180:183], v[228:231], v[76:79]
  s_add_u32 m0, s32, 142976
  v_mfma_f32_16x16x32_bf16 v[84:87], v[180:183], v[232:235], v[84:87]
  buffer_load_dwordx4 v4, s[20:23], s41 offen offset:384 lds
  v_mfma_f32_16x16x32_bf16 v[92:95], v[180:183], v[236:239], v[92:95]
  s_waitcnt lgkmcnt(6)
  v_mfma_f32_16x16x32_bf16 v[96:99], v[184:187], a[240:243], v[96:99]
  ds_read_b64_tr_b16 v[168:169], v12 offset:28672
  ds_read_b64_tr_b16 v[170:171], v12 offset:30720
  v_mfma_f32_16x16x32_bf16 v[104:107], v[184:187], a[244:247], v[104:107]
  s_add_u32 s47, s42, 384
  s_add_u32 m0, s32, 0
  v_mfma_f32_16x16x32_bf16 v[112:115], v[184:187], a[248:251], v[112:115]
  buffer_load_dwordx4 v4, s[20:23], s47 offen offset:0 lds
  v_mfma_f32_16x16x32_bf16 v[120:123], v[184:187], a[252:255], v[120:123]
  s_waitcnt lgkmcnt(6)
  v_mfma_f32_16x16x32_bf16 v[100:103], v[188:191], a[240:243], v[100:103]
  ds_read_b64_tr_b16 v[172:173], v13 offset:28672
  ds_read_b64_tr_b16 v[174:175], v13 offset:30720
  v_mfma_f32_16x16x32_bf16 v[108:111], v[188:191], a[244:247], v[108:111]
  s_add_u32 m0, s32, 3712
  v_mfma_f32_16x16x32_bf16 v[116:119], v[188:191], a[248:251], v[116:119]
  buffer_load_dwordx4 v4, s[20:23], s43 offen offset:384 lds
  v_mfma_f32_16x16x32_bf16 v[124:127], v[188:191], a[252:255], v[124:127]
  s_waitcnt lgkmcnt(6)
  v_mfma_f32_16x16x32_bf16 v[96:99], v[160:163], v[224:227], v[96:99]
  ds_read_b64_tr_b16 v[176:177], v8 offset:57344
  ds_read_b64_tr_b16 v[178:179], v8 offset:59392
  v_mfma_f32_16x16x32_bf16 v[104:107], v[160:163], v[228:231], v[104:107]
  s_add_u32 m0, s32, 32384
  v_mfma_f32_16x16x32_bf16 v[112:115], v[160:163], v[232:235], v[112:115]
  buffer_load_dwordx4 v4, s[20:23], s44 offen offset:384 lds
  v_mfma_f32_16x16x32_bf16 v[120:123], v[160:163], v[236:239], v[120:123]
  s_waitcnt lgkmcnt(6)
  v_mfma_f32_16x16x32_bf16 v[100:103], v[164:167], v[224:227], v[100:103]
  ds_read_b64_tr_b16 v[180:181], v9 offset:57344
  ds_read_b64_tr_b16 v[182:183], v9 offset:59392
  v_mfma_f32_16x16x32_bf16 v[108:111], v[164:167], v[228:231], v[108:111]
  s_add_u32 m0, s32, 36480
  v_mfma_f32_16x16x32_bf16 v[116:119], v[164:167], v[232:235], v[116:119]
  buffer_load_dwordx4 v4, s[20:23], s45 offen offset:384 lds
  v_mfma_f32_16x16x32_bf16 v[124:127], v[164:167], v[236:239], v[124:127]
  s_waitcnt lgkmcnt(6)
  v_mfma_f32_16x16x32_bf16 v[32:35], v[168:171], a[240:243], v[32:35]
  ds_read_b64_tr_b16 v[184:185], v14 offset:61440
  ds_read_b64_tr_b16 v[186:187], v14 offset:62464
  v_mfma_f32_16x16x32_bf16 v[40:43], v[168:171], a[244:247], v[40:43]
  v_mfma_f32_16x16x32_bf16 v[48:51], v[168:171], a[248:251], v[48:51]
  ds_read_b64 v[240:241], v18 offset:0
  ds_read_b64 v[242:243], v18 offset:2048
  v_mfma_f32_16x16x32_bf16 v[56:59], v[168:171], a[252:255], v[56:59]
  s_waitcnt lgkmcnt(8)
  v_mfma_f32_16x16x32_bf16 v[36:39], v[172:175], a[240:243], v[36:39]
  ds_read_b64_tr_b16 v[188:189], v14 offset:63488
  ds_read_b64_tr_b16 v[190:191], v14 offset:64512
  v_mfma_f32_16x16x32_bf16 v[44:47], v[172:175], a[244:247], v[44:47]
  v_mfma_f32_16x16x32_bf16 v[52:55], v[172:175], a[248:251], v[52:55]
  ds_read_b64 v[244:245], v18 offset:8
  ds_read_b64 v[246:247], v18 offset:2056
  v_mfma_f32_16x16x32_bf16 v[60:63], v[172:175], a[252:255], v[60:63]
  s_waitcnt lgkmcnt(10)
  v_mfma_f32_16x16x32_bf16 v[32:35], v[176:179], v[224:227], v[32:35]
  ds_read_b64_tr_b16 v[160:161], v14 offset:16384
  ds_read_b64_tr_b16 v[162:163], v14 offset:17408
  v_mfma_f32_16x16x32_bf16 v[40:43], v[176:179], v[228:231], v[40:43]
  v_mfma_f32_16x16x32_bf16 v[48:51], v[176:179], v[232:235], v[48:51]
  ds_read_b64 v[248:249], v18 offset:1024
  ds_read_b64 v[250:251], v18 offset:3072
  v_mfma_f32_16x16x32_bf16 v[56:59], v[176:179], v[236:239], v[56:59]
  s_waitcnt lgkmcnt(12)
  v_mfma_f32_16x16x32_bf16 v[36:39], v[180:183], v[224:227], v[36:39]
  ds_read_b64_tr_b16 v[164:165], v14 offset:18432
  ds_read_b64_tr_b16 v[166:167], v14 offset:19456
  v_mfma_f32_16x16x32_bf16 v[44:47], v[180:183], v[228:231], v[44:47]
  v_mfma_f32_16x16x32_bf16 v[52:55], v[180:183], v[232:235], v[52:55]
  ds_read_b64 v[252:253], v18 offset:1032
  ds_read_b64 v[254:255], v18 offset:3080
  v_mfma_f32_16x16x32_bf16 v[60:63], v[180:183], v[236:239], v[60:63]
  s_waitcnt lgkmcnt(14)
  v_mfma_f32_16x16x32_bf16 v[128:131], v[184:187], a[96:99], v[128:131]
  ds_read_b64_tr_b16 v[168:169], v8 offset:20480
  ds_read_b64_tr_b16 v[170:171], v8 offset:22528
  v_mfma_f32_16x16x32_bf16 v[132:135], v[184:187], a[100:103], v[132:135]
  v_mfma_f32_16x16x32_bf16 v[136:139], v[184:187], a[104:107], v[136:139]
  v_mfma_f32_16x16x32_bf16 v[140:143], v[184:187], a[108:111], v[140:143]
  s_waitcnt lgkmcnt(12)
  v_mfma_f32_16x16x32_bf16 v[128:131], v[188:191], a[240:243], v[128:131]
  ds_read_b64_tr_b16 v[172:173], v9 offset:20480
  ds_read_b64_tr_b16 v[174:175], v9 offset:22528
  v_mfma_f32_16x16x32_bf16 v[132:135], v[188:191], a[244:247], v[132:135]
  v_mfma_f32_16x16x32_bf16 v[136:139], v[188:191], a[248:251], v[136:139]
  v_mfma_f32_16x16x32_bf16 v[140:143], v[188:191], a[252:255], v[140:143]
  s_waitcnt lgkmcnt(10)
  v_mfma_f32_16x16x32_bf16 v[128:131], v[160:163], a[112:115], v[128:131]
  s_waitcnt vmcnt(12)
  s_barrier
  ds_read_b64_tr_b16 v[176:177], v10 offset:8192
  ds_read_b64_tr_b16 v[178:179], v10 offset:10240
  v_mfma_f32_16x16x32_bf16 v[132:135], v[160:163], a[116:119], v[132:135]
  s_add_u32 m0, s32, 147072
  v_mfma_f32_16x16x32_bf16 v[136:139], v[160:163], a[120:123], v[136:139]
  buffer_load_dwordx4 v4, s[20:23], s48 offen offset:384 lds
  v_mfma_f32_16x16x32_bf16 v[140:143], v[160:163], a[124:127], v[140:143]
  s_waitcnt lgkmcnt(8)
  v_mfma_f32_16x16x32_bf16 v[128:131], v[164:167], v[224:227], v[128:131]
  ds_read_b64_tr_b16 v[180:181], v11 offset:8192
  ds_read_b64_tr_b16 v[182:183], v11 offset:10240
  v_mfma_f32_16x16x32_bf16 v[132:135], v[164:167], v[228:231], v[132:135]
  s_add_u32 m0, s32, 151168
  v_mfma_f32_16x16x32_bf16 v[136:139], v[164:167], v[232:235], v[136:139]
  buffer_load_dwordx4 v4, s[20:23], s49 offen offset:384 lds
  v_mfma_f32_16x16x32_bf16 v[140:143], v[164:167], v[236:239], v[140:143]
  s_waitcnt lgkmcnt(6)
  v_mfma_f32_16x16x32_bf16 v[64:67], v[168:171], v[240:243], v[64:67]
  ds_read_b64_tr_b16 v[184:185], v10 offset:12288
  ds_read_b64_tr_b16 v[186:187], v10 offset:14336
  v_mfma_f32_16x16x32_bf16 v[72:75], v[168:171], v[244:247], v[72:75]
  s_add_u32 m0, s32, 7808
  v_mfma_f32_16x16x32_bf16 v[80:83], v[168:171], v[248:251], v[80:83]
  buffer_load_dwordx4 v4, s[20:23], s50 offen offset:384 lds
  v_mfma_f32_16x16x32_bf16 v[88:91], v[168:171], v[252:255], v[88:91]
  s_waitcnt lgkmcnt(6)
  v_mfma_f32_16x16x32_bf16 v[68:71], v[172:175], v[240:243], v[68:71]
  ds_read_b64_tr_b16 v[188:189], v11 offset:12288
  ds_read_b64_tr_b16 v[190:191], v11 offset:14336
  v_mfma_f32_16x16x32_bf16 v[76:79], v[172:175], v[244:247], v[76:79]
  v_mfma_f32_16x16x32_bf16 v[84:87], v[172:175], v[248:251], v[84:87]
  v_mfma_f32_16x16x32_bf16 v[92:95], v[172:175], v[252:255], v[92:95]
  v_cvt_pk_bf16_f32 v64, v64, v65
  v_cvt_pk_bf16_f32 v65, v66, v67
  s_waitcnt lgkmcnt(6)
  v_mfma_f32_16x16x32_bf16 v[96:99], v[176:179], v[240:243], v[96:99]
  v_cvt_pk_bf16_f32 v72, v72, v73
  v_cvt_pk_bf16_f32 v73, v74, v75
  ds_read_b64_tr_b16 v[160:161], v15 offset:24576
  ds_read_b64_tr_b16 v[162:163], v15 offset:25600
  v_mfma_f32_16x16x32_bf16 v[104:107], v[176:179], v[244:247], v[104:107]
  v_cvt_pk_bf16_f32 v80, v80, v81
  v_cvt_pk_bf16_f32 v81, v82, v83
  v_mfma_f32_16x16x32_bf16 v[112:115], v[176:179], v[248:251], v[112:115]
  v_cvt_pk_bf16_f32 v88, v88, v89
  v_cvt_pk_bf16_f32 v89, v90, v91
  v_mfma_f32_16x16x32_bf16 v[120:123], v[176:179], v[252:255], v[120:123]
  v_cvt_pk_bf16_f32 v66, v68, v69
  v_cvt_pk_bf16_f32 v67, v70, v71
  s_waitcnt lgkmcnt(6)
  v_mfma_f32_16x16x32_bf16 v[100:103], v[180:183], v[240:243], v[100:103]
  v_cvt_pk_bf16_f32 v74, v76, v77
  v_cvt_pk_bf16_f32 v75, v78, v79
  ds_read_b64_tr_b16 v[164:165], v15 offset:26624
  ds_read_b64_tr_b16 v[166:167], v15 offset:27648
  v_mfma_f32_16x16x32_bf16 v[108:111], v[180:183], v[244:247], v[108:111]
  v_cvt_pk_bf16_f32 v82, v84, v85
  v_cvt_pk_bf16_f32 v83, v86, v87
  v_mfma_f32_16x16x32_bf16 v[116:119], v[180:183], v[248:251], v[116:119]
  v_cvt_pk_bf16_f32 v90, v92, v93
  v_cvt_pk_bf16_f32 v91, v94, v95
  v_mfma_f32_16x16x32_bf16 v[124:127], v[180:183], v[252:255], v[124:127]
  v_cvt_pk_bf16_f32 v96, v96, v97
  v_cvt_pk_bf16_f32 v97, v98, v99
  s_waitcnt lgkmcnt(6)
  v_mfma_f32_16x16x32_bf16 v[32:35], v[184:187], v[240:243], v[32:35]
  v_cvt_pk_bf16_f32 v104, v104, v105
  v_cvt_pk_bf16_f32 v105, v106, v107
  ds_read_b64_tr_b16 v[168:169], v10 offset:28672
  ds_read_b64_tr_b16 v[170:171], v10 offset:30720
  v_mfma_f32_16x16x32_bf16 v[40:43], v[184:187], v[244:247], v[40:43]
  v_cvt_pk_bf16_f32 v112, v112, v113
  v_cvt_pk_bf16_f32 v113, v114, v115
  v_mfma_f32_16x16x32_bf16 v[48:51], v[184:187], v[248:251], v[48:51]
  v_cvt_pk_bf16_f32 v120, v120, v121
  v_cvt_pk_bf16_f32 v121, v122, v123
  v_mfma_f32_16x16x32_bf16 v[56:59], v[184:187], v[252:255], v[56:59]
  v_cvt_pk_bf16_f32 v98, v100, v101
  v_cvt_pk_bf16_f32 v99, v102, v103
  s_waitcnt lgkmcnt(6)
  v_mfma_f32_16x16x32_bf16 v[36:39], v[188:191], v[240:243], v[36:39]
  v_cvt_pk_bf16_f32 v106, v108, v109
  v_cvt_pk_bf16_f32 v107, v110, v111
  ds_read_b64_tr_b16 v[172:173], v11 offset:28672
  ds_read_b64_tr_b16 v[174:175], v11 offset:30720
  v_mfma_f32_16x16x32_bf16 v[44:47], v[188:191], v[244:247], v[44:47]
  v_cvt_pk_bf16_f32 v114, v116, v117
  v_cvt_pk_bf16_f32 v115, v118, v119
  v_mfma_f32_16x16x32_bf16 v[52:55], v[188:191], v[248:251], v[52:55]
  v_cvt_pk_bf16_f32 v122, v124, v125
  v_cvt_pk_bf16_f32 v123, v126, v127
  v_mfma_f32_16x16x32_bf16 v[60:63], v[188:191], v[252:255], v[60:63]
  v_cvt_pk_bf16_f32 v32, v32, v33
  v_cvt_pk_bf16_f32 v33, v34, v35
  s_waitcnt lgkmcnt(6)
  v_mfma_f32_16x16x32_bf16 v[128:131], v[160:163], a[128:131], v[128:131]
  v_cvt_pk_bf16_f32 v40, v40, v41
  v_cvt_pk_bf16_f32 v41, v42, v43
  ds_read_b64_tr_b16 v[176:177], v8 offset:24576
  ds_read_b64_tr_b16 v[178:179], v8 offset:26624
  v_mfma_f32_16x16x32_bf16 v[132:135], v[160:163], a[132:135], v[132:135]
  v_cvt_pk_bf16_f32 v48, v48, v49
  v_cvt_pk_bf16_f32 v49, v50, v51
  v_mfma_f32_16x16x32_bf16 v[136:139], v[160:163], a[136:139], v[136:139]
  v_cvt_pk_bf16_f32 v56, v56, v57
  v_cvt_pk_bf16_f32 v57, v58, v59
  v_mfma_f32_16x16x32_bf16 v[140:143], v[160:163], a[140:143], v[140:143]
  v_cvt_pk_bf16_f32 v34, v36, v37
  v_cvt_pk_bf16_f32 v35, v38, v39
  s_waitcnt lgkmcnt(6)
  v_mfma_f32_16x16x32_bf16 v[128:131], v[164:167], v[240:243], v[128:131]
  v_cvt_pk_bf16_f32 v42, v44, v45
  v_cvt_pk_bf16_f32 v43, v46, v47
  ds_read_b64_tr_b16 v[180:181], v9 offset:24576
  ds_read_b64_tr_b16 v[182:183], v9 offset:26624
  v_mfma_f32_16x16x32_bf16 v[132:135], v[164:167], v[244:247], v[132:135]
  v_cvt_pk_bf16_f32 v50, v52, v53
  v_cvt_pk_bf16_f32 v51, v54, v55
  v_mfma_f32_16x16x32_bf16 v[136:139], v[164:167], v[248:251], v[136:139]
  v_cvt_pk_bf16_f32 v58, v60, v61
  v_cvt_pk_bf16_f32 v59, v62, v63
  v_mfma_f32_16x16x32_bf16 v[140:143], v[164:167], v[252:255], v[140:143]
  s_add_u32 s56, s46, 0
  s_waitcnt lgkmcnt(6)
  v_mfma_f32_16x16x32_bf16 v[192:195], v[168:171], a[0:3], 0
  ds_read_b64_tr_b16 v[184:185], v8 offset:28672
  ds_read_b64_tr_b16 v[186:187], v8 offset:30720
  v_mfma_f32_16x16x32_bf16 v[200:203], v[168:171], a[4:7], 0
  buffer_store_dwordx4 v[64:67], v5, s[8:11], s56 offen sc1
  s_add_u32 s56, s46, 18432
  v_mfma_f32_16x16x32_bf16 v[208:211], v[168:171], a[8:11], 0
  v_mfma_f32_16x16x32_bf16 v[216:219], v[168:171], a[12:15], 0
  v_cvt_pk_bf16_f32 v128, v128, v129
  v_cvt_pk_bf16_f32 v129, v130, v131
  s_waitcnt lgkmcnt(6)
  v_mfma_f32_16x16x32_bf16 v[196:199], v[172:175], a[0:3], 0
  v_cvt_pk_bf16_f32 v130, v132, v133
  v_cvt_pk_bf16_f32 v131, v134, v135
  ds_read_b64_tr_b16 v[188:189], v9 offset:28672
  ds_read_b64_tr_b16 v[190:191], v9 offset:30720
  v_mfma_f32_16x16x32_bf16 v[204:207], v[172:175], a[4:7], 0
  v_cvt_pk_bf16_f32 v132, v136, v137
  v_cvt_pk_bf16_f32 v133, v138, v139
  v_mfma_f32_16x16x32_bf16 v[212:215], v[172:175], a[8:11], 0
  v_cvt_pk_bf16_f32 v134, v140, v141
  v_cvt_pk_bf16_f32 v135, v142, v143
  v_mfma_f32_16x16x32_bf16 v[220:223], v[172:175], a[12:15], 0
  s_waitcnt lgkmcnt(6)
  v_mfma_f32_16x16x32_bf16 v[192:195], v[176:179], a[16:19], v[192:195]
  s_waitcnt vmcnt(10)
  s_barrier
  ds_read_b64_tr_b16 v[160:161], v10 offset:32768
  ds_read_b64_tr_b16 v[162:163], v10 offset:34816
  v_mfma_f32_16x16x32_bf16 v[200:203], v[176:179], a[20:23], v[200:203]
  v_mfma_f32_16x16x32_bf16 v[208:211], v[176:179], a[24:27], v[208:211]
  v_mfma_f32_16x16x32_bf16 v[216:219], v[176:179], a[28:31], v[216:219]
  buffer_store_dwordx4 v[72:75], v5, s[8:11], s56 offen sc1
  s_waitcnt lgkmcnt(6)
  v_mfma_f32_16x16x32_bf16 v[196:199], v[180:183], a[16:19], v[196:199]
  ds_read_b64_tr_b16 v[164:165], v11 offset:32768
  ds_read_b64_tr_b16 v[166:167], v11 offset:34816
  v_mfma_f32_16x16x32_bf16 v[204:207], v[180:183], a[20:23], v[204:207]
  s_add_u32 s56, s46, 36864
  v_mfma_f32_16x16x32_bf16 v[212:215], v[180:183], a[24:27], v[212:215]
  v_mfma_f32_16x16x32_bf16 v[220:223], v[180:183], a[28:31], v[220:223]
  s_waitcnt lgkmcnt(6)
  v_mfma_f32_16x16x32_bf16 v[192:195], v[184:187], a[32:35], v[192:195]
  ds_read_b64_tr_b16 v[168:169], v10 offset:36864
  ds_read_b64_tr_b16 v[170:171], v10 offset:38912
  v_mfma_f32_16x16x32_bf16 v[200:203], v[184:187], a[36:39], v[200:203]
  v_mfma_f32_16x16x32_bf16 v[208:211], v[184:187], a[40:43], v[208:211]
  v_mfma_f32_16x16x32_bf16 v[216:219], v[184:187], a[44:47], v[216:219]
  s_waitcnt lgkmcnt(6)
  v_mfma_f32_16x16x32_bf16 v[196:199], v[188:191], a[32:35], v[196:199]
  ds_read_b64_tr_b16 v[172:173], v11 offset:36864
  ds_read_b64_tr_b16 v[174:175], v11 offset:38912
  v_mfma_f32_16x16x32_bf16 v[204:207], v[188:191], a[36:39], v[204:207]
  buffer_store_dwordx4 v[80:83], v5, s[8:11], s56 offen sc1
  s_add_u32 s56, s46, 55296
  v_mfma_f32_16x16x32_bf16 v[212:215], v[188:191], a[40:43], v[212:215]
  v_mfma_f32_16x16x32_bf16 v[220:223], v[188:191], a[44:47], v[220:223]
  s_waitcnt lgkmcnt(6)
  v_mfma_f32_16x16x32_bf16 v[192:195], v[160:163], a[48:51], v[192:195]
  ds_read_b64_tr_b16 v[176:177], v10 offset:40960
  ds_read_b64_tr_b16 v[178:179], v10 offset:43008
  v_mfma_f32_16x16x32_bf16 v[200:203], v[160:163], a[52:55], v[200:203]
  v_mfma_f32_16x16x32_bf16 v[208:211], v[160:163], a[56:59], v[208:211]
  v_mfma_f32_16x16x32_bf16 v[216:219], v[160:163], a[60:63], v[216:219]
  s_waitcnt lgkmcnt(6)
  v_mfma_f32_16x16x32_bf16 v[196:199], v[164:167], a[48:51], v[196:199]
  ds_read_b64_tr_b16 v[180:181], v11 offset:40960
  ds_read_b64_tr_b16 v[182:183], v11 offset:43008
  v_mfma_f32_16x16x32_bf16 v[204:207], v[164:167], a[52:55], v[204:207]
  v_mfma_f32_16x16x32_bf16 v[212:215], v[164:167], a[56:59], v[212:215]
  v_mfma_f32_16x16x32_bf16 v[220:223], v[164:167], a[60:63], v[220:223]
  buffer_store_dwordx4 v[88:91], v5, s[8:11], s56 offen sc1
  s_waitcnt lgkmcnt(6)
  v_mfma_f32_16x16x32_bf16 v[192:195], v[168:171], a[64:67], v[192:195]
  ds_read_b64_tr_b16 v[184:185], v10 offset:45056
  ds_read_b64_tr_b16 v[186:187], v10 offset:47104
  v_mfma_f32_16x16x32_bf16 v[200:203], v[168:171], a[68:71], v[200:203]
  s_add_u32 s56, s46, 2048
  v_mfma_f32_16x16x32_bf16 v[208:211], v[168:171], a[72:75], v[208:211]
  v_mfma_f32_16x16x32_bf16 v[216:219], v[168:171], a[76:79], v[216:219]
  s_waitcnt lgkmcnt(6)
  v_mfma_f32_16x16x32_bf16 v[196:199], v[172:175], a[64:67], v[196:199]
  ds_read_b64_tr_b16 v[188:189], v11 offset:45056
  ds_read_b64_tr_b16 v[190:191], v11 offset:47104
  v_mfma_f32_16x16x32_bf16 v[204:207], v[172:175], a[68:71], v[204:207]
  v_mfma_f32_16x16x32_bf16 v[212:215], v[172:175], a[72:75], v[212:215]
  v_mfma_f32_16x16x32_bf16 v[220:223], v[172:175], a[76:79], v[220:223]
  s_waitcnt lgkmcnt(6)
  v_mfma_f32_16x16x32_bf16 v[192:195], v[176:179], a[80:83], v[192:195]
  ds_read_b64_tr_b16 v[160:161], v10 offset:49152
  ds_read_b64_tr_b16 v[162:163], v10 offset:51200
  v_mfma_f32_16x16x32_bf16 v[200:203], v[176:179], a[84:87], v[200:203]
  buffer_store_dwordx4 v[96:99], v5, s[8:11], s56 offen sc1
  s_add_u32 s56, s46, 20480
  v_mfma_f32_16x16x32_bf16 v[208:211], v[176:179], a[88:91], v[208:211]
  v_mfma_f32_16x16x32_bf16 v[216:219], v[176:179], a[92:95], v[216:219]
  s_waitcnt lgkmcnt(6)
  v_mfma_f32_16x16x32_bf16 v[196:199], v[180:183], a[80:83], v[196:199]
  ds_read_b64_tr_b16 v[164:165], v11 offset:49152
  ds_read_b64_tr_b16 v[166:167], v11 offset:51200
  v_mfma_f32_16x16x32_bf16 v[204:207], v[180:183], a[84:87], v[204:207]
  v_mfma_f32_16x16x32_bf16 v[212:215], v[180:183], a[88:91], v[212:215]
  v_mfma_f32_16x16x32_bf16 v[220:223], v[180:183], a[92:95], v[220:223]
  s_waitcnt lgkmcnt(6)
  v_mfma_f32_16x16x32_bf16 v[192:195], v[184:187], a[96:99], v[192:195]
  ds_read_b64_tr_b16 v[168:169], v10 offset:53248
  ds_read_b64_tr_b16 v[170:171], v10 offset:55296
  v_mfma_f32_16x16x32_bf16 v[200:203], v[184:187], a[100:103], v[200:203]
  v_mfma_f32_16x16x32_bf16 v[208:211], v[184:187], a[104:107], v[208:211]
  v_mfma_f32_16x16x32_bf16 v[216:219], v[184:187], a[108:111], v[216:219]
  buffer_store_dwordx4 v[104:107], v5, s[8:11], s56 offen sc1
  s_waitcnt lgkmcnt(6)
  v_mfma_f32_16x16x32_bf16 v[196:199], v[188:191], a[96:99], v[196:199]
  ds_read_b64_tr_b16 v[172:173], v11 offset:53248
  ds_read_b64_tr_b16 v[174:175], v11 offset:55296
  v_mfma_f32_16x16x32_bf16 v[204:207], v[188:191], a[100:103], v[204:207]
  s_add_u32 s56, s46, 38912
  v_mfma_f32_16x16x32_bf16 v[212:215], v[188:191], a[104:107], v[212:215]
  v_mfma_f32_16x16x32_bf16 v[220:223], v[188:191], a[108:111], v[220:223]
  s_waitcnt lgkmcnt(6)
  v_mfma_f32_16x16x32_bf16 v[192:195], v[160:163], a[112:115], v[192:195]
  s_waitcnt vmcnt(9)
  s_barrier
  ds_read_b64_tr_b16 v[176:177], v12 offset:8192
  ds_read_b64_tr_b16 v[178:179], v12 offset:10240
  v_mfma_f32_16x16x32_bf16 v[200:203], v[160:163], a[116:119], v[200:203]
  v_mfma_f32_16x16x32_bf16 v[208:211], v[160:163], a[120:123], v[208:211]
  v_mfma_f32_16x16x32_bf16 v[216:219], v[160:163], a[124:127], v[216:219]
  s_waitcnt lgkmcnt(6)
  v_mfma_f32_16x16x32_bf16 v[196:199], v[164:167], a[112:115], v[196:199]
  ds_read_b64_tr_b16 v[180:181], v13 offset:8192
  ds_read_b64_tr_b16 v[182:183], v13 offset:10240
  v_mfma_f32_16x16x32_bf16 v[204:207], v[164:167], a[116:119], v[204:207]
  buffer_store_dwordx4 v[112:115], v5, s[8:11], s56 offen sc1
  s_add_u32 s56, s46, 57344
  v_mfma_f32_16x16x32_bf16 v[212:215], v[164:167], a[120:123], v[212:215]
  v_mfma_f32_16x16x32_bf16 v[220:223], v[164:167], a[124:127], v[220:223]
  s_waitcnt lgkmcnt(6)
  v_mfma_f32_16x16x32_bf16 v[192:195], v[168:171], a[128:131], v[192:195]
  ds_read_b64_tr_b16 v[184:185], v12 offset:12288
  ds_read_b64_tr_b16 v[186:187], v12 offset:14336
  v_mfma_f32_16x16x32_bf16 v[200:203], v[168:171], a[132:135], v[200:203]
  v_mfma_f32_16x16x32_bf16 v[208:211], v[168:171], a[136:139], v[208:211]
  v_mfma_f32_16x16x32_bf16 v[216:219], v[168:171], a[140:143], v[216:219]
  s_waitcnt lgkmcnt(6)
  v_mfma_f32_16x16x32_bf16 v[196:199], v[172:175], a[128:131], v[196:199]
  ds_read_b64_tr_b16 v[188:189], v13 offset:12288
  ds_read_b64_tr_b16 v[190:191], v13 offset:14336
  v_mfma_f32_16x16x32_bf16 v[204:207], v[172:175], a[132:135], v[204:207]
  v_mfma_f32_16x16x32_bf16 v[212:215], v[172:175], a[136:139], v[212:215]
  v_mfma_f32_16x16x32_bf16 v[220:223], v[172:175], a[140:143], v[220:223]
  buffer_store_dwordx4 v[120:123], v5, s[8:11], s56 offen sc1
  s_waitcnt lgkmcnt(6)
  v_mfma_f32_16x16x32_bf16 v[192:195], v[176:179], a[144:147], v[192:195]
  ds_read_b64_tr_b16 v[160:161], v8 offset:0
  ds_read_b64_tr_b16 v[162:163], v8 offset:2048
  v_mfma_f32_16x16x32_bf16 v[200:203], v[176:179], a[148:151], v[200:203]
  s_add_u32 s56, s46, 4096
  v_mfma_f32_16x16x32_bf16 v[208:211], v[176:179], a[152:155], v[208:211]
  v_mfma_f32_16x16x32_bf16 v[216:219], v[176:179], a[156:159], v[216:219]
  s_waitcnt lgkmcnt(6)
  v_mfma_f32_16x16x32_bf16 v[196:199], v[180:183], a[144:147], v[196:199]
  ds_read_b64_tr_b16 v[164:165], v9 offset:0
  ds_read_b64_tr_b16 v[166:167], v9 offset:2048
  v_mfma_f32_16x16x32_bf16 v[204:207], v[180:183], a[148:151], v[204:207]
  v_mfma_f32_16x16x32_bf16 v[212:215], v[180:183], a[152:155], v[212:215]
  v_mfma_f32_16x16x32_bf16 v[220:223], v[180:183], a[156:159], v[220:223]
  s_waitcnt lgkmcnt(6)
  v_mfma_f32_16x16x32_bf16 v[192:195], v[184:187], a[160:163], v[192:195]
  ds_read_b64_tr_b16 v[168:169], v8 offset:4096
  ds_read_b64_tr_b16 v[170:171], v8 offset:6144
  v_mfma_f32_16x16x32_bf16 v[200:203], v[184:187], a[164:167], v[200:203]
  buffer_store_dwordx4 v[32:35], v5, s[8:11], s56 offen sc1
  s_add_u32 s56, s46, 22528
  v_mfma_f32_16x16x32_bf16 v[208:211], v[184:187], a[168:171], v[208:211]
  v_mfma_f32_16x16x32_bf16 v[216:219], v[184:187], a[172:175], v[216:219]
  s_waitcnt lgkmcnt(6)
  v_mfma_f32_16x16x32_bf16 v[196:199], v[188:191], a[160:163], v[196:199]
  ds_read_b64_tr_b16 v[172:173], v9 offset:4096
  ds_read_b64_tr_b16 v[174:175], v9 offset:6144
  v_mfma_f32_16x16x32_bf16 v[204:207], v[188:191], a[164:167], v[204:207]
  v_mfma_f32_16x16x32_bf16 v[212:215], v[188:191], a[168:171], v[212:215]
  v_mfma_f32_16x16x32_bf16 v[220:223], v[188:191], a[172:175], v[220:223]
  s_waitcnt lgkmcnt(6)
  v_mfma_f32_16x16x32_bf16 v[192:195], v[160:163], a[176:179], v[192:195]
  ds_read_b64_tr_b16 v[176:177], v8 offset:32768
  ds_read_b64_tr_b16 v[178:179], v8 offset:34816
  v_mfma_f32_16x16x32_bf16 v[200:203], v[160:163], a[180:183], v[200:203]
  v_mfma_f32_16x16x32_bf16 v[208:211], v[160:163], a[184:187], v[208:211]
  v_mfma_f32_16x16x32_bf16 v[216:219], v[160:163], a[188:191], v[216:219]
  buffer_store_dwordx4 v[40:43], v5, s[8:11], s56 offen sc1
  s_waitcnt lgkmcnt(6)
  v_mfma_f32_16x16x32_bf16 v[196:199], v[164:167], a[176:179], v[196:199]
  ds_read_b64_tr_b16 v[180:181], v9 offset:32768
  ds_read_b64_tr_b16 v[182:183], v9 offset:34816
  v_mfma_f32_16x16x32_bf16 v[204:207], v[164:167], a[180:183], v[204:207]
  s_add_u32 s56, s46, 40960
  v_mfma_f32_16x16x32_bf16 v[212:215], v[164:167], a[184:187], v[212:215]
  v_mfma_f32_16x16x32_bf16 v[220:223], v[164:167], a[188:191], v[220:223]
  s_waitcnt lgkmcnt(6)
  v_mfma_f32_16x16x32_bf16 v[192:195], v[168:171], a[192:195], v[192:195]
  ds_read_b64_tr_b16 v[184:185], v8 offset:36864
  ds_read_b64_tr_b16 v[186:187], v8 offset:38912
  v_mfma_f32_16x16x32_bf16 v[200:203], v[168:171], a[196:199], v[200:203]
  v_mfma_f32_16x16x32_bf16 v[208:211], v[168:171], a[200:203], v[208:211]
  v_mfma_f32_16x16x32_bf16 v[216:219], v[168:171], a[204:207], v[216:219]
  s_waitcnt lgkmcnt(6)
  v_mfma_f32_16x16x32_bf16 v[196:199], v[172:175], a[192:195], v[196:199]
  ds_read_b64_tr_b16 v[188:189], v9 offset:36864
  ds_read_b64_tr_b16 v[190:191], v9 offset:38912
  v_mfma_f32_16x16x32_bf16 v[204:207], v[172:175], a[196:199], v[204:207]
  buffer_store_dwordx4 v[48:51], v5, s[8:11], s56 offen sc1
  s_add_u32 s56, s46, 59392
  v_mfma_f32_16x16x32_bf16 v[212:215], v[172:175], a[200:203], v[212:215]
  v_mfma_f32_16x16x32_bf16 v[220:223], v[172:175], a[204:207], v[220:223]
  s_waitcnt lgkmcnt(6)
  v_mfma_f32_16x16x32_bf16 v[192:195], v[176:179], a[208:211], v[192:195]
  s_waitcnt vmcnt(11)
  s_barrier
  ds_read_b64_tr_b16 v[160:161], v12 offset:16384
  ds_read_b64_tr_b16 v[162:163], v12 offset:18432
  v_mfma_f32_16x16x32_bf16 v[200:203], v[176:179], a[212:215], v[200:203]
  v_mfma_f32_16x16x32_bf16 v[208:211], v[176:179], a[216:219], v[208:211]
  v_mfma_f32_16x16x32_bf16 v[216:219], v[176:179], a[220:223], v[216:219]
  s_waitcnt lgkmcnt(6)
  v_mfma_f32_16x16x32_bf16 v[196:199], v[180:183], a[208:211], v[196:199]
  ds_read_b64_tr_b16 v[164:165], v13 offset:16384
  ds_read_b64_tr_b16 v[166:167], v13 offset:18432
  v_mfma_f32_16x16x32_bf16 v[204:207], v[180:183], a[212:215], v[204:207]
  v_mfma_f32_16x16x32_bf16 v[212:215], v[180:183], a[216:219], v[212:215]
  v_mfma_f32_16x16x32_bf16 v[220:223], v[180:183], a[220:223], v[220:223]
  buffer_store_dwordx4 v[56:59], v5, s[8:11], s56 offen sc1
  s_waitcnt lgkmcnt(6)
  v_mfma_f32_16x16x32_bf16 v[192:195], v[184:187], a[224:227], v[192:195]
  ds_read_b64_tr_b16 v[168:169], v12 offset:20480
  ds_read_b64_tr_b16 v[170:171], v12 offset:22528
  v_mfma_f32_16x16x32_bf16 v[200:203], v[184:187], a[228:231], v[200:203]
  v_mfma_f32_16x16x32_bf16 v[208:211], v[184:187], a[232:235], v[208:211]
  v_mfma_f32_16x16x32_bf16 v[216:219], v[184:187], a[236:239], v[216:219]
  s_waitcnt lgkmcnt(6)
  v_mfma_f32_16x16x32_bf16 v[196:199], v[188:191], a[224:227], v[196:199]
  ds_read_b64_tr_b16 v[172:173], v13 offset:20480
  ds_read_b64_tr_b16 v[174:175], v13 offset:22528
  v_mfma_f32_16x16x32_bf16 v[204:207], v[188:191], a[228:231], v[204:207]
  v_mfma_f32_16x16x32_bf16 v[212:215], v[188:191], a[232:235], v[212:215]
  v_mfma_f32_16x16x32_bf16 v[220:223], v[188:191], a[236:239], v[220:223]
  s_waitcnt lgkmcnt(6)
  v_mfma_f32_16x16x32_bf16 v[192:195], v[160:163], a[240:243], v[192:195]
  ds_read_b64_tr_b16 v[176:177], v8 offset:8192
  ds_read_b64_tr_b16 v[178:179], v8 offset:10240
  v_mfma_f32_16x16x32_bf16 v[200:203], v[160:163], a[244:247], v[200:203]
  buffer_store_dwordx4 v[128:131], v5, s[8:11], s51 offen sc1
  s_add_u32 s51, s51, 36864
  v_mfma_f32_16x16x32_bf16 v[208:211], v[160:163], a[248:251], v[208:211]
  v_mfma_f32_16x16x32_bf16 v[216:219], v[160:163], a[252:255], v[216:219]
  s_waitcnt lgkmcnt(6)
  v_mfma_f32_16x16x32_bf16 v[196:199], v[164:167], a[240:243], v[196:199]
  ds_read_b64_tr_b16 v[180:181], v9 offset:8192
  ds_read_b64_tr_b16 v[182:183], v9 offset:10240
  v_mfma_f32_16x16x32_bf16 v[204:207], v[164:167], a[244:247], v[204:207]
  v_mfma_f32_16x16x32_bf16 v[212:215], v[164:167], a[248:251], v[212:215]
  v_mfma_f32_16x16x32_bf16 v[220:223], v[164:167], a[252:255], v[220:223]
  s_waitcnt lgkmcnt(6)
  v_mfma_f32_16x16x32_bf16 v[192:195], v[168:171], v[224:227], v[192:195]
  v_mfma_f32_16x16x32_bf16 v[200:203], v[168:171], v[228:231], v[200:203]
  v_mfma_f32_16x16x32_bf16 v[208:211], v[168:171], v[232:235], v[208:211]
  v_mfma_f32_16x16x32_bf16 v[216:219], v[168:171], v[236:239], v[216:219]
  buffer_store_dwordx4 v[132:135], v5, s[8:11], s51 offen sc1
  s_waitcnt lgkmcnt(4)
  v_mfma_f32_16x16x32_bf16 v[196:199], v[172:175], v[224:227], v[196:199]
  v_mfma_f32_16x16x32_bf16 v[204:207], v[172:175], v[228:231], v[204:207]
  v_mfma_f32_16x16x32_bf16 v[212:215], v[172:175], v[232:235], v[212:215]
  v_mfma_f32_16x16x32_bf16 v[220:223], v[172:175], v[236:239], v[220:223]
  s_waitcnt lgkmcnt(2)
  v_mfma_f32_16x16x32_bf16 v[192:195], v[176:179], v[240:243], v[192:195]
  v_mfma_f32_16x16x32_bf16 v[200:203], v[176:179], v[244:247], v[200:203]
  v_mfma_f32_16x16x32_bf16 v[208:211], v[176:179], v[248:251], v[208:211]
  v_mfma_f32_16x16x32_bf16 v[216:219], v[176:179], v[252:255], v[216:219]
  s_waitcnt lgkmcnt(0)
  v_mfma_f32_16x16x32_bf16 v[196:199], v[180:183], v[240:243], v[196:199]
  v_mfma_f32_16x16x32_bf16 v[204:207], v[180:183], v[244:247], v[204:207]
  v_mfma_f32_16x16x32_bf16 v[212:215], v[180:183], v[248:251], v[212:215]
  v_mfma_f32_16x16x32_bf16 v[220:223], v[180:183], v[252:255], v[220:223]
  v_cvt_pk_bf16_f32 v192, v192, v193
  v_cvt_pk_bf16_f32 v193, v194, v195
  v_cvt_pk_bf16_f32 v200, v200, v201
  v_cvt_pk_bf16_f32 v201, v202, v203
  v_cvt_pk_bf16_f32 v208, v208, v209
  v_cvt_pk_bf16_f32 v209, v210, v211
  v_cvt_pk_bf16_f32 v216, v216, v217
  v_cvt_pk_bf16_f32 v217, v218, v219
  v_cvt_pk_bf16_f32 v194, v196, v197
  v_cvt_pk_bf16_f32 v195, v198, v199
  v_cvt_pk_bf16_f32 v202, v204, v205
  v_cvt_pk_bf16_f32 v203, v206, v207
  v_cvt_pk_bf16_f32 v210, v212, v213
  v_cvt_pk_bf16_f32 v211, v214, v215
  v_cvt_pk_bf16_f32 v218, v220, v221
  v_cvt_pk_bf16_f32 v219, v222, v223
  s_add_u32 s56, s46, 6144
  buffer_store_dwordx4 v[192:195], v5, s[8:11], s56 offen sc1
  s_add_u32 s56, s46, 24576
  buffer_store_dwordx4 v[200:203], v5, s[8:11], s56 offen sc1
  s_add_u32 s56, s46, 43008
  buffer_store_dwordx4 v[208:211], v5, s[8:11], s56 offen sc1
  s_add_u32 s56, s46, 61440
  buffer_store_dwordx4 v[216:219], v5, s[8:11], s56 offen sc1
  s_load_dwordx2 s[12:13], s[0:1], 56
  s_lshr_b32 s30, s25, 1
  s_lshl_b32 s31, s26, 3
  s_add_u32 s30, s30, s31
  s_and_b32 s31, s25, 1
  v_lshrrev_b32 v33, 3, v2
  v_and_b32 v34, 7, v2
  v_lshlrev_b32 v32, 8, v33
  v_lshl_add_u32 v32, v34, 4, v32
  s_lshl_b32 s34, s24, 11
  s_lshl_b32 s35, s31, 7
  s_add_u32 s34, s34, s35
  v_add_u32 v32, s34, v32
  v_add_u32 v35, 10240, v32
  v_and_b32 v41, 1, v33
  v_bfe_u32 v42, v2, 4, 1
  v_lshrrev_b32 v43, 5, v2
  v_lshlrev_b32 v36, 10, v41
  v_lshl_add_u32 v36, v34, 4, v36
  v_lshl_add_u32 v36, v43, 2, v36
  s_lshl_b32 s34, s24, 8
  s_add_u32 s34, s34, s35
  s_add_u32 s34, s34, 8192
  v_add_u32 v36, s34, v36
  v_mul_u32_u24 v37, 18432, v42
  s_and_b32 s34, s30, 1
  s_lshl_b32 s34, s34, 3
  v_add3_u32 v37, v37, v36, s34
  v_lshl_add_u32 v36, v42, 3, v36
  s_mul_i32 s36, s30, 18432
  s_add_u32 s37, s36, 12460032
  s_and_b32 s38, s30, -2
  s_mul_i32 s38, s38, 18432
  s_add_u32 s38, s38, 12460032
  v_subrev_u32 v44, 16, v2
  v_min_u32 v44, 5, v44
  s_bfe_u32 s34, s30, 0x20002
  s_mul_i32 s34, s34, 6
  v_add_u32 v44, s34, v44
  v_lshrrev_b32 v45, 1, v44
  v_lshlrev_b32 v45, 4, v45
  v_and_b32 v44, 1, v44
  s_lshr_b32 s34, s30, 4
  s_lshl_b32 s34, s34, 1
  v_add3_u32 v44, v44, v45, s34
  s_lshl_b32 s34, s26, 4
  v_add_u32 v45, s34, v2
  v_cmp_gt_u32 vcc, 16, v2
  s_nop 1
  v_cndmask_b32 v38, v44, v45, vcc
  v_lshlrev_b32 v38, 7, v38
  v_cndmask_b32 v39, 0, 3, vcc
  s_add_u32 s39, s3, 54730752
  s_lshl_b32 s34, s30, 4
  s_lshl_b32 s35, s31, 3
  s_add_u32 s34, s34, s35
  v_add_u32 v46, s34, v34
  v_mul_u32_u24 v46, 1152, v46
  v_lshl_add_u32 v47, v41, 6, v46
  v_lshl_add_u32 v47, v42, 5, v47
  v_lshl_add_u32 v47, v43, 2, v47
  s_lshl_b32 s34, s24, 3
  s_add_u32 s34, s34, 512
  v_add_u32 v47, s34, v47
  v_lshl_add_u32 v46, v43, 6, v46
  v_and_b32 v45, 3, v33
  v_lshl_add_u32 v46, v45, 3, v46
  s_lshl_b32 s34, s24, 7
  v_add_u32 v46, s34, v46
  v_lshlrev_b32 v48, 4, v34
  s_lshl_b32 s34, s24, 2
  v_add_u32 v48, 147456, v48
  v_add_u32 v49, s34, v48
  v_mov_b32 v1, 3
  s_mov_b32 s14, 2359296
  s_mov_b32 s15, 0x20000
  s_waitcnt vmcnt(0) lgkmcnt(0)
  s_barrier
  buffer_store_dword v1, v7, s[8:11], 0 offen sc1
  s_mov_b32 s47, 0
  s_mov_b32 exec_hi, 0
  s_lshl_b32 exec_lo, 0x11111111, s24
tp_36:
  buffer_load_dword v40, v38, s[8:11], s39 offen sc1
  s_waitcnt vmcnt(0)
  v_cmp_lt_i32 vcc, v40, v39
  s_add_u32 s47, s47, 1
  s_cbranch_vccz tpd_37
  buffer_load_dword v41, v38, s[8:11], s39 offen sc1
  s_waitcnt vmcnt(0)
  v_cmp_lt_i32 vcc, v41, v39
  s_add_u32 s47, s47, 1
  s_cbranch_vccz tpd_37
  s_cmp_lt_u32 s47, 0x40000
  s_cbranch_scc1 tp_36
tpd_37:
  s_mov_b64 exec, -1
  s_barrier
  buffer_load_dwordx4 v[64:67], v32, s[8:11], s37 offen sc1
  buffer_load_dwordx4 v[68:71], v35, s[8:11], s37 offen sc1
  buffer_load_dword v128, v37, s[8:11], s38 offen sc1
  s_add_u32 s37, s37, 2359296
  s_add_u32 s38, s38, 2359296
  buffer_load_dwordx4 v[72:75], v32, s[8:11], s37 offen sc1
  buffer_load_dwordx4 v[76:79], v35, s[8:11], s37 offen sc1
  buffer_load_dword v129, v37, s[8:11], s38 offen sc1
  s_add_u32 s37, s37, 2359296
  s_add_u32 s38, s38, 2359296
  buffer_load_dwordx4 v[80:83], v32, s[8:11], s37 offen sc1
  buffer_load_dwordx4 v[84:87], v35, s[8:11], s37 offen sc1
  buffer_load_dword v130, v37, s[8:11], s38 offen sc1
  s_add_u32 s37, s37, 2359296
  s_add_u32 s38, s38, 2359296
  buffer_load_dwordx4 v[88:91], v32, s[8:11], s37 offen sc1
  buffer_load_dwordx4 v[92:95], v35, s[8:11], s37 offen sc1
  buffer_load_dword v131, v37, s[8:11], s38 offen sc1
  s_add_u32 s37, s37, 2359296
  s_add_u32 s38, s38, 2359296
  buffer_load_dwordx4 v[96:99], v32, s[8:11], s37 offen sc1
  buffer_load_dwordx4 v[100:103], v35, s[8:11], s37 offen sc1
  buffer_load_dword v132, v37, s[8:11], s38 offen sc1
  s_add_u32 s37, s37, 2359296
  s_add_u32 s38, s38, 2359296
  buffer_load_dwordx4 v[104:107], v32, s[8:11], s37 offen sc1
  buffer_load_dwordx4 v[108:111], v35, s[8:11], s37 offen sc1
  buffer_load_dword v133, v37, s[8:11], s38 offen sc1
  s_add_u32 s37, s37, 2359296
  s_add_u32 s38, s38, 2359296
  buffer_load_dwordx4 v[112:115], v32, s[8:11], s37 offen sc1
  buffer_load_dwordx4 v[116:119], v35, s[8:11], s37 offen sc1
  buffer_load_dword v134, v37, s[8:11], s38 offen sc1
  s_add_u32 s37, s37, 2359296
  s_add_u32 s38, s38, 2359296
  buffer_load_dwordx4 v[120:123], v32, s[8:11], s37 offen sc1
  buffer_load_dwordx4 v[124:127], v35, s[8:11], s37 offen sc1
  buffer_load_dword v135, v37, s[8:11], s38 offen sc1
  buffer_load_dwordx4 v[136:139], v32, s[8:11], s36 offen sc1
  buffer_load_dwordx4 v[140:143], v35, s[8:11], s36 offen sc1
  buffer_load_dword v144, v36, s[8:11], s36 offen sc1
  s_waitcnt vmcnt(26)
  v_lshlrev_b32 v160, 16, v64
  v_and_b32 v161, 0xffff0000, v64
  v_lshlrev_b32 v162, 16, v65
  v_and_b32 v163, 0xffff0000, v65
  v_lshlrev_b32 v164, 16, v66
  v_and_b32 v165, 0xffff0000, v66
  v_lshlrev_b32 v166, 16, v67
  v_and_b32 v167, 0xffff0000, v67
  s_waitcnt vmcnt(25)
  v_lshlrev_b32 v168, 16, v68
  v_and_b32 v169, 0xffff0000, v68
  v_lshlrev_b32 v170, 16, v69
  v_and_b32 v171, 0xffff0000, v69
  v_lshlrev_b32 v172, 16, v70
  v_and_b32 v173, 0xffff0000, v70
  v_lshlrev_b32 v174, 16, v71
  v_and_b32 v175, 0xffff0000, v71
  s_waitcnt vmcnt(24)
  v_lshlrev_b32 v176, 16, v128
  v_and_b32 v177, 0xffff0000, v128
  s_waitcnt vmcnt(23)
  v_lshlrev_b32 v50, 16, v72
  v_and_b32 v51, s33, v72
  v_add_f32 v160, v160, v50
  v_add_f32 v161, v161, v51
  v_lshlrev_b32 v52, 16, v73
  v_and_b32 v53, s33, v73
  v_add_f32 v162, v162, v52
  v_add_f32 v163, v163, v53
  v_lshlrev_b32 v50, 16, v74
  v_and_b32 v51, s33, v74
  v_add_f32 v164, v164, v50
  v_add_f32 v165, v165, v51
  v_lshlrev_b32 v52, 16, v75
  v_and_b32 v53, s33, v75
  v_add_f32 v166, v166, v52
  v_add_f32 v167, v167, v53
  s_waitcnt vmcnt(22)
  v_lshlrev_b32 v50, 16, v76
  v_and_b32 v51, s33, v76
  v_add_f32 v168, v168, v50
  v_add_f32 v169, v169, v51
  v_lshlrev_b32 v52, 16, v77
  v_and_b32 v53, s33, v77
  v_add_f32 v170, v170, v52
  v_add_f32 v171, v171, v53
  v_lshlrev_b32 v50, 16, v78
  v_and_b32 v51, s33, v78
  v_add_f32 v172, v172, v50
  v_add_f32 v173, v173, v51
  v_lshlrev_b32 v52, 16, v79
  v_and_b32 v53, s33, v79
  v_add_f32 v174, v174, v52
  v_add_f32 v175, v175, v53
  s_waitcnt vmcnt(21)
  v_lshlrev_b32 v50, 16, v129
  v_and_b32 v51, s33, v129
  v_add_f32 v176, v176, v50
  v_add_f32 v177, v177, v51
  s_waitcnt vmcnt(20)
  v_lshlrev_b32 v50, 16, v80
  v_and_b32 v51, s33, v80
  v_add_f32 v160, v160, v50
  v_add_f32 v161, v161, v51
  v_lshlrev_b32 v52, 16, v81
  v_and_b32 v53, s33, v81
  v_add_f32 v162, v162, v52
  v_add_f32 v163, v163, v53
  v_lshlrev_b32 v50, 16, v82
  v_and_b32 v51, s33, v82
  v_add_f32 v164, v164, v50
  v_add_f32 v165, v165, v51
  v_lshlrev_b32 v52, 16, v83
  v_and_b32 v53, s33, v83
  v_add_f32 v166, v166, v52
  v_add_f32 v167, v167, v53
  s_waitcnt vmcnt(19)
  v_lshlrev_b32 v50, 16, v84
  v_and_b32 v51, s33, v84
  v_add_f32 v168, v168, v50
  v_add_f32 v169, v169, v51
  v_lshlrev_b32 v52, 16, v85
  v_and_b32 v53, s33, v85
  v_add_f32 v170, v170, v52
  v_add_f32 v171, v171, v53
  v_lshlrev_b32 v50, 16, v86
  v_and_b32 v51, s33, v86
  v_add_f32 v172, v172, v50
  v_add_f32 v173, v173, v51
  v_lshlrev_b32 v52, 16, v87
  v_and_b32 v53, s33, v87
  v_add_f32 v174, v174, v52
  v_add_f32 v175, v175, v53
  s_waitcnt vmcnt(18)
  v_lshlrev_b32 v50, 16, v130
  v_and_b32 v51, s33, v130
  v_add_f32 v176, v176, v50
  v_add_f32 v177, v177, v51
  s_waitcnt vmcnt(17)
  v_lshlrev_b32 v50, 16, v88
  v_and_b32 v51, s33, v88
  v_add_f32 v160, v160, v50
  v_add_f32 v161, v161, v51
  v_lshlrev_b32 v52, 16, v89
  v_and_b32 v53, s33, v89
  v_add_f32 v162, v162, v52
  v_add_f32 v163, v163, v53
  v_lshlrev_b32 v50, 16, v90
  v_and_b32 v51, s33, v90
  v_add_f32 v164, v164, v50
  v_add_f32 v165, v165, v51
  v_lshlrev_b32 v52, 16, v91
  v_and_b32 v53, s33, v91
  v_add_f32 v166, v166, v52
  v_add_f32 v167, v167, v53
  s_waitcnt vmcnt(16)
  v_lshlrev_b32 v50, 16, v92
  v_and_b32 v51, s33, v92
  v_add_f32 v168, v168, v50
  v_add_f32 v169, v169, v51
  v_lshlrev_b32 v52, 16, v93
  v_and_b32 v53, s33, v93
  v_add_f32 v170, v170, v52
  v_add_f32 v171, v171, v53
  v_lshlrev_b32 v50, 16, v94
  v_and_b32 v51, s33, v94
  v_add_f32 v172, v172, v50
  v_add_f32 v173, v173, v51
  v_lshlrev_b32 v52, 16, v95
  v_and_b32 v53, s33, v95
  v_add_f32 v174, v174, v52
  v_add_f32 v175, v175, v53
  s_waitcnt vmcnt(15)
  v_lshlrev_b32 v50, 16, v131
  v_and_b32 v51, s33, v131
  v_add_f32 v176, v176, v50
  v_add_f32 v177, v177, v51
  s_waitcnt vmcnt(14)
  v_lshlrev_b32 v50, 16, v96
  v_and_b32 v51, s33, v96
  v_add_f32 v160, v160, v50
  v_add_f32 v161, v161, v51
  v_lshlrev_b32 v52, 16, v97
  v_and_b32 v53, s33, v97
  v_add_f32 v162, v162, v52
  v_add_f32 v163, v163, v53
  v_lshlrev_b32 v50, 16, v98
  v_and_b32 v51, s33, v98
  v_add_f32 v164, v164, v50
  v_add_f32 v165, v165, v51
  v_lshlrev_b32 v52, 16, v99
  v_and_b32 v53, s33, v99
  v_add_f32 v166, v166, v52
  v_add_f32 v167, v167, v53
  s_waitcnt vmcnt(13)
  v_lshlrev_b32 v50, 16, v100
  v_and_b32 v51, s33, v100
  v_add_f32 v168, v168, v50
  v_add_f32 v169, v169, v51
  v_lshlrev_b32 v52, 16, v101
  v_and_b32 v53, s33, v101
  v_add_f32 v170, v170, v52
  v_add_f32 v171, v171, v53
  v_lshlrev_b32 v50, 16, v102
  v_and_b32 v51, s33, v102
  v_add_f32 v172, v172, v50
  v_add_f32 v173, v173, v51
  v_lshlrev_b32 v52, 16, v103
  v_and_b32 v53, s33, v103
  v_add_f32 v174, v174, v52
  v_add_f32 v175, v175, v53
  s_waitcnt vmcnt(12)
  v_lshlrev_b32 v50, 16, v132
  v_and_b32 v51, s33, v132
  v_add_f32 v176, v176, v50
  v_add_f32 v177, v177, v51
  s_waitcnt vmcnt(11)
  v_lshlrev_b32 v50, 16, v104
  v_and_b32 v51, s33, v104
  v_add_f32 v160, v160, v50
  v_add_f32 v161, v161, v51
  v_lshlrev_b32 v52, 16, v105
  v_and_b32 v53, s33, v105
  v_add_f32 v162, v162, v52
  v_add_f32 v163, v163, v53
  v_lshlrev_b32 v50, 16, v106
  v_and_b32 v51, s33, v106
  v_add_f32 v164, v164, v50
  v_add_f32 v165, v165, v51
  v_lshlrev_b32 v52, 16, v107
  v_and_b32 v53, s33, v107
  v_add_f32 v166, v166, v52
  v_add_f32 v167, v167, v53
  s_waitcnt vmcnt(10)
  v_lshlrev_b32 v50, 16, v108
  v_and_b32 v51, s33, v108
  v_add_f32 v168, v168, v50
  v_add_f32 v169, v169, v51
  v_lshlrev_b32 v52, 16, v109
  v_and_b32 v53, s33, v109
  v_add_f32 v170, v170, v52
  v_add_f32 v171, v171, v53
  v_lshlrev_b32 v50, 16, v110
  v_and_b32 v51, s33, v110
  v_add_f32 v172, v172, v50
  v_add_f32 v173, v173, v51
  v_lshlrev_b32 v52, 16, v111
  v_and_b32 v53, s33, v111
  v_add_f32 v174, v174, v52
  v_add_f32 v175, v175, v53
  s_waitcnt vmcnt(9)
  v_lshlrev_b32 v50, 16, v133
  v_and_b32 v51, s33, v133
  v_add_f32 v176, v176, v50
  v_add_f32 v177, v177, v51
  s_waitcnt vmcnt(8)
  v_lshlrev_b32 v50, 16, v112
  v_and_b32 v51, s33, v112
  v_add_f32 v160, v160, v50
  v_add_f32 v161, v161, v51
  v_lshlrev_b32 v52, 16, v113
  v_and_b32 v53, s33, v113
  v_add_f32 v162, v162, v52
  v_add_f32 v163, v163, v53
  v_lshlrev_b32 v50, 16, v114
  v_and_b32 v51, s33, v114
  v_add_f32 v164, v164, v50
  v_add_f32 v165, v165, v51
  v_lshlrev_b32 v52, 16, v115
  v_and_b32 v53, s33, v115
  v_add_f32 v166, v166, v52
  v_add_f32 v167, v167, v53
  s_waitcnt vmcnt(7)
  v_lshlrev_b32 v50, 16, v116
  v_and_b32 v51, s33, v116
  v_add_f32 v168, v168, v50
  v_add_f32 v169, v169, v51
  v_lshlrev_b32 v52, 16, v117
  v_and_b32 v53, s33, v117
  v_add_f32 v170, v170, v52
  v_add_f32 v171, v171, v53
  v_lshlrev_b32 v50, 16, v118
  v_and_b32 v51, s33, v118
  v_add_f32 v172, v172, v50
  v_add_f32 v173, v173, v51
  v_lshlrev_b32 v52, 16, v119
  v_and_b32 v53, s33, v119
  v_add_f32 v174, v174, v52
  v_add_f32 v175, v175, v53
  s_waitcnt vmcnt(6)
  v_lshlrev_b32 v50, 16, v134
  v_and_b32 v51, s33, v134
  v_add_f32 v176, v176, v50
  v_add_f32 v177, v177, v51
  s_waitcnt vmcnt(5)
  v_lshlrev_b32 v50, 16, v120
  v_and_b32 v51, s33, v120
  v_add_f32 v160, v160, v50
  v_add_f32 v161, v161, v51
  v_lshlrev_b32 v52, 16, v121
  v_and_b32 v53, s33, v121
  v_add_f32 v162, v162, v52
  v_add_f32 v163, v163, v53
  v_lshlrev_b32 v50, 16, v122
  v_and_b32 v51, s33, v122
  v_add_f32 v164, v164, v50
  v_add_f32 v165, v165, v51
  v_lshlrev_b32 v52, 16, v123
  v_and_b32 v53, s33, v123
  v_add_f32 v166, v166, v52
  v_add_f32 v167, v167, v53
  s_waitcnt vmcnt(4)
  v_lshlrev_b32 v50, 16, v124
  v_and_b32 v51, s33, v124
  v_add_f32 v168, v168, v50
  v_add_f32 v169, v169, v51
  v_lshlrev_b32 v52, 16, v125
  v_and_b32 v53, s33, v125
  v_add_f32 v170, v170, v52
  v_add_f32 v171, v171, v53
  v_lshlrev_b32 v50, 16, v126
  v_and_b32 v51, s33, v126
  v_add_f32 v172, v172, v50
  v_add_f32 v173, v173, v51
  v_lshlrev_b32 v52, 16, v127
  v_and_b32 v53, s33, v127
  v_add_f32 v174, v174, v52
  v_add_f32 v175, v175, v53
  s_waitcnt vmcnt(3)
  v_lshlrev_b32 v50, 16, v135
  v_and_b32 v51, s33, v135
  v_add_f32 v176, v176, v50
  v_add_f32 v177, v177, v51
  s_waitcnt vmcnt(0)
tsum_35:
  v_cvt_pk_bf16_f32 v160, 0, v160
  v_cvt_pk_bf16_f32 v161, 0, v161
  v_lshlrev_b32 v50, 16, v136
  v_and_b32 v51, s33, v136
  v_add_f32 v160, v160, v50
  v_add_f32 v161, v161, v51
  v_cvt_pk_bf16_f32 v136, v160, v161
  v_cvt_pk_bf16_f32 v162, 0, v162
  v_cvt_pk_bf16_f32 v163, 0, v163
  v_lshlrev_b32 v50, 16, v137
  v_and_b32 v51, s33, v137
  v_add_f32 v162, v162, v50
  v_add_f32 v163, v163, v51
  v_cvt_pk_bf16_f32 v137, v162, v163
  v_cvt_pk_bf16_f32 v164, 0, v164
  v_cvt_pk_bf16_f32 v165, 0, v165
  v_lshlrev_b32 v50, 16, v138
  v_and_b32 v51, s33, v138
  v_add_f32 v164, v164, v50
  v_add_f32 v165, v165, v51
  v_cvt_pk_bf16_f32 v138, v164, v165
  v_cvt_pk_bf16_f32 v166, 0, v166
  v_cvt_pk_bf16_f32 v167, 0, v167
  v_lshlrev_b32 v50, 16, v139
  v_and_b32 v51, s33, v139
  v_add_f32 v166, v166, v50
  v_add_f32 v167, v167, v51
  v_cvt_pk_bf16_f32 v139, v166, v167
  v_cvt_pk_bf16_f32 v168, 0, v168
  v_cvt_pk_bf16_f32 v169, 0, v169
  v_lshlrev_b32 v50, 16, v140
  v_and_b32 v51, s33, v140
  v_add_f32 v168, v168, v50
  v_add_f32 v169, v169, v51
  v_cvt_pk_bf16_f32 v140, v168, v169
  v_cvt_pk_bf16_f32 v170, 0, v170
  v_cvt_pk_bf16_f32 v171, 0, v171
  v_lshlrev_b32 v50, 16, v141
  v_and_b32 v51, s33, v141
  v_add_f32 v170, v170, v50
  v_add_f32 v171, v171, v51
  v_cvt_pk_bf16_f32 v141, v170, v171
  v_cvt_pk_bf16_f32 v172, 0, v172
  v_cvt_pk_bf16_f32 v173, 0, v173
  v_lshlrev_b32 v50, 16, v142
  v_and_b32 v51, s33, v142
  v_add_f32 v172, v172, v50
  v_add_f32 v173, v173, v51
  v_cvt_pk_bf16_f32 v142, v172, v173
  v_cvt_pk_bf16_f32 v174, 0, v174
  v_cvt_pk_bf16_f32 v175, 0, v175
  v_lshlrev_b32 v50, 16, v143
  v_and_b32 v51, s33, v143
  v_add_f32 v174, v174, v50
  v_add_f32 v175, v175, v51
  v_cvt_pk_bf16_f32 v143, v174, v175
  v_cvt_pk_bf16_f32 v176, 0, v176
  v_cvt_pk_bf16_f32 v177, 0, v177
  v_lshlrev_b32 v50, 16, v144
  v_and_b32 v51, s33, v144
  v_add_f32 v176, v176, v50
  v_add_f32 v177, v177, v51
  v_cvt_pk_bf16_f32 v144, v176, v177
  buffer_store_dwordx2 v[136:137], v46, s[12:15], 0 offen offset:0 sc1
  buffer_store_dwordx2 v[138:139], v46, s[12:15], 0 offen offset:32 sc1
  buffer_store_dwordx2 v[140:141], v46, s[12:15], 0 offen offset:640 sc1
  buffer_store_dwordx2 v[142:143], v46, s[12:15], 0 offen offset:672 sc1
  buffer_store_dword v144, v47, s[12:15], 0 offen sc1
  s_cmp_lg_u32 s3, 0
  s_cbranch_scc1 fin_11
  v_lshlrev_b32 v160, 16, v136
  v_and_b32 v161, s33, v136
  v_lshlrev_b32 v162, 16, v137
  v_and_b32 v163, s33, v137
  v_lshlrev_b32 v164, 16, v138
  v_and_b32 v165, s33, v138
  v_lshlrev_b32 v166, 16, v139
  v_and_b32 v167, s33, v139
  v_lshlrev_b32 v168, 16, v140
  v_and_b32 v169, s33, v140
  v_lshlrev_b32 v170, 16, v141
  v_and_b32 v171, s33, v141
  v_lshlrev_b32 v172, 16, v142
  v_and_b32 v173, s33, v142
  v_lshlrev_b32 v174, 16, v143
  v_and_b32 v175, s33, v143
  v_lshlrev_b32 v176, 16, v144
  v_and_b32 v177, s33, v144
  v_add_f32 v50, v160, v161
  v_add_f32 v51, v162, v163
  v_add_f32 v50, v50, v164
  v_add_f32 v51, v51, v165
  v_add_f32 v50, v50, v166
  v_add_f32 v51, v51, v167
  v_add_f32 v50, v50, v168
  v_add_f32 v51, v51, v169
  v_add_f32 v50, v50, v170
  v_add_f32 v51, v51, v171
  v_add_f32 v50, v50, v172
  v_add_f32 v51, v51, v173
  v_add_f32 v50, v50, v174
  v_add_f32 v51, v51, v175
  v_add_f32 v50, v50, v176
  v_add_f32 v51, v51, v177
  v_add_f32 v50, v50, v51
  s_nop 1
  v_add_f32_dpp v50, v50, v50 row_ror:8 row_mask:0xf bank_mask:0xf
  v_mov_b32 v53, v50
  s_nop 1
  v_permlane16_swap_b32 v50, v53
  v_add_f32 v50, v50, v53
  v_mov_b32 v53, v50
  s_nop 1
  v_permlane32_swap_b32 v50, v53
  v_add_f32 v50, v50, v53
  s_mov_b64 exec, 0xff
  ds_write_b32 v49, v50 offset:0
  s_mov_b64 exec, -1
  s_waitcnt lgkmcnt(0)
  s_barrier
  ds_read_b128 v[56:59], v48 offset:0
  s_waitcnt lgkmcnt(0)
  v_add_f32 v56, v56, v57
  v_add_f32 v58, v58, v59
  v_add_f32 v60, v56, v58
  v_mul_f32 v60, 0x3ae38e39, v60
  v_sub_f32 v52, v160, v60
  v_sub_f32 v53, v161, v60
  v_mul_f32 v50, v52, v52
  v_mul_f32 v51, v53, v53
  v_sub_f32 v52, v162, v60
  v_sub_f32 v53, v163, v60
  v_fmac_f32 v50, v52, v52
  v_fmac_f32 v51, v53, v53
  v_sub_f32 v52, v164, v60
  v_sub_f32 v53, v165, v60
  v_fmac_f32 v50, v52, v52
  v_fmac_f32 v51, v53, v53
  v_sub_f32 v52, v166, v60
  v_sub_f32 v53, v167, v60
  v_fmac_f32 v50, v52, v52
  v_fmac_f32 v51, v53, v53
  v_sub_f32 v52, v168, v60
  v_sub_f32 v53, v169, v60
  v_fmac_f32 v50, v52, v52
  v_fmac_f32 v51, v53, v53
  v_sub_f32 v52, v170, v60
  v_sub_f32 v53, v171, v60
  v_fmac_f32 v50, v52, v52
  v_fmac_f32 v51, v53, v53
  v_sub_f32 v52, v172, v60
  v_sub_f32 v53, v173, v60
  v_fmac_f32 v50, v52, v52
  v_fmac_f32 v51, v53, v53
  v_sub_f32 v52, v174, v60
  v_sub_f32 v53, v175, v60
  v_fmac_f32 v50, v52, v52
  v_fmac_f32 v51, v53, v53
  v_sub_f32 v52, v176, v60
  v_sub_f32 v53, v177, v60
  v_fmac_f32 v50, v52, v52
  v_fmac_f32 v51, v53, v53
  v_add_f32 v50, v50, v51
  s_nop 1
  v_add_f32_dpp v50, v50, v50 row_ror:8 row_mask:0xf bank_mask:0xf
  v_mov_b32 v53, v50
  s_nop 1
  v_permlane16_swap_b32 v50, v53
  v_add_f32 v50, v50, v53
  v_mov_b32 v53, v50
  s_nop 1
  v_permlane32_swap_b32 v50, v53
  v_add_f32 v50, v50, v53
  s_mov_b64 exec, 0xff
  ds_write_b32 v49, v50 offset:256
  s_mov_b64 exec, -1
  s_waitcnt lgkmcnt(0)
  s_barrier
  ds_read_b128 v[56:59], v48 offset:256
  s_waitcnt lgkmcnt(0)
  v_add_f32 v56, v56, v57
  v_add_f32 v58, v58, v59
  v_add_f32 v61, v56, v58
  v_mul_f32 v61, 0x3ae38e39, v61
  v_cvt_pk_bf16_f32 v60, 0, v60
  v_cvt_pk_bf16_f32 v61, 0, v61
  v_add_f32 v61, 0x3727c5ac, v61
  v_cvt_pk_bf16_f32 v61, 0, v61
  v_sqrt_f32 v61, v61
  s_nop 0
  v_cvt_pk_bf16_f32 v61, 0, v61
  v_rcp_f32 v61, v61
  v_sub_f32 v160, v160, v60
  v_sub_f32 v161, v161, v60
  v_cvt_pk_bf16_f32 v50, v160, v161
  v_lshlrev_b32 v160, 16, v50
  v_and_b32 v161, 0xffff0000, v50
  v_mul_f32 v160, v160, v61
  v_mul_f32 v161, v161, v61
  v_cvt_pk_bf16_f32 v64, v160, v161
  v_sub_f32 v162, v162, v60
  v_sub_f32 v163, v163, v60
  v_cvt_pk_bf16_f32 v50, v162, v163
  v_lshlrev_b32 v162, 16, v50
  v_and_b32 v163, 0xffff0000, v50
  v_mul_f32 v162, v162, v61
  v_mul_f32 v163, v163, v61
  v_cvt_pk_bf16_f32 v65, v162, v163
  v_sub_f32 v164, v164, v60
  v_sub_f32 v165, v165, v60
  v_cvt_pk_bf16_f32 v50, v164, v165
  v_lshlrev_b32 v164, 16, v50
  v_and_b32 v165, 0xffff0000, v50
  v_mul_f32 v164, v164, v61
  v_mul_f32 v165, v165, v61
  v_cvt_pk_bf16_f32 v66, v164, v165
  v_sub_f32 v166, v166, v60
  v_sub_f32 v167, v167, v60
  v_cvt_pk_bf16_f32 v50, v166, v167
  v_lshlrev_b32 v166, 16, v50
  v_and_b32 v167, 0xffff0000, v50
  v_mul_f32 v166, v166, v61
  v_mul_f32 v167, v167, v61
  v_cvt_pk_bf16_f32 v67, v166, v167
  v_sub_f32 v168, v168, v60
  v_sub_f32 v169, v169, v60
  v_cvt_pk_bf16_f32 v50, v168, v169
  v_lshlrev_b32 v168, 16, v50
  v_and_b32 v169, 0xffff0000, v50
  v_mul_f32 v168, v168, v61
  v_mul_f32 v169, v169, v61
  v_cvt_pk_bf16_f32 v68, v168, v169
  v_sub_f32 v170, v170, v60
  v_sub_f32 v171, v171, v60
  v_cvt_pk_bf16_f32 v50, v170, v171
  v_lshlrev_b32 v170, 16, v50
  v_and_b32 v171, 0xffff0000, v50
  v_mul_f32 v170, v170, v61
  v_mul_f32 v171, v171, v61
  v_cvt_pk_bf16_f32 v69, v170, v171
  v_sub_f32 v172, v172, v60
  v_sub_f32 v173, v173, v60
  v_cvt_pk_bf16_f32 v50, v172, v173
  v_lshlrev_b32 v172, 16, v50
  v_and_b32 v173, 0xffff0000, v50
  v_mul_f32 v172, v172, v61
  v_mul_f32 v173, v173, v61
  v_cvt_pk_bf16_f32 v70, v172, v173
  v_sub_f32 v174, v174, v60
  v_sub_f32 v175, v175, v60
  v_cvt_pk_bf16_f32 v50, v174, v175
  v_lshlrev_b32 v174, 16, v50
  v_and_b32 v175, 0xffff0000, v50
  v_mul_f32 v174, v174, v61
  v_mul_f32 v175, v175, v61
  v_cvt_pk_bf16_f32 v71, v174, v175
  v_sub_f32 v176, v176, v60
  v_sub_f32 v177, v177, v60
  v_cvt_pk_bf16_f32 v50, v176, v177
  v_lshlrev_b32 v176, 16, v50
  v_and_b32 v177, 0xffff0000, v50
  v_mul_f32 v176, v176, v61
  v_mul_f32 v177, v177, v61
  v_cvt_pk_bf16_f32 v72, v176, v177
  s_add_u32 s36, s36, 4947968
  buffer_store_dwordx4 v[64:67], v32, s[8:11], s36 offen sc1
  buffer_store_dwordx4 v[68:71], v35, s[8:11], s36 offen sc1
  buffer_store_dword v72, v36, s[8:11], s36 offen sc1
fin_11:
end_10:
  s_endpgm
slow_29:
  s_mov_b32 s31, 0
slow_29_l:
  buffer_load_dword v23, off, s[8:11], s59 sc1
  s_waitcnt vmcnt(0)
  v_readfirstlane_b32 s30, v23
  s_add_u32 s31, s31, 1
  s_cmp_ge_i32 s30, 0
  s_cbranch_scc1 back_30
  s_cmp_lt_u32 s31, 0x40000
  s_cbranch_scc1 slow_29_l
  s_branch back_30
slow_31:
  s_mov_b32 s31, 0
slow_31_l:
  buffer_load_dword v23, off, s[8:11], s59 sc1
  s_waitcnt vmcnt(0)
  v_readfirstlane_b32 s30, v23
  s_add_u32 s31, s31, 1
  s_cmp_ge_i32 s30, 1
  s_cbranch_scc1 back_32
  s_cmp_lt_u32 s31, 0x40000
  s_cbranch_scc1 slow_31_l
  s_branch back_32
slow_33:
  s_mov_b32 s31, 0
slow_33_l:
  buffer_load_dword v23, off, s[8:11], s59 sc1
  s_waitcnt vmcnt(0)
  v_readfirstlane_b32 s30, v23
  s_add_u32 s31, s31, 1
  s_cmp_ge_i32 s30, 2
  s_cbranch_scc1 back_34
  s_cmp_lt_u32 s31, 0x40000
  s_cbranch_scc1 slow_33_l
  s_branch back_34
code_end:
.section .rodata,"a"
.p2align 6
.amdhsa_kernel k0_kernel
  .amdhsa_next_free_vgpr 96
  .amdhsa_next_free_sgpr 102
  .amdhsa_accum_offset 96
  .amdhsa_group_segment_fixed_size 0
  .amdhsa_kernarg_size 80
  .amdhsa_user_sgpr_count 2
  .amdhsa_user_sgpr_kernarg_segment_ptr 1
  .amdhsa_system_sgpr_workgroup_id_x 1
.end_amdhsa_kernel
.p2align 6
.amdhsa_kernel k3_kernel
  .amdhsa_next_free_vgpr 512
  .amdhsa_next_free_sgpr 102
  .amdhsa_accum_offset 256
  .amdhsa_group_segment_fixed_size 0
  .amdhsa_kernarg_size 80
  .amdhsa_user_sgpr_count 2
  .amdhsa_user_sgpr_kernarg_segment_ptr 1
  .amdhsa_system_sgpr_workgroup_id_x 1
.end_amdhsa_kernel
.p2align 6
.amdhsa_kernel k3d_kernel
  .amdhsa_next_free_vgpr 512
  .amdhsa_next_free_sgpr 102
  .amdhsa_accum_offset 256
  .amdhsa_group_segment_fixed_size 0
  .amdhsa_kernarg_size 80
  .amdhsa_user_sgpr_count 2
  .amdhsa_user_sgpr_kernarg_segment_ptr 1
  .amdhsa_system_sgpr_workgroup_id_x 1
.end_amdhsa_kernel
```
